```python
import torch

def _softmax(x, axis=-1):
    return torch.softmax(x, dim=axis)
def _gelu(x):
    return torch.nn.functional.gelu(x, approximate="tanh")
def _silu(x):
    return torch.nn.functional.silu(x)
def _sigmoid(x):
    return torch.sigmoid(x)
def _layernorm(x, axis=-1, eps=1e-5):
    m = x.mean(dim=axis, keepdim=True)
    v = x.var(dim=axis, keepdim=True, unbiased=False)
    return (x - m) / torch.sqrt(v + eps)
def _scatter_add(tgt, idx, src, axis=0):
    return tgt.clone().index_add_(axis, idx, src)
def _segment_sum(src, seg, n):
    out = torch.zeros((n,) + src.shape[1:], dtype=src.dtype)
    return out.index_add_(0, seg, src)
def _pad(x, pw):
    flat = tuple(v for pair in reversed(pw) for v in pair)
    return torch.nn.functional.pad(x, flat)

kernel_name = 'concat_heads__mha_block__ssm_conv_s4d__prompt'

def setup_inputs():

    _w = (lambda a: (lambda t: t.to(torch.bfloat16) if t.is_floating_point() else t)(torch.as_tensor(a)))
    def _A_setup():
        B, S, D, H = 1, 2048, 640, 32
        return {
            "x": _w((lambda *s: torch.randn(*s, dtype=torch.bfloat16) * 0.2)(B, S, D)),
            "wqkv": _w((lambda *s: torch.randn(*s, dtype=torch.bfloat16) * 0.2)(D, 3 * D)),
            "wo": _w((lambda *s: torch.randn(*s, dtype=torch.bfloat16) * 0.05)(D, D)),
        }
    _A_in = _A_setup()

    def _B_setup():
        Bsz, L, D, N = 1, 2048, 640, 128
        return {
            "u": _w((lambda *s: torch.randn(*s, dtype=torch.bfloat16) * 0.05)(Bsz, L, D)),
            "log_A_real": _w((lambda *s: torch.randn(*s, dtype=torch.bfloat16) * 6.4)(D, N) * 0.5),
            "A_imag": _w((lambda *s: torch.randn(*s, dtype=torch.bfloat16) * 0.1)(D, N) * 3.14),
            "C_real": _w((lambda *s: torch.randn(*s, dtype=torch.bfloat16) * 0.8)(D, N) / N ** 0.5),
            "C_imag": _w((lambda *s: torch.randn(*s, dtype=torch.bfloat16) * 0.8)(D, N) / N ** 0.5),
            "log_dt": _w((lambda *s: torch.randn(*s, dtype=torch.bfloat16) * 0.1)(D) * 0.5 - 4.0),
            "D_skip": _w((lambda *s: torch.randn(*s, dtype=torch.bfloat16) * 0.1)(D)),
        }
    _B_in = _B_setup()

    return {
        "A_x": _A_in["x"],
        "A_wqkv": _A_in["wqkv"],
        "A_wo": _A_in["wo"],
        "B_u": _B_in["u"],
        "B_log_A_real": _B_in["log_A_real"],
        "B_A_imag": _B_in["A_imag"],
        "B_C_real": _B_in["C_real"],
        "B_C_imag": _B_in["C_imag"],
        "B_log_dt": _B_in["log_dt"],
        "B_D_skip": _B_in["D_skip"],
    }

def reference(A_x, A_wqkv, A_wo, B_u, B_log_A_real, B_A_imag, B_C_real, B_C_imag, B_log_dt, B_D_skip):
    def _A_ref(x, wqkv, wo):
        B, S, D = x.shape
        H = 32
        Dh = D // H
        qkv = (lambda x, *d: x.permute(*d))((x @ wqkv).reshape(B, S, 3, H, Dh), 2, 0, 3, 1, 4)
        q, k, v = qkv[0], qkv[1], qkv[2]
        scores = torch.einsum("bhqd,bhkd->bhqk", q, k) * (Dh ** -0.5)
        p = _softmax(scores, axis=-1)
        o = torch.einsum("bhqk,bhkd->bhqd", p, v)
        return (lambda x, *d: x.permute(*d))(o, 0, 2, 1, 3).reshape(B, S, D) @ wo

    def _B_ref(u, log_A_real, A_imag, C_real, C_imag, log_dt, D_skip):
        L = u.shape[1]
        dt = torch.exp(log_dt)
        A = -torch.exp(log_A_real) + 1j * A_imag
        C = (C_real + 1j * C_imag) * dt[:, None]
        pos = (lambda x, dt: x.to(dt))(torch.arange(L), log_dt.dtype)
        P = torch.exp((A * dt[:, None])[:, :, None] * pos[None, None, :])
        K = 2.0 * torch.einsum("dn,dnl->dl", C, P).real
        L2 = 2 * L
        u_t = (lambda x, *d: x.permute(*d))(u, 0, 2, 1)
        Kf = (lambda x, *a, **k: torch.fft.rfft(x.float(), *a, **k))(K, L2)
        Uf = (lambda x, *a, **k: torch.fft.rfft(x.float(), *a, **k))(u_t, L2)
        y = (lambda x, *a, **k: torch.fft.irfft(x, *a, **k).to(torch.bfloat16))(Uf * Kf[None, :, :], L2)[:, :, :L]
        y = (lambda x, *d: x.permute(*d))(y, 0, 2, 1)
        return y + u * D_skip[None, None, :]

    a = _A_ref(A_x, A_wqkv, A_wo)
    b = _B_ref(B_u, B_log_A_real, B_A_imag, B_C_real, B_C_imag, B_log_dt, B_D_skip)
    return torch.concatenate([a, b], axis=-1)
```

```asm
; @launch grid=(256,1,1) block=(768,1,1) lds=163840
.amdgcn_target "amdgcn-amd-amdhsa--gfx950"
.text
.globl concat_heads__mha_block__ssm_conv_s4d__prompt_kernel
.p2align 8
.type concat_heads__mha_block__ssm_conv_s4d__prompt_kernel,@function
concat_heads__mha_block__ssm_conv_s4d__prompt_kernel:
    s_cmp_ge_u32 s2, 256
    s_cbranch_scc1 L_END
    s_load_dwordx16 s[36:51], s[0:1], 0
    s_load_dwordx8 s[52:59], s[0:1], 64
    s_load_dwordx2 s[60:61], s[0:1], 96
    v_lshrrev_b32 v1, 6, v0
    v_and_b32 v0, 63, v0
    v_readfirstlane_b32 s3, v1
    s_bitcmp1_b32 s3, 2
    s_cselect_b32 s88, 0, 8
    s_xor_b32 s3, s3, s88
    s_and_b32 s4, s2, 7
    s_lshr_b32 s5, s2, 3
    s_getpc_b64 s[90:91]
L_PC:
    s_lshl_b32 s88, s3, 5
    s_add_u32 s88, s88, s5
    s_lshl_b32 s88, s88, 7
    v_and_b32 v1, 1, v0
    v_mul_u32_u24 v1, 49152, v1
    v_add_u32 v1, s88, v1
    v_min_u32 v1, L_CODE_END-L_PC-4, v1
    global_load_dword v167, v1, s[90:91]
    s_cmp_ge_u32 s5, 30
    s_cbranch_scc1 L_FREE
    s_lshr_b32 s6, s4, 1
    s_lshl_b32 s6, s6, 2
    s_and_b32 s7, s5, 3
    s_add_u32 s6, s6, s7
    s_and_b32 s89, s4, 1
    s_lshr_b32 s88, s5, 2
    s_cmp_lt_u32 s5, 20
    s_cselect_b32 s7, 5, 3
    s_mul_i32 s7, s7, s89
    s_cselect_b32 s62, 5, -5
    s_add_u32 s7, s7, s88
    s_add_u32 s7, s7, s62
    s_lshl_b32 s89, s89, 1
    s_cmp_ge_u32 s5, 28
    s_cselect_b32 s7, 2, s7
    s_cselect_b32 s89, s89, 0
    s_add_u32 s6, s6, s89
    s_cmp_lt_u32 s3, 4
    s_cbranch_scc1 L_GEMM
    s_cmp_lt_u32 s3, 8
    s_cbranch_scc1 L_LOADER
    s_cmp_ge_u32 s5, 20
    s_cbranch_scc1 L_UTR
    s_sub_u32 s90, s3, 8
    s_mul_i32 s91, s4, 20
    s_add_u32 s91, s91, s5
    s_lshl_b32 s91, s91, 2
    s_add_u32 s91, s91, s90
    s_lshl_b32 s88, s91, 8
    v_lshl_add_u32 v10, v0, 2, s88
    s_lshl_b32 s88, s91, 1
    v_mov_b32 v11, s88
    s_waitcnt lgkmcnt(0)
    global_load_dword v17, v10, s[44:45] nt
    global_load_dword v19, v10, s[46:47] nt
    global_load_dword v21, v10, s[48:49] nt
    global_load_dword v23, v10, s[50:51] nt
    global_load_ushort v24, v11, s[52:53]
    global_load_ushort v25, v11, s[54:55]
    s_branch L_SSM
L_LOADER:
    s_sub_u32 s90, s3, 4
    v_lshrrev_b32 v10, 3, v0
    s_lshl_b32 s88, s6, 7
    s_lshl_b32 s89, s90, 5
    s_add_u32 s88, s88, s89
    v_add_u32 v10, s88, v10
    v_mul_u32_u24 v10, 1280, v10
    v_and_b32 v11, 7, v0
    v_lshrrev_b32 v12, 4, v0
    v_xor_b32 v13, v11, v12
    v_xor_b32 v14, 4, v13
    v_lshl_add_u32 v2, v13, 4, v10
    v_lshl_add_u32 v3, v14, 4, v10
    v_add_u32 v3, 10240, v3
    v_and_b32 v11, 15, v0
    v_lshlrev_b32 v13, 2, v12
    v_xor_b32 v11, v11, v13
    v_mul_u32_u24 v10, 3840, v12
    v_lshl_add_u32 v10, v11, 4, v10
    s_lshl_b32 s88, s7, 8
    s_mul_i32 s89, s90, 61440
    s_add_u32 s88, s88, s89
    v_add_u32 v6, s88, v10
    s_lshl_b32 s91, s90, 12
    s_and_b32 s88, s5, 28
    s_lshr_b32 s92, 0x87653210, s88
    s_and_b32 s92, s92, 15
    s_and_b32 s88, s5, 3
    s_lshl_b32 s88, s88, 2
    s_lshr_b32 s89, 0x8530, s88
    s_and_b32 s89, s89, 15
    s_add_u32 s92, s92, s89
    s_cmp_ge_u32 s92, 10
    s_cselect_b32 s88, 10, 0
    s_sub_u32 s92, s92, s88
    s_waitcnt lgkmcnt(0)
    s_mov_b32 s8, s36
    s_and_b32 s9, s37, 0xffff
    s_mov_b32 s10, 0x280000
    s_mov_b32 s11, 0x00020000
    s_mov_b32 s12, s38
    s_and_b32 s13, s39, 0xffff
    s_mov_b32 s14, 0x258000
    s_mov_b32 s15, 0x00020000
    s_add_u32 s95, s92, 0
    s_lshl_b32 s93, s95, 7
    s_mul_i32 s94, s95, 245760
    s_add_u32 m0, s91, 16384
    s_nop 0
    buffer_load_dwordx4 v6, s[12:15], s94 offen  lds
    s_add_u32 m0, s91, 0
    s_nop 0
    buffer_load_dwordx4 v2, s[8:11], s93 offen  lds
    s_add_u32 m0, s91, 17408
    s_add_u32 s94, s94, 15360
    buffer_load_dwordx4 v6, s[12:15], s94 offen  lds
    s_add_u32 m0, s91, 1024
    s_nop 0
    buffer_load_dwordx4 v3, s[8:11], s93 offen  lds
    s_add_u32 m0, s91, 18432
    s_add_u32 s94, s94, 15360
    buffer_load_dwordx4 v6, s[12:15], s94 offen  lds
    s_add_u32 m0, s91, 2048
    s_add_u32 s93, s93, 20480
    buffer_load_dwordx4 v2, s[8:11], s93 offen  lds
    s_add_u32 m0, s91, 19456
    s_add_u32 s94, s94, 15360
    buffer_load_dwordx4 v6, s[12:15], s94 offen  lds
    s_add_u32 m0, s91, 3072
    s_nop 0
    buffer_load_dwordx4 v3, s[8:11], s93 offen  lds
    s_add_u32 s92, s92, 1
    s_cmp_eq_u32 s92, 10
    s_cselect_b32 s92, 0, s92
    s_mov_b32 s16, s60
    s_and_b32 s17, s61, 0xffff
    s_mov_b32 s18, 0x1000000
    s_mov_b32 s19, 0x00020000
    s_mov_b32 s20, s42
    s_and_b32 s21, s43, 0xffff
    s_mov_b32 s22, 0x280000
    s_mov_b32 s23, 0x00020000
    s_mul_i32 s38, s4, 20
    s_add_u32 s38, s38, s5
    s_lshr_b32 s39, s38, 4
    s_and_b32 s40, s38, 15
    s_lshl_b32 s41, s40, 2
    s_add_u32 s41, s41, s90
    v_lshrrev_b32 v13, 4, v0
    v_and_b32 v14, 15, v0
    v_mul_u32_u24 v11, 1280, v13
    v_lshl_add_u32 v11, v14, 3, v11
    v_lshlrev_b32 v12, 6, v14
    v_lshl_add_u32 v12, v13, 4, v12
    s_mul_i32 s43, s41, 40960
    s_lshl_b32 s88, s39, 7
    s_add_u32 s43, s43, s88
    s_lshl_b32 s56, s39, 6
    s_add_u32 s56, s56, s41
    s_mul_i32 s56, s56, 4352
    s_add_u32 s56, s56, 11534336
    s_cmp_lt_u32 s5, 20
    s_cselect_b32 s43, s43, 0x7ff00000
    s_cselect_b32 s56, s56, 0x7ff00000
    s_mov_b32 s57, 0x05040100
    s_mov_b32 s58, 0x07060302
    buffer_load_dwordx2 v[46:47], v11, s[20:23], s43 offen nt
    s_add_u32 s43, s43, 5120
    buffer_load_dwordx2 v[44:45], v11, s[20:23], s43 offen nt
    s_add_u32 s43, s43, 5120
    buffer_load_dwordx2 v[42:43], v11, s[20:23], s43 offen nt
    s_add_u32 s43, s43, 5120
    buffer_load_dwordx2 v[40:41], v11, s[20:23], s43 offen nt
    s_add_u32 s43, s43, 5120
    buffer_load_dwordx2 v[38:39], v11, s[20:23], s43 offen nt
    s_add_u32 s43, s43, 5120
    buffer_load_dwordx2 v[36:37], v11, s[20:23], s43 offen nt
    s_add_u32 s43, s43, 5120
    buffer_load_dwordx2 v[34:35], v11, s[20:23], s43 offen nt
    s_add_u32 s43, s43, 5120
    buffer_load_dwordx2 v[32:33], v11, s[20:23], s43 offen nt
    s_add_u32 s43, s43, 5120
    s_add_u32 s95, s92, 0
    s_lshl_b32 s93, s95, 7
    s_mul_i32 s94, s95, 245760
    s_add_u32 m0, s91, 49152
    s_nop 0
    buffer_load_dwordx4 v6, s[12:15], s94 offen  lds
    s_add_u32 m0, s91, 32768
    s_nop 0
    buffer_load_dwordx4 v2, s[8:11], s93 offen  lds
    s_add_u32 m0, s91, 50176
    s_add_u32 s94, s94, 15360
    buffer_load_dwordx4 v6, s[12:15], s94 offen  lds
    s_add_u32 m0, s91, 33792
    s_nop 0
    buffer_load_dwordx4 v3, s[8:11], s93 offen  lds
    s_add_u32 m0, s91, 51200
    s_add_u32 s94, s94, 15360
    buffer_load_dwordx4 v6, s[12:15], s94 offen  lds
    s_add_u32 m0, s91, 34816
    s_add_u32 s93, s93, 20480
    buffer_load_dwordx4 v2, s[8:11], s93 offen  lds
    s_add_u32 m0, s91, 52224
    s_add_u32 s94, s94, 15360
    buffer_load_dwordx4 v6, s[12:15], s94 offen  lds
    s_add_u32 m0, s91, 35840
    s_nop 0
    buffer_load_dwordx4 v3, s[8:11], s93 offen  lds
    s_add_u32 s92, s92, 1
    s_cmp_eq_u32 s92, 10
    s_cselect_b32 s92, 0, s92
    s_waitcnt vmcnt(16)
    s_barrier
    s_add_u32 s95, s92, 0
    s_lshl_b32 s93, s95, 7
    s_mul_i32 s94, s95, 245760
    s_add_u32 m0, s91, 81920
    s_nop 0
    buffer_load_dwordx4 v6, s[12:15], s94 offen  lds
    s_add_u32 m0, s91, 65536
    s_nop 0
    buffer_load_dwordx4 v2, s[8:11], s93 offen  lds
    s_add_u32 m0, s91, 82944
    s_add_u32 s94, s94, 15360
    buffer_load_dwordx4 v6, s[12:15], s94 offen  lds
    s_add_u32 m0, s91, 66560
    s_nop 0
    buffer_load_dwordx4 v3, s[8:11], s93 offen  lds
    s_add_u32 m0, s91, 83968
    s_add_u32 s94, s94, 15360
    buffer_load_dwordx4 v6, s[12:15], s94 offen  lds
    s_add_u32 m0, s91, 67584
    s_add_u32 s93, s93, 20480
    buffer_load_dwordx4 v2, s[8:11], s93 offen  lds
    s_add_u32 m0, s91, 84992
    s_add_u32 s94, s94, 15360
    buffer_load_dwordx4 v6, s[12:15], s94 offen  lds
    s_add_u32 m0, s91, 68608
    s_nop 0
    buffer_load_dwordx4 v3, s[8:11], s93 offen  lds
    s_add_u32 s92, s92, 1
    s_cmp_eq_u32 s92, 10
    s_cselect_b32 s92, 0, s92
    s_waitcnt vmcnt(8)
    s_barrier
    s_add_u32 s95, s92, 0
    s_lshl_b32 s93, s95, 7
    s_mul_i32 s94, s95, 245760
    s_add_u32 m0, s91, 16384
    s_nop 0
    buffer_load_dwordx4 v6, s[12:15], s94 offen  lds
    s_add_u32 m0, s91, 0
    s_nop 0
    buffer_load_dwordx4 v2, s[8:11], s93 offen  lds
    s_add_u32 m0, s91, 17408
    s_add_u32 s94, s94, 15360
    buffer_load_dwordx4 v6, s[12:15], s94 offen  lds
    s_add_u32 m0, s91, 1024
    s_nop 0
    buffer_load_dwordx4 v3, s[8:11], s93 offen  lds
    s_add_u32 m0, s91, 18432
    s_add_u32 s94, s94, 15360
    buffer_load_dwordx4 v6, s[12:15], s94 offen  lds
    s_add_u32 m0, s91, 2048
    s_add_u32 s93, s93, 20480
    buffer_load_dwordx4 v2, s[8:11], s93 offen  lds
    s_add_u32 m0, s91, 19456
    s_add_u32 s94, s94, 15360
    buffer_load_dwordx4 v6, s[12:15], s94 offen  lds
    s_add_u32 m0, s91, 3072
    s_nop 0
    buffer_load_dwordx4 v3, s[8:11], s93 offen  lds
    s_add_u32 s92, s92, 1
    s_cmp_eq_u32 s92, 10
    s_cselect_b32 s92, 0, s92
    v_perm_b32 v48, v34, v32, s57
    v_perm_b32 v49, v38, v36, s57
    v_perm_b32 v50, v42, v40, s57
    v_perm_b32 v51, v46, v44, s57
    buffer_store_dwordx4 v[48:51], v12, s[16:19], s56 offen offset:0 sc1
    v_perm_b32 v52, v34, v32, s58
    v_perm_b32 v53, v38, v36, s58
    v_perm_b32 v54, v42, v40, s58
    v_perm_b32 v55, v46, v44, s58
    buffer_store_dwordx4 v[52:55], v12, s[16:19], s56 offen offset:1024 sc1
    v_perm_b32 v56, v35, v33, s57
    v_perm_b32 v57, v39, v37, s57
    v_perm_b32 v58, v43, v41, s57
    v_perm_b32 v59, v47, v45, s57
    buffer_store_dwordx4 v[56:59], v12, s[16:19], s56 offen offset:2048 sc1
    v_perm_b32 v60, v35, v33, s58
    v_perm_b32 v61, v39, v37, s58
    v_perm_b32 v62, v43, v41, s58
    v_perm_b32 v63, v47, v45, s58
    buffer_store_dwordx4 v[60:63], v12, s[16:19], s56 offen offset:3072 sc1
    s_waitcnt vmcnt(12)
    s_barrier
    s_add_u32 s95, s92, 0
    s_lshl_b32 s93, s95, 7
    s_mul_i32 s94, s95, 245760
    s_add_u32 m0, s91, 49152
    s_nop 0
    buffer_load_dwordx4 v6, s[12:15], s94 offen  lds
    s_add_u32 m0, s91, 32768
    s_nop 0
    buffer_load_dwordx4 v2, s[8:11], s93 offen  lds
    s_add_u32 m0, s91, 50176
    s_add_u32 s94, s94, 15360
    buffer_load_dwordx4 v6, s[12:15], s94 offen  lds
    s_add_u32 m0, s91, 33792
    s_nop 0
    buffer_load_dwordx4 v3, s[8:11], s93 offen  lds
    s_add_u32 m0, s91, 51200
    s_add_u32 s94, s94, 15360
    buffer_load_dwordx4 v6, s[12:15], s94 offen  lds
    s_add_u32 m0, s91, 34816
    s_add_u32 s93, s93, 20480
    buffer_load_dwordx4 v2, s[8:11], s93 offen  lds
    s_add_u32 m0, s91, 52224
    s_add_u32 s94, s94, 15360
    buffer_load_dwordx4 v6, s[12:15], s94 offen  lds
    s_add_u32 m0, s91, 35840
    s_nop 0
    buffer_load_dwordx4 v3, s[8:11], s93 offen  lds
    s_add_u32 s92, s92, 1
    s_cmp_eq_u32 s92, 10
    s_cselect_b32 s92, 0, s92
    s_waitcnt vmcnt(12)
    s_barrier
    s_add_u32 s95, s92, 0
    s_lshl_b32 s93, s95, 7
    s_mul_i32 s94, s95, 245760
    s_add_u32 m0, s91, 81920
    s_nop 0
    buffer_load_dwordx4 v6, s[12:15], s94 offen  lds
    s_add_u32 m0, s91, 65536
    s_nop 0
    buffer_load_dwordx4 v2, s[8:11], s93 offen  lds
    s_add_u32 m0, s91, 82944
    s_add_u32 s94, s94, 15360
    buffer_load_dwordx4 v6, s[12:15], s94 offen  lds
    s_add_u32 m0, s91, 66560
    s_nop 0
    buffer_load_dwordx4 v3, s[8:11], s93 offen  lds
    s_add_u32 m0, s91, 83968
    s_add_u32 s94, s94, 15360
    buffer_load_dwordx4 v6, s[12:15], s94 offen  lds
    s_add_u32 m0, s91, 67584
    s_add_u32 s93, s93, 20480
    buffer_load_dwordx4 v2, s[8:11], s93 offen  lds
    s_add_u32 m0, s91, 84992
    s_add_u32 s94, s94, 15360
    buffer_load_dwordx4 v6, s[12:15], s94 offen  lds
    s_add_u32 m0, s91, 68608
    s_nop 0
    buffer_load_dwordx4 v3, s[8:11], s93 offen  lds
    s_add_u32 s92, s92, 1
    s_cmp_eq_u32 s92, 10
    s_cselect_b32 s92, 0, s92
    s_waitcnt vmcnt(8)
    s_barrier
    s_add_u32 s95, s92, 0
    s_lshl_b32 s93, s95, 7
    s_mul_i32 s94, s95, 245760
    s_add_u32 m0, s91, 16384
    s_nop 0
    buffer_load_dwordx4 v6, s[12:15], s94 offen  lds
    s_add_u32 m0, s91, 0
    s_nop 0
    buffer_load_dwordx4 v2, s[8:11], s93 offen  lds
    s_add_u32 m0, s91, 17408
    s_add_u32 s94, s94, 15360
    buffer_load_dwordx4 v6, s[12:15], s94 offen  lds
    s_add_u32 m0, s91, 1024
    s_nop 0
    buffer_load_dwordx4 v3, s[8:11], s93 offen  lds
    s_add_u32 m0, s91, 18432
    s_add_u32 s94, s94, 15360
    buffer_load_dwordx4 v6, s[12:15], s94 offen  lds
    s_add_u32 m0, s91, 2048
    s_add_u32 s93, s93, 20480
    buffer_load_dwordx4 v2, s[8:11], s93 offen  lds
    s_add_u32 m0, s91, 19456
    s_add_u32 s94, s94, 15360
    buffer_load_dwordx4 v6, s[12:15], s94 offen  lds
    s_add_u32 m0, s91, 3072
    s_nop 0
    buffer_load_dwordx4 v3, s[8:11], s93 offen  lds
    s_add_u32 s92, s92, 1
    s_cmp_eq_u32 s92, 10
    s_cselect_b32 s92, 0, s92
    s_waitcnt vmcnt(8)
    s_barrier
    s_add_u32 s95, s92, 0
    s_lshl_b32 s93, s95, 7
    s_mul_i32 s94, s95, 245760
    s_add_u32 m0, s91, 49152
    s_nop 0
    buffer_load_dwordx4 v6, s[12:15], s94 offen  lds
    s_add_u32 m0, s91, 32768
    s_nop 0
    buffer_load_dwordx4 v2, s[8:11], s93 offen  lds
    s_add_u32 m0, s91, 50176
    s_add_u32 s94, s94, 15360
    buffer_load_dwordx4 v6, s[12:15], s94 offen  lds
    s_add_u32 m0, s91, 33792
    s_nop 0
    buffer_load_dwordx4 v3, s[8:11], s93 offen  lds
    s_add_u32 m0, s91, 51200
    s_add_u32 s94, s94, 15360
    buffer_load_dwordx4 v6, s[12:15], s94 offen  lds
    s_add_u32 m0, s91, 34816
    s_add_u32 s93, s93, 20480
    buffer_load_dwordx4 v2, s[8:11], s93 offen  lds
    s_add_u32 m0, s91, 52224
    s_add_u32 s94, s94, 15360
    buffer_load_dwordx4 v6, s[12:15], s94 offen  lds
    s_add_u32 m0, s91, 35840
    s_nop 0
    buffer_load_dwordx4 v3, s[8:11], s93 offen  lds
    s_add_u32 s92, s92, 1
    s_cmp_eq_u32 s92, 10
    s_cselect_b32 s92, 0, s92
    s_waitcnt vmcnt(8)
    s_barrier
    s_add_u32 s95, s92, 0
    s_lshl_b32 s93, s95, 7
    s_mul_i32 s94, s95, 245760
    s_add_u32 m0, s91, 81920
    s_nop 0
    buffer_load_dwordx4 v6, s[12:15], s94 offen  lds
    s_add_u32 m0, s91, 65536
    s_nop 0
    buffer_load_dwordx4 v2, s[8:11], s93 offen  lds
    s_add_u32 m0, s91, 82944
    s_add_u32 s94, s94, 15360
    buffer_load_dwordx4 v6, s[12:15], s94 offen  lds
    s_add_u32 m0, s91, 66560
    s_nop 0
    buffer_load_dwordx4 v3, s[8:11], s93 offen  lds
    s_add_u32 m0, s91, 83968
    s_add_u32 s94, s94, 15360
    buffer_load_dwordx4 v6, s[12:15], s94 offen  lds
    s_add_u32 m0, s91, 67584
    s_add_u32 s93, s93, 20480
    buffer_load_dwordx4 v2, s[8:11], s93 offen  lds
    s_add_u32 m0, s91, 84992
    s_add_u32 s94, s94, 15360
    buffer_load_dwordx4 v6, s[12:15], s94 offen  lds
    s_add_u32 m0, s91, 68608
    s_nop 0
    buffer_load_dwordx4 v3, s[8:11], s93 offen  lds
    s_add_u32 s92, s92, 1
    s_cmp_eq_u32 s92, 10
    s_cselect_b32 s92, 0, s92
    s_waitcnt vmcnt(8)
    s_barrier
    s_add_u32 s95, s92, 0
    s_lshl_b32 s93, s95, 7
    s_mul_i32 s94, s95, 245760
    s_add_u32 m0, s91, 16384
    s_nop 0
    buffer_load_dwordx4 v6, s[12:15], s94 offen  lds
    s_add_u32 m0, s91, 0
    s_nop 0
    buffer_load_dwordx4 v2, s[8:11], s93 offen  lds
    s_add_u32 m0, s91, 17408
    s_add_u32 s94, s94, 15360
    buffer_load_dwordx4 v6, s[12:15], s94 offen  lds
    s_add_u32 m0, s91, 1024
    s_nop 0
    buffer_load_dwordx4 v3, s[8:11], s93 offen  lds
    s_add_u32 m0, s91, 18432
    s_add_u32 s94, s94, 15360
    buffer_load_dwordx4 v6, s[12:15], s94 offen  lds
    s_add_u32 m0, s91, 2048
    s_add_u32 s93, s93, 20480
    buffer_load_dwordx4 v2, s[8:11], s93 offen  lds
    s_add_u32 m0, s91, 19456
    s_add_u32 s94, s94, 15360
    buffer_load_dwordx4 v6, s[12:15], s94 offen  lds
    s_add_u32 m0, s91, 3072
    s_nop 0
    buffer_load_dwordx4 v3, s[8:11], s93 offen  lds
    s_add_u32 s92, s92, 1
    s_cmp_eq_u32 s92, 10
    s_cselect_b32 s92, 0, s92
    s_waitcnt vmcnt(8)
    s_barrier
    s_waitcnt vmcnt(0)
    s_barrier
L_LD2:
L_ATT:
    s_lshl_b32 s36, s4, 2
    s_and_b32 s37, s5, 3
    s_add_u32 s36, s36, s37
    s_lshr_b32 s37, s5, 2
    s_lshr_b32 s38, s3, 2
    s_and_b32 s39, s3, 3
    v_lshlrev_b32 v1, 3, v0
    v_and_b32 v7, 31, v0
    v_lshlrev_b32 v2, 3, v7
    v_lshrrev_b32 v8, 5, v0
    v_mul_u32_u24 v8, 320, v8
    v_lshl_add_u32 v3, v7, 4, v8
    v_lshlrev_b32 v4, 4, v0
    v_mov_b32 v5, 114432
    v_mov_b32 v6, 1
    v_lshlrev_b32 v112, 2, v0
    v_mov_b32 v113, 0
    s_mov_b32 s40, 0x000fffff
    s_mov_b32 s41, 0x000fffff
    s_mov_b32 s42, 0
    s_mov_b32 s43, 24
    v_and_b32 v8, 27, v7
    v_cmp_eq_u32 vcc, 24, v8
    v_mov_b32 v8, 0x3f803f80
    s_mul_i32 s59, s36, 163840
    s_add_u32 s59, s59, 2621440
    v_cndmask_b32 v32, 0, v8, vcc
    v_cndmask_b32 v36, 0, v8, vcc
    v_cndmask_b32 v33, 0, v8, vcc
    v_cndmask_b32 v37, 0, v8, vcc
    v_cndmask_b32 v34, 0, v8, vcc
    v_cndmask_b32 v38, 0, v8, vcc
    v_cndmask_b32 v35, 0, v8, vcc
    v_cndmask_b32 v39, 0, v8, vcc
    v_mov_b32 v80, 0
    v_mov_b32 v96, 0
    v_mov_b32 v81, 0
    v_mov_b32 v97, 0
    v_mov_b32 v82, 0
    v_mov_b32 v98, 0
    v_mov_b32 v83, 0
    v_mov_b32 v99, 0
    v_mov_b32 v84, 0
    v_mov_b32 v100, 0
    v_mov_b32 v85, 0
    v_mov_b32 v101, 0
    v_mov_b32 v86, 0
    v_mov_b32 v102, 0
    v_mov_b32 v87, 0
    v_mov_b32 v103, 0
    v_mov_b32 v88, 0
    v_mov_b32 v104, 0
    v_mov_b32 v89, 0
    v_mov_b32 v105, 0
    v_mov_b32 v90, 0
    v_mov_b32 v106, 0
    v_mov_b32 v91, 0
    v_mov_b32 v107, 0
    v_mov_b32 v92, 0
    v_mov_b32 v108, 0
    v_mov_b32 v93, 0
    v_mov_b32 v109, 0
    v_mov_b32 v94, 0
    v_mov_b32 v110, 0
    v_mov_b32 v95, 0
    v_mov_b32 v111, 0
    v_mov_b32 v44, 0
    v_mov_b32 v45, 0
    v_mov_b32 v46, 0
    v_mov_b32 v47, 0
    v_mov_b32 v28, 0x3f80
    v_mov_b32 v29, 0
    v_mov_b32 v20, 0
    v_mov_b32 v21, 0
    v_mov_b32 v22, 0
    v_mov_b32 v23, 0
    s_mov_b32 s98, -1
    s_mov_b32 s99, 0
    s_lshl_b32 s56, s36, 6
    s_lshl_b32 s57, s37, 3
    s_add_u32 s56, s56, s57
    s_lshl_b32 s57, s39, 1
    s_add_u32 s56, s56, s57
    s_mul_i32 s56, s56, 1280
    s_mul_i32 s88, s38, 1280
    s_add_u32 s97, s56, s88
    s_sub_u32 s56, s56, s88
    s_add_u32 s56, s56, 1280
    s_lshl_b32 s88, s3, 12
    s_add_u32 s88, s88, 103424
    v_add_u32 v119, s88, v4
    s_xor_b32 s88, s3, 4
    s_lshl_b32 s88, s88, 12
    s_add_u32 s88, s88, 103424
    v_add_u32 v120, s88, v4
    s_lshl_b32 s88, s3, 2
    s_add_u32 s88, s88, 64
    v_mov_b32 v121, s88
    v_xor_b32 v122, 16, v121
    s_lshl_b32 s96, s37, 3
    s_lshl_b32 s88, s39, 1
    s_add_u32 s96, s96, s88
    s_add_u32 s96, s96, s38
    s_lshr_b32 s88, s96, 1
    s_lshl_b32 s88, s88, 10
    s_lshl_b32 s89, s38, 4
    s_add_u32 s88, s88, s89
    s_lshr_b32 s89, s36, 3
    s_lshl_b32 s89, s89, 2
    s_add_u32 s88, s88, s89
    s_add_u32 s88, s88, 10489888
    v_lshl_add_u32 v123, v0, 7, s88
    v_lshlrev_b32 v124, 3, v0
    s_lshl_b32 s96, s96, 5
    s_add_u32 s96, s96, s36
    s_mul_i32 s96, s96, 1280
    s_add_u32 s96, s96, 7864320
    s_lshl_b32 s60, s3, 10
    s_add_u32 s61, s59, s60
    s_cmp_lg_u32 s3, 4
    s_cbranch_scc1 L_A_W
    s_mul_i32 s88, s36, 20
    s_add_u32 s89, s88, 19
    s_lshr_b32 s88, s88, 7
    s_lshr_b32 s89, s89, 7
    s_cmp_eq_u32 s88, s89
    s_cselect_b32 s58, 32, 64
    s_lshr_b32 s57, s58, 4
    s_lshl_b32 s88, s36, 3
    s_add_u32 s88, s88, s37
    s_lshl_b32 s88, s88, 7
    s_add_u32 s88, s88, 10489856
    v_mov_b32 v9, s88
    s_mov_b32 s63, 0
    s_branch L_CGO_R
L_CGO:
    v_readfirstlane_b32 s88, v7
    s_cmp_ge_u32 s88, 1
    s_cbranch_scc1 L_CGO_X
    s_add_u32 s63, s63, 1
    s_cmp_gt_u32 s63, 200000
    s_cbranch_scc1 L_CGO_X
    s_sleep 1
L_CGO_R:
    ds_read_b32 v7, v5 offset:36
    s_waitcnt lgkmcnt(0)
    s_branch L_CGO
L_CGO_X:
    v_add_u32 v8, 4, v9
    s_mov_b64 exec, 1
    s_mov_b32 s62, 0
L_SQP:
    v_mov_b32 v10, 0
    buffer_atomic_add v10, v8, s[16:19], 0 offen sc0 sc1
    s_add_u32 s62, s62, 1
    s_waitcnt vmcnt(0)
    v_cmp_ne_u32 vcc, s57, v10
    s_cmp_gt_u32 s62, 20000
    s_cbranch_scc1 L_SQP_X
    s_cbranch_vccz L_SQP_X
    s_sleep 4
    s_branch L_SQP
L_SQP_X:
    s_mov_b64 exec, -1
    ds_write_b32 v5, v6 offset:40
    buffer_load_dwordx2 v[12:13], v1, s[16:19], s56 offen offset:0 sc1
    buffer_load_dwordx2 v[14:15], v1, s[16:19], s56 offen offset:512 sc1
    s_mov_b64 exec, s[98:99]
    buffer_load_dwordx2 v[20:21], v2, s[16:19], s56 offen offset:1024 sc1
    s_mov_b64 exec, -1
    buffer_load_dwordx2 v[16:17], v1, s[16:19], s97 offen offset:0 sc1
    buffer_load_dwordx2 v[18:19], v1, s[16:19], s97 offen offset:512 sc1
    s_mov_b64 exec, s[98:99]
    buffer_load_dwordx2 v[22:23], v2, s[16:19], s97 offen offset:1024 sc1
    s_mov_b64 exec, -1
    s_mov_b32 s63, 0
    s_branch L_CNTP_R
L_CNTP:
    v_readfirstlane_b32 s88, v7
    s_cmp_ge_u32 s88, 4
    s_cbranch_scc1 L_CNTP_X
    s_add_u32 s63, s63, 1
    s_cmp_gt_u32 s63, 200000
    s_cbranch_scc1 L_CNTP_X
    s_sleep 1
L_CNTP_R:
    ds_read_b32 v7, v5 offset:0
    s_waitcnt lgkmcnt(0)
    s_branch L_CNTP
L_CNTP_X:
    s_mov_b64 exec, 1
    s_mov_b32 s62, 0
L_S1P:
    v_mov_b32 v10, 0
    buffer_atomic_add v10, v9, s[16:19], 0 offen sc0 sc1
    s_add_u32 s62, s62, 1
    s_waitcnt vmcnt(0)
    v_cmp_ne_u32 vcc, s58, v10
    s_cmp_gt_u32 s62, 20000
    s_cbranch_scc1 L_S1P_X
    s_cbranch_vccz L_S1P_X
    s_sleep 1
    s_branch L_S1P
L_S1P_X:
    s_mov_b64 exec, -1
    ds_write_b32 v5, v6 offset:16
    s_branch L_A_S1_X
L_A_W:
    s_mov_b32 s63, 0
    s_branch L_A_SQ_R
L_A_SQ:
    v_readfirstlane_b32 s88, v7
    s_cmp_ge_u32 s88, 1
    s_cbranch_scc1 L_A_SQ_X
    s_add_u32 s63, s63, 1
    s_cmp_gt_u32 s63, 200000
    s_cbranch_scc1 L_A_SQ_X
    s_sleep 2
L_A_SQ_R:
    ds_read_b32 v7, v5 offset:40
    s_waitcnt lgkmcnt(0)
    s_branch L_A_SQ
L_A_SQ_X:
    buffer_load_dwordx2 v[12:13], v1, s[16:19], s56 offen offset:0 sc1
    buffer_load_dwordx2 v[14:15], v1, s[16:19], s56 offen offset:512 sc1
    s_mov_b64 exec, s[98:99]
    buffer_load_dwordx2 v[20:21], v2, s[16:19], s56 offen offset:1024 sc1
    s_mov_b64 exec, -1
    buffer_load_dwordx2 v[16:17], v1, s[16:19], s97 offen offset:0 sc1
    buffer_load_dwordx2 v[18:19], v1, s[16:19], s97 offen offset:512 sc1
    s_mov_b64 exec, s[98:99]
    buffer_load_dwordx2 v[22:23], v2, s[16:19], s97 offen offset:1024 sc1
    s_mov_b64 exec, -1
    s_mov_b32 s63, 0
    s_branch L_A_S1_R
L_A_S1:
    v_readfirstlane_b32 s88, v7
    s_cmp_ge_u32 s88, 1
    s_cbranch_scc1 L_A_S1_X
    s_add_u32 s63, s63, 1
    s_cmp_gt_u32 s63, 200000
    s_cbranch_scc1 L_A_S1_X
    s_sleep 1
L_A_S1_R:
    ds_read_b32 v7, v5 offset:16
    s_waitcnt lgkmcnt(0)
    s_branch L_A_S1
L_A_S1_X:
    buffer_load_dwordx2 v[24:25], v1, s[16:19], s59 offen offset:0 sc1
    buffer_load_dwordx2 v[26:27], v1, s[16:19], s59 offen offset:512 sc1
    s_mov_b64 exec, s[98:99]
    buffer_load_dwordx2 v[28:29], v2, s[16:19], s59 offen offset:1024 sc1
    s_mov_b64 exec, -1
    s_mov_b32 m0, s60
    s_add_u32 s60, s60, 8192
    buffer_load_dwordx4 v4, s[16:19], s61 offen sc1 lds
    s_add_u32 s61, s61, 8192
    s_mov_b32 m0, s60
    s_add_u32 s60, s60, 8192
    buffer_load_dwordx4 v4, s[16:19], s61 offen sc1 lds
    s_add_u32 s61, s61, 8192
    s_mov_b32 m0, s60
    s_add_u32 s60, s60, 8192
    buffer_load_dwordx4 v4, s[16:19], s61 offen sc1 lds
    s_add_u32 s61, s61, 8192
    s_mov_b32 m0, s60
    s_add_u32 s60, s60, 8192
    buffer_load_dwordx4 v4, s[16:19], s61 offen sc1 lds
    s_add_u32 s61, s61, 8192
    v_cmp_gt_u32 vcc, 32, v0
    s_mul_i32 s56, s38, 2560
    v_add_u32 v1, s56, v1
    v_add_u32 v2, s56, v2
    v_add_u32 v3, s56, v3
    v_add_u32 v114, 122880, v1
    v_add_u32 v115, 61440, v2
    v_add_u32 v117, 61440, v3
    v_add_u32 v116, 122880, v2
    v_add_u32 v118, 122880, v3
    s_waitcnt vmcnt(4)
    v_mfma_f32_32x32x16_bf16 v[48:63], v[24:27], v[12:15], 0
    v_mfma_f32_32x32x16_bf16 v[64:79], v[24:27], v[16:19], 0
    v_mfma_f32_32x32x8_bf16 v[48:63], v[28:29], v[20:21], v[48:63]
    v_mfma_f32_32x32x8_bf16 v[64:79], v[28:29], v[22:23], v[64:79]
    s_waitcnt vmcnt(2)
    s_mov_b64 exec, 1
    ds_add_u32 v5, v6 offset:20
    s_mov_b64 exec, -1
    s_nop 6
    v_max3_f32 v7, v48, v49, v50
    s_nop 0
    v_max3_f32 v7, v7, v51, v52
    v_max3_f32 v8, v64, v65, v66
    v_max3_f32 v7, v7, v53, v54
    v_max3_f32 v8, v8, v67, v68
    v_max3_f32 v7, v7, v55, v56
    v_max3_f32 v8, v8, v69, v70
    v_max3_f32 v7, v7, v57, v58
    v_max3_f32 v8, v8, v71, v72
    v_max3_f32 v7, v7, v59, v60
    v_max3_f32 v8, v8, v73, v74
    v_max3_f32 v7, v7, v61, v62
    v_max3_f32 v8, v8, v75, v76
    v_max_f32 v7, v7, v63
    v_max3_f32 v8, v8, v77, v78
    v_max_f32 v8, v8, v79
    v_mov_b32 v9, v7
    v_mov_b32 v10, v8
    s_nop 1
    v_permlane32_swap_b32 v7, v9
    v_permlane32_swap_b32 v8, v10
    s_nop 1
    v_max_f32 v7, v7, v9
    v_max_f32 v8, v8, v10
    v_cvt_pk_bf16_f32 v7, -v7, 0
    v_cvt_pk_bf16_f32 v8, -v8, 0
    v_cndmask_b32 v20, v7, v20, vcc
    v_cndmask_b32 v22, v8, v22, vcc
    s_mov_b32 s63, 0
L_A_WA:
    ds_read_b32 v9, v5 offset:20
    s_add_u32 s63, s63, 1
    s_waitcnt lgkmcnt(0)
    v_readfirstlane_b32 s88, v9
    s_cmp_gt_u32 s63, 200000
    s_cselect_b32 s88, 8, s88
    s_cmp_ge_u32 s88, 8
    s_cbranch_scc0 L_A_WA
    ds_read2st64_b64 v[24:27], v1 offset0:0 offset1:1
    s_mov_b64 exec, s[98:99]
    ds_read_b64 v[28:29], v2 offset:1024
    s_mov_b64 exec, s[40:41]
    ds_read_b128 v[32:35], v3 offset:1280
    s_mov_b64 exec, -1
    s_waitcnt lgkmcnt(1)
    v_mfma_f32_32x32x16_bf16 v[48:63], v[24:27], v[12:15], 0
    v_mfma_f32_32x32x8_bf16 v[48:63], v[28:29], v[20:21], v[48:63]
    s_nop 8
    s_setprio 0
    v_mfma_f32_32x32x16_bf16 v[64:79], v[24:27], v[16:19], 0
    s_mov_b32 m0, s60
    s_add_u32 s60, s60, 8192
    buffer_load_dwordx4 v4, s[16:19], s61 offen sc1 lds
    s_add_u32 s61, s61, 8192
    ds_read2st64_b64 v[24:27], v1 offset0:10 offset1:11
    v_exp_f32 v48, v48
    v_exp_f32 v49, v49
    v_exp_f32 v50, v50
    v_cvt_pk_bf16_f32 v40, v48, v49
    v_exp_f32 v51, v51
    v_mfma_f32_32x32x16_bf16 v[96:111], v[36:39], v[44:47], v[96:111]
    v_exp_f32 v52, v52
    v_cvt_pk_bf16_f32 v41, v50, v51
    v_exp_f32 v53, v53
    v_exp_f32 v54, v54
    v_cvt_pk_bf16_f32 v42, v52, v53
    v_mfma_f32_32x32x8_bf16 v[64:79], v[28:29], v[22:23], v[64:79]
    s_mov_b64 exec, s[40:41]
    ds_read_b128 v[36:39], v3 offset:1920
    s_mov_b64 exec, s[98:99]
    ds_read_b64 v[28:29], v2 offset:6144
    s_mov_b64 exec, -1
    v_exp_f32 v55, v55
    v_exp_f32 v56, v56
    v_cvt_pk_bf16_f32 v43, v54, v55
    v_exp_f32 v57, v57
    v_exp_f32 v58, v58
    v_cvt_pk_bf16_f32 v44, v56, v57
    s_waitcnt lgkmcnt(3)
    v_mfma_f32_32x32x16_bf16 v[80:95], v[32:35], v[40:43], v[80:95]
    s_mov_b32 m0, s60
    s_add_u32 s60, s60, 8192
    buffer_load_dwordx4 v4, s[16:19], s61 offen sc1 lds
    s_add_u32 s61, s61, 8192
    v_exp_f32 v59, v59
    v_exp_f32 v60, v60
    v_cvt_pk_bf16_f32 v45, v58, v59
    v_exp_f32 v61, v61
    v_exp_f32 v62, v62
    v_exp_f32 v63, v63
    v_cvt_pk_bf16_f32 v46, v60, v61
    v_cvt_pk_bf16_f32 v47, v62, v63
    s_waitcnt lgkmcnt(2)
    v_mfma_f32_32x32x16_bf16 v[48:63], v[24:27], v[12:15], 0
    s_mov_b32 m0, s60
    s_add_u32 s60, s60, 8192
    buffer_load_dwordx4 v4, s[16:19], s61 offen sc1 lds
    s_add_u32 s61, s61, 8192
    v_exp_f32 v64, v64
    v_exp_f32 v65, v65
    v_exp_f32 v66, v66
    v_cvt_pk_bf16_f32 v40, v64, v65
    v_exp_f32 v67, v67
    s_waitcnt lgkmcnt(0)
    v_mfma_f32_32x32x16_bf16 v[80:95], v[36:39], v[44:47], v[80:95]
    v_exp_f32 v68, v68
    v_cvt_pk_bf16_f32 v41, v66, v67
    v_exp_f32 v69, v69
    v_exp_f32 v70, v70
    v_cvt_pk_bf16_f32 v42, v68, v69
    v_mfma_f32_32x32x8_bf16 v[48:63], v[28:29], v[20:21], v[48:63]
    s_waitcnt vmcnt(3)
    s_mov_b64 exec, 1
    ds_add_u32 v5, v6 offset:24
    s_mov_b64 exec, -1
    v_exp_f32 v71, v71
    v_exp_f32 v72, v72
    v_cvt_pk_bf16_f32 v43, v70, v71
    v_exp_f32 v73, v73
    v_exp_f32 v74, v74
    v_cvt_pk_bf16_f32 v44, v72, v73
    v_mfma_f32_32x32x16_bf16 v[96:111], v[32:35], v[40:43], v[96:111]
    s_mov_b64 exec, s[40:41]
    ds_read_b128 v[32:35], v3 offset:6400
    s_mov_b64 exec, -1
    v_exp_f32 v75, v75
    v_exp_f32 v76, v76
    v_cvt_pk_bf16_f32 v45, v74, v75
    v_exp_f32 v77, v77
    v_exp_f32 v78, v78
    v_exp_f32 v79, v79
    v_cvt_pk_bf16_f32 v46, v76, v77
    v_cvt_pk_bf16_f32 v47, v78, v79
    v_mfma_f32_32x32x16_bf16 v[64:79], v[24:27], v[16:19], 0
    s_mov_b32 m0, s60
    s_add_u32 s60, s60, 8192
    buffer_load_dwordx4 v4, s[16:19], s61 offen sc1 lds
    s_add_u32 s61, s61, 8192
    ds_read2st64_b64 v[24:27], v1 offset0:20 offset1:21
    v_exp_f32 v48, v48
    v_exp_f32 v49, v49
    v_exp_f32 v50, v50
    v_cvt_pk_bf16_f32 v40, v48, v49
    v_exp_f32 v51, v51
    v_mfma_f32_32x32x16_bf16 v[96:111], v[36:39], v[44:47], v[96:111]
    v_exp_f32 v52, v52
    v_cvt_pk_bf16_f32 v41, v50, v51
    v_exp_f32 v53, v53
    v_exp_f32 v54, v54
    v_cvt_pk_bf16_f32 v42, v52, v53
    v_mfma_f32_32x32x8_bf16 v[64:79], v[28:29], v[22:23], v[64:79]
    s_mov_b64 exec, s[40:41]
    ds_read_b128 v[36:39], v3 offset:7040
    s_mov_b64 exec, s[98:99]
    ds_read_b64 v[28:29], v2 offset:11264
    s_mov_b64 exec, -1
    v_exp_f32 v55, v55
    v_exp_f32 v56, v56
    v_cvt_pk_bf16_f32 v43, v54, v55
    v_exp_f32 v57, v57
    v_exp_f32 v58, v58
    v_cvt_pk_bf16_f32 v44, v56, v57
    s_waitcnt lgkmcnt(3)
    v_mfma_f32_32x32x16_bf16 v[80:95], v[32:35], v[40:43], v[80:95]
    s_mov_b32 m0, s60
    s_add_u32 s60, s60, 8192
    buffer_load_dwordx4 v4, s[16:19], s61 offen sc1 lds
    s_add_u32 s61, s61, 8192
    v_exp_f32 v59, v59
    v_exp_f32 v60, v60
    v_cvt_pk_bf16_f32 v45, v58, v59
    v_exp_f32 v61, v61
    v_exp_f32 v62, v62
    v_exp_f32 v63, v63
    v_cvt_pk_bf16_f32 v46, v60, v61
    v_cvt_pk_bf16_f32 v47, v62, v63
    s_waitcnt lgkmcnt(2)
    v_mfma_f32_32x32x16_bf16 v[48:63], v[24:27], v[12:15], 0
    s_mov_b32 m0, s60
    s_add_u32 s60, s60, 8192
    buffer_load_dwordx4 v4, s[16:19], s61 offen sc1 lds
    s_add_u32 s61, s61, 8192
    v_exp_f32 v64, v64
    v_exp_f32 v65, v65
    v_exp_f32 v66, v66
    v_cvt_pk_bf16_f32 v40, v64, v65
    v_exp_f32 v67, v67
    s_waitcnt lgkmcnt(0)
    v_mfma_f32_32x32x16_bf16 v[80:95], v[36:39], v[44:47], v[80:95]
    v_exp_f32 v68, v68
    v_cvt_pk_bf16_f32 v41, v66, v67
    v_exp_f32 v69, v69
    v_exp_f32 v70, v70
    v_cvt_pk_bf16_f32 v42, v68, v69
    v_mfma_f32_32x32x8_bf16 v[48:63], v[28:29], v[20:21], v[48:63]
    s_mov_b32 m0, s60
    s_add_u32 s60, s60, 8192
    buffer_load_dwordx4 v4, s[16:19], s61 offen sc1 lds
    s_add_u32 s61, s61, 8192
    v_exp_f32 v71, v71
    v_exp_f32 v72, v72
    v_cvt_pk_bf16_f32 v43, v70, v71
    v_exp_f32 v73, v73
    v_exp_f32 v74, v74
    v_cvt_pk_bf16_f32 v44, v72, v73
    v_mfma_f32_32x32x16_bf16 v[96:111], v[32:35], v[40:43], v[96:111]
    s_mov_b64 exec, s[40:41]
    ds_read_b128 v[32:35], v3 offset:11520
    s_mov_b64 exec, -1
    v_exp_f32 v75, v75
    v_exp_f32 v76, v76
    v_cvt_pk_bf16_f32 v45, v74, v75
    v_exp_f32 v77, v77
    v_exp_f32 v78, v78
    v_exp_f32 v79, v79
    v_cvt_pk_bf16_f32 v46, v76, v77
    v_cvt_pk_bf16_f32 v47, v78, v79
    v_mfma_f32_32x32x16_bf16 v[64:79], v[24:27], v[16:19], 0
    s_mov_b32 s63, 0
L_A_WB:
    ds_read_b32 v9, v5 offset:24
    s_add_u32 s63, s63, 1
    s_waitcnt lgkmcnt(0)
    v_readfirstlane_b32 s88, v9
    s_cmp_gt_u32 s63, 200000
    s_cselect_b32 s88, 8, s88
    s_cmp_ge_u32 s88, 8
    s_cbranch_scc0 L_A_WB
    ds_read2st64_b64 v[24:27], v1 offset0:30 offset1:31
    v_exp_f32 v48, v48
    v_exp_f32 v49, v49
    v_exp_f32 v50, v50
    v_cvt_pk_bf16_f32 v40, v48, v49
    v_exp_f32 v51, v51
    v_mfma_f32_32x32x16_bf16 v[96:111], v[36:39], v[44:47], v[96:111]
    v_exp_f32 v52, v52
    v_cvt_pk_bf16_f32 v41, v50, v51
    v_exp_f32 v53, v53
    v_exp_f32 v54, v54
    v_cvt_pk_bf16_f32 v42, v52, v53
    v_mfma_f32_32x32x8_bf16 v[64:79], v[28:29], v[22:23], v[64:79]
    s_mov_b64 exec, s[40:41]
    ds_read_b128 v[36:39], v3 offset:12160
    s_mov_b64 exec, s[98:99]
    ds_read_b64 v[28:29], v2 offset:16384
    s_mov_b64 exec, -1
    v_exp_f32 v55, v55
    v_exp_f32 v56, v56
    v_cvt_pk_bf16_f32 v43, v54, v55
    v_exp_f32 v57, v57
    v_exp_f32 v58, v58
    v_cvt_pk_bf16_f32 v44, v56, v57
    s_waitcnt lgkmcnt(3)
    v_mfma_f32_32x32x16_bf16 v[80:95], v[32:35], v[40:43], v[80:95]
    v_exp_f32 v59, v59
    v_exp_f32 v60, v60
    v_cvt_pk_bf16_f32 v45, v58, v59
    v_exp_f32 v61, v61
    v_exp_f32 v62, v62
    v_exp_f32 v63, v63
    v_cvt_pk_bf16_f32 v46, v60, v61
    v_cvt_pk_bf16_f32 v47, v62, v63
    s_waitcnt lgkmcnt(2)
    v_mfma_f32_32x32x16_bf16 v[48:63], v[24:27], v[12:15], 0
    v_exp_f32 v64, v64
    v_exp_f32 v65, v65
    v_exp_f32 v66, v66
    v_cvt_pk_bf16_f32 v40, v64, v65
    v_exp_f32 v67, v67
    s_waitcnt lgkmcnt(0)
    v_mfma_f32_32x32x16_bf16 v[80:95], v[36:39], v[44:47], v[80:95]
    v_exp_f32 v68, v68
    v_cvt_pk_bf16_f32 v41, v66, v67
    v_exp_f32 v69, v69
    v_exp_f32 v70, v70
    v_cvt_pk_bf16_f32 v42, v68, v69
    v_mfma_f32_32x32x8_bf16 v[48:63], v[28:29], v[20:21], v[48:63]
    ds_write_b32 v112, v113
    s_waitcnt vmcnt(0)
    s_mov_b64 exec, 1
    ds_add_u32 v5, v6 offset:28
    s_mov_b64 exec, -1
    v_exp_f32 v71, v71
    v_exp_f32 v72, v72
    v_cvt_pk_bf16_f32 v43, v70, v71
    v_exp_f32 v73, v73
    v_exp_f32 v74, v74
    v_cvt_pk_bf16_f32 v44, v72, v73
    v_mfma_f32_32x32x16_bf16 v[96:111], v[32:35], v[40:43], v[96:111]
    s_mov_b64 exec, s[40:41]
    ds_read_b128 v[32:35], v3 offset:16640
    s_mov_b64 exec, -1
    v_exp_f32 v75, v75
    v_exp_f32 v76, v76
    v_cvt_pk_bf16_f32 v45, v74, v75
    v_exp_f32 v77, v77
    v_exp_f32 v78, v78
    v_exp_f32 v79, v79
    v_cvt_pk_bf16_f32 v46, v76, v77
    v_cvt_pk_bf16_f32 v47, v78, v79
    s_setprio 3
    v_mfma_f32_32x32x16_bf16 v[64:79], v[24:27], v[16:19], 0
    ds_read2st64_b64 v[24:27], v1 offset0:40 offset1:41
    v_exp_f32 v48, v48
    v_exp_f32 v49, v49
    v_exp_f32 v50, v50
    v_cvt_pk_bf16_f32 v40, v48, v49
    v_exp_f32 v51, v51
    v_mfma_f32_32x32x16_bf16 v[96:111], v[36:39], v[44:47], v[96:111]
    v_exp_f32 v52, v52
    v_cvt_pk_bf16_f32 v41, v50, v51
    v_exp_f32 v53, v53
    v_exp_f32 v54, v54
    v_cvt_pk_bf16_f32 v42, v52, v53
    v_mfma_f32_32x32x8_bf16 v[64:79], v[28:29], v[22:23], v[64:79]
    s_mov_b64 exec, s[40:41]
    ds_read_b128 v[36:39], v3 offset:17280
    s_mov_b64 exec, s[98:99]
    ds_read_b64 v[28:29], v2 offset:21504
    s_mov_b64 exec, -1
    v_exp_f32 v55, v55
    v_exp_f32 v56, v56
    v_cvt_pk_bf16_f32 v43, v54, v55
    v_exp_f32 v57, v57
    v_exp_f32 v58, v58
    v_cvt_pk_bf16_f32 v44, v56, v57
    s_waitcnt lgkmcnt(3)
    v_mfma_f32_32x32x16_bf16 v[80:95], v[32:35], v[40:43], v[80:95]
    v_exp_f32 v59, v59
    v_exp_f32 v60, v60
    v_cvt_pk_bf16_f32 v45, v58, v59
    v_exp_f32 v61, v61
    v_exp_f32 v62, v62
    v_exp_f32 v63, v63
    v_cvt_pk_bf16_f32 v46, v60, v61
    v_cvt_pk_bf16_f32 v47, v62, v63
    s_waitcnt lgkmcnt(2)
    v_mfma_f32_32x32x16_bf16 v[48:63], v[24:27], v[12:15], 0
    v_exp_f32 v64, v64
    v_exp_f32 v65, v65
    v_exp_f32 v66, v66
    v_cvt_pk_bf16_f32 v40, v64, v65
    v_exp_f32 v67, v67
    s_waitcnt lgkmcnt(0)
    v_mfma_f32_32x32x16_bf16 v[80:95], v[36:39], v[44:47], v[80:95]
    v_exp_f32 v68, v68
    v_cvt_pk_bf16_f32 v41, v66, v67
    v_exp_f32 v69, v69
    v_exp_f32 v70, v70
    v_cvt_pk_bf16_f32 v42, v68, v69
    v_mfma_f32_32x32x8_bf16 v[48:63], v[28:29], v[20:21], v[48:63]
    v_exp_f32 v71, v71
    v_exp_f32 v72, v72
    v_cvt_pk_bf16_f32 v43, v70, v71
    v_exp_f32 v73, v73
    v_exp_f32 v74, v74
    v_cvt_pk_bf16_f32 v44, v72, v73
    v_mfma_f32_32x32x16_bf16 v[96:111], v[32:35], v[40:43], v[96:111]
    s_mov_b64 exec, s[40:41]
    ds_read_b128 v[32:35], v3 offset:21760
    s_mov_b64 exec, -1
    v_exp_f32 v75, v75
    v_exp_f32 v76, v76
    v_cvt_pk_bf16_f32 v45, v74, v75
    v_exp_f32 v77, v77
    v_exp_f32 v78, v78
    v_exp_f32 v79, v79
    v_cvt_pk_bf16_f32 v46, v76, v77
    v_cvt_pk_bf16_f32 v47, v78, v79
    v_mfma_f32_32x32x16_bf16 v[64:79], v[24:27], v[16:19], 0
    ds_read2st64_b64 v[24:27], v1 offset0:50 offset1:51
    v_exp_f32 v48, v48
    v_exp_f32 v49, v49
    v_exp_f32 v50, v50
    v_cvt_pk_bf16_f32 v40, v48, v49
    v_exp_f32 v51, v51
    v_mfma_f32_32x32x16_bf16 v[96:111], v[36:39], v[44:47], v[96:111]
    v_exp_f32 v52, v52
    v_cvt_pk_bf16_f32 v41, v50, v51
    v_exp_f32 v53, v53
    v_exp_f32 v54, v54
    v_cvt_pk_bf16_f32 v42, v52, v53
    v_mfma_f32_32x32x8_bf16 v[64:79], v[28:29], v[22:23], v[64:79]
    s_mov_b64 exec, s[40:41]
    ds_read_b128 v[36:39], v3 offset:22400
    s_mov_b64 exec, s[98:99]
    ds_read_b64 v[28:29], v2 offset:26624
    s_mov_b64 exec, -1
    v_exp_f32 v55, v55
    v_exp_f32 v56, v56
    v_cvt_pk_bf16_f32 v43, v54, v55
    v_exp_f32 v57, v57
    v_exp_f32 v58, v58
    v_cvt_pk_bf16_f32 v44, v56, v57
    s_waitcnt lgkmcnt(3)
    v_mfma_f32_32x32x16_bf16 v[80:95], v[32:35], v[40:43], v[80:95]
    v_exp_f32 v59, v59
    v_exp_f32 v60, v60
    v_cvt_pk_bf16_f32 v45, v58, v59
    v_exp_f32 v61, v61
    v_exp_f32 v62, v62
    v_exp_f32 v63, v63
    v_cvt_pk_bf16_f32 v46, v60, v61
    v_cvt_pk_bf16_f32 v47, v62, v63
    s_waitcnt lgkmcnt(2)
    v_mfma_f32_32x32x16_bf16 v[48:63], v[24:27], v[12:15], 0
    v_exp_f32 v64, v64
    v_exp_f32 v65, v65
    v_exp_f32 v66, v66
    v_cvt_pk_bf16_f32 v40, v64, v65
    v_exp_f32 v67, v67
    s_waitcnt lgkmcnt(0)
    v_mfma_f32_32x32x16_bf16 v[80:95], v[36:39], v[44:47], v[80:95]
    v_exp_f32 v68, v68
    v_cvt_pk_bf16_f32 v41, v66, v67
    v_exp_f32 v69, v69
    v_exp_f32 v70, v70
    v_cvt_pk_bf16_f32 v42, v68, v69
    v_mfma_f32_32x32x8_bf16 v[48:63], v[28:29], v[20:21], v[48:63]
    v_exp_f32 v71, v71
    v_exp_f32 v72, v72
    v_cvt_pk_bf16_f32 v43, v70, v71
    v_exp_f32 v73, v73
    v_exp_f32 v74, v74
    v_cvt_pk_bf16_f32 v44, v72, v73
    v_mfma_f32_32x32x16_bf16 v[96:111], v[32:35], v[40:43], v[96:111]
    s_mov_b64 exec, s[40:41]
    ds_read_b128 v[32:35], v3 offset:26880
    s_mov_b64 exec, -1
    v_exp_f32 v75, v75
    v_exp_f32 v76, v76
    v_cvt_pk_bf16_f32 v45, v74, v75
    v_exp_f32 v77, v77
    v_exp_f32 v78, v78
    v_exp_f32 v79, v79
    v_cvt_pk_bf16_f32 v46, v76, v77
    v_cvt_pk_bf16_f32 v47, v78, v79
    v_mfma_f32_32x32x16_bf16 v[64:79], v[24:27], v[16:19], 0
    s_mov_b32 s63, 0
L_A_WC:
    ds_read_b32 v9, v5 offset:28
    s_add_u32 s63, s63, 1
    s_waitcnt lgkmcnt(0)
    v_readfirstlane_b32 s88, v9
    s_cmp_gt_u32 s63, 200000
    s_cselect_b32 s88, 8, s88
    s_cmp_ge_u32 s88, 8
    s_cbranch_scc0 L_A_WC
    ds_read2st64_b64 v[24:27], v1 offset0:60 offset1:61
    v_exp_f32 v48, v48
    v_exp_f32 v49, v49
    v_exp_f32 v50, v50
    v_cvt_pk_bf16_f32 v40, v48, v49
    v_exp_f32 v51, v51
    v_mfma_f32_32x32x16_bf16 v[96:111], v[36:39], v[44:47], v[96:111]
    v_exp_f32 v52, v52
    v_cvt_pk_bf16_f32 v41, v50, v51
    v_exp_f32 v53, v53
    v_exp_f32 v54, v54
    v_cvt_pk_bf16_f32 v42, v52, v53
    v_mfma_f32_32x32x8_bf16 v[64:79], v[28:29], v[22:23], v[64:79]
    s_mov_b64 exec, s[40:41]
    ds_read_b128 v[36:39], v3 offset:27520
    s_mov_b64 exec, s[98:99]
    ds_read_b64 v[28:29], v2 offset:31744
    s_mov_b64 exec, -1
    v_exp_f32 v55, v55
    v_exp_f32 v56, v56
    v_cvt_pk_bf16_f32 v43, v54, v55
    v_exp_f32 v57, v57
    v_exp_f32 v58, v58
    v_cvt_pk_bf16_f32 v44, v56, v57
    s_waitcnt lgkmcnt(3)
    v_mfma_f32_32x32x16_bf16 v[80:95], v[32:35], v[40:43], v[80:95]
    v_exp_f32 v59, v59
    v_exp_f32 v60, v60
    v_cvt_pk_bf16_f32 v45, v58, v59
    v_exp_f32 v61, v61
    v_exp_f32 v62, v62
    v_exp_f32 v63, v63
    v_cvt_pk_bf16_f32 v46, v60, v61
    v_cvt_pk_bf16_f32 v47, v62, v63
    s_waitcnt lgkmcnt(2)
    v_mfma_f32_32x32x16_bf16 v[48:63], v[24:27], v[12:15], 0
    v_exp_f32 v64, v64
    v_exp_f32 v65, v65
    v_exp_f32 v66, v66
    v_cvt_pk_bf16_f32 v40, v64, v65
    v_exp_f32 v67, v67
    s_waitcnt lgkmcnt(0)
    v_mfma_f32_32x32x16_bf16 v[80:95], v[36:39], v[44:47], v[80:95]
    v_exp_f32 v68, v68
    v_cvt_pk_bf16_f32 v41, v66, v67
    v_exp_f32 v69, v69
    v_exp_f32 v70, v70
    v_cvt_pk_bf16_f32 v42, v68, v69
    v_mfma_f32_32x32x8_bf16 v[48:63], v[28:29], v[20:21], v[48:63]
    s_mov_b64 exec, 1
    ds_add_u32 v113, v6 offset:4
    s_mov_b64 exec, -1
    v_exp_f32 v71, v71
    v_exp_f32 v72, v72
    v_cvt_pk_bf16_f32 v43, v70, v71
    v_exp_f32 v73, v73
    v_exp_f32 v74, v74
    v_cvt_pk_bf16_f32 v44, v72, v73
    v_mfma_f32_32x32x16_bf16 v[96:111], v[32:35], v[40:43], v[96:111]
    s_mov_b64 exec, s[40:41]
    ds_read_b128 v[32:35], v3 offset:32000
    s_mov_b64 exec, -1
    v_exp_f32 v75, v75
    v_exp_f32 v76, v76
    v_cvt_pk_bf16_f32 v45, v74, v75
    v_exp_f32 v77, v77
    v_exp_f32 v78, v78
    v_exp_f32 v79, v79
    v_cvt_pk_bf16_f32 v46, v76, v77
    v_cvt_pk_bf16_f32 v47, v78, v79
    v_mfma_f32_32x32x16_bf16 v[64:79], v[24:27], v[16:19], 0
    ds_read2st64_b64 v[24:27], v1 offset0:70 offset1:71
    v_exp_f32 v48, v48
    v_exp_f32 v49, v49
    v_exp_f32 v50, v50
    v_cvt_pk_bf16_f32 v40, v48, v49
    v_exp_f32 v51, v51
    v_mfma_f32_32x32x16_bf16 v[96:111], v[36:39], v[44:47], v[96:111]
    v_exp_f32 v52, v52
    v_cvt_pk_bf16_f32 v41, v50, v51
    v_exp_f32 v53, v53
    v_exp_f32 v54, v54
    v_cvt_pk_bf16_f32 v42, v52, v53
    v_mfma_f32_32x32x8_bf16 v[64:79], v[28:29], v[22:23], v[64:79]
    s_mov_b64 exec, s[40:41]
    ds_read_b128 v[36:39], v3 offset:32640
    s_mov_b64 exec, s[98:99]
    ds_read_b64 v[28:29], v2 offset:36864
    s_mov_b64 exec, -1
    v_exp_f32 v55, v55
    v_exp_f32 v56, v56
    v_cvt_pk_bf16_f32 v43, v54, v55
    v_exp_f32 v57, v57
    v_exp_f32 v58, v58
    v_cvt_pk_bf16_f32 v44, v56, v57
    s_waitcnt lgkmcnt(3)
    v_mfma_f32_32x32x16_bf16 v[80:95], v[32:35], v[40:43], v[80:95]
    v_exp_f32 v59, v59
    v_exp_f32 v60, v60
    v_cvt_pk_bf16_f32 v45, v58, v59
    v_exp_f32 v61, v61
    v_exp_f32 v62, v62
    v_exp_f32 v63, v63
    v_cvt_pk_bf16_f32 v46, v60, v61
    v_cvt_pk_bf16_f32 v47, v62, v63
    s_waitcnt lgkmcnt(2)
    v_mfma_f32_32x32x16_bf16 v[48:63], v[24:27], v[12:15], 0
    v_exp_f32 v64, v64
    v_exp_f32 v65, v65
    v_exp_f32 v66, v66
    v_cvt_pk_bf16_f32 v40, v64, v65
    v_exp_f32 v67, v67
    s_waitcnt lgkmcnt(0)
    v_mfma_f32_32x32x16_bf16 v[80:95], v[36:39], v[44:47], v[80:95]
    v_exp_f32 v68, v68
    v_cvt_pk_bf16_f32 v41, v66, v67
    v_exp_f32 v69, v69
    v_exp_f32 v70, v70
    v_cvt_pk_bf16_f32 v42, v68, v69
    v_mfma_f32_32x32x8_bf16 v[48:63], v[28:29], v[20:21], v[48:63]
    v_exp_f32 v71, v71
    v_exp_f32 v72, v72
    v_cvt_pk_bf16_f32 v43, v70, v71
    v_exp_f32 v73, v73
    v_exp_f32 v74, v74
    v_cvt_pk_bf16_f32 v44, v72, v73
    v_mfma_f32_32x32x16_bf16 v[96:111], v[32:35], v[40:43], v[96:111]
    s_mov_b64 exec, s[40:41]
    ds_read_b128 v[32:35], v3 offset:37120
    s_mov_b64 exec, -1
    v_exp_f32 v75, v75
    v_exp_f32 v76, v76
    v_cvt_pk_bf16_f32 v45, v74, v75
    v_exp_f32 v77, v77
    v_exp_f32 v78, v78
    v_exp_f32 v79, v79
    v_cvt_pk_bf16_f32 v46, v76, v77
    v_cvt_pk_bf16_f32 v47, v78, v79
    v_mfma_f32_32x32x16_bf16 v[64:79], v[24:27], v[16:19], 0
    ds_read2st64_b64 v[24:27], v1 offset0:80 offset1:81
    v_exp_f32 v48, v48
    v_exp_f32 v49, v49
    v_exp_f32 v50, v50
    v_cvt_pk_bf16_f32 v40, v48, v49
    v_exp_f32 v51, v51
    v_mfma_f32_32x32x16_bf16 v[96:111], v[36:39], v[44:47], v[96:111]
    v_exp_f32 v52, v52
    v_cvt_pk_bf16_f32 v41, v50, v51
    v_exp_f32 v53, v53
    v_exp_f32 v54, v54
    v_cvt_pk_bf16_f32 v42, v52, v53
    v_mfma_f32_32x32x8_bf16 v[64:79], v[28:29], v[22:23], v[64:79]
    s_mov_b64 exec, s[40:41]
    ds_read_b128 v[36:39], v3 offset:37760
    s_mov_b64 exec, s[98:99]
    ds_read_b64 v[28:29], v2 offset:41984
    s_mov_b64 exec, -1
    v_exp_f32 v55, v55
    v_exp_f32 v56, v56
    v_cvt_pk_bf16_f32 v43, v54, v55
    v_exp_f32 v57, v57
    v_exp_f32 v58, v58
    v_cvt_pk_bf16_f32 v44, v56, v57
    s_waitcnt lgkmcnt(3)
    v_mfma_f32_32x32x16_bf16 v[80:95], v[32:35], v[40:43], v[80:95]
    v_exp_f32 v59, v59
    v_exp_f32 v60, v60
    v_cvt_pk_bf16_f32 v45, v58, v59
    v_exp_f32 v61, v61
    v_exp_f32 v62, v62
    v_exp_f32 v63, v63
    v_cvt_pk_bf16_f32 v46, v60, v61
    v_cvt_pk_bf16_f32 v47, v62, v63
    s_waitcnt lgkmcnt(2)
    v_mfma_f32_32x32x16_bf16 v[48:63], v[24:27], v[12:15], 0
    v_exp_f32 v64, v64
    v_exp_f32 v65, v65
    v_exp_f32 v66, v66
    v_cvt_pk_bf16_f32 v40, v64, v65
    v_exp_f32 v67, v67
    s_waitcnt lgkmcnt(0)
    v_mfma_f32_32x32x16_bf16 v[80:95], v[36:39], v[44:47], v[80:95]
    v_exp_f32 v68, v68
    v_cvt_pk_bf16_f32 v41, v66, v67
    v_exp_f32 v69, v69
    v_exp_f32 v70, v70
    v_cvt_pk_bf16_f32 v42, v68, v69
    v_mfma_f32_32x32x8_bf16 v[48:63], v[28:29], v[20:21], v[48:63]
    v_exp_f32 v71, v71
    v_exp_f32 v72, v72
    v_cvt_pk_bf16_f32 v43, v70, v71
    v_exp_f32 v73, v73
    v_exp_f32 v74, v74
    v_cvt_pk_bf16_f32 v44, v72, v73
    v_mfma_f32_32x32x16_bf16 v[96:111], v[32:35], v[40:43], v[96:111]
    s_mov_b64 exec, s[40:41]
    ds_read_b128 v[32:35], v3 offset:42240
    s_mov_b64 exec, -1
    v_exp_f32 v75, v75
    v_exp_f32 v76, v76
    v_cvt_pk_bf16_f32 v45, v74, v75
    v_exp_f32 v77, v77
    v_exp_f32 v78, v78
    v_exp_f32 v79, v79
    v_cvt_pk_bf16_f32 v46, v76, v77
    v_cvt_pk_bf16_f32 v47, v78, v79
    v_mfma_f32_32x32x16_bf16 v[64:79], v[24:27], v[16:19], 0
    ds_read2st64_b64 v[24:27], v1 offset0:90 offset1:91
    v_exp_f32 v48, v48
    v_exp_f32 v49, v49
    v_exp_f32 v50, v50
    v_cvt_pk_bf16_f32 v40, v48, v49
    v_exp_f32 v51, v51
    v_mfma_f32_32x32x16_bf16 v[96:111], v[36:39], v[44:47], v[96:111]
    v_exp_f32 v52, v52
    v_cvt_pk_bf16_f32 v41, v50, v51
    v_exp_f32 v53, v53
    v_exp_f32 v54, v54
    v_cvt_pk_bf16_f32 v42, v52, v53
    v_mfma_f32_32x32x8_bf16 v[64:79], v[28:29], v[22:23], v[64:79]
    s_mov_b64 exec, s[40:41]
    ds_read_b128 v[36:39], v3 offset:42880
    s_mov_b64 exec, s[98:99]
    ds_read_b64 v[28:29], v2 offset:47104
    s_mov_b64 exec, -1
    v_exp_f32 v55, v55
    v_exp_f32 v56, v56
    v_cvt_pk_bf16_f32 v43, v54, v55
    v_exp_f32 v57, v57
    v_exp_f32 v58, v58
    v_cvt_pk_bf16_f32 v44, v56, v57
    s_waitcnt lgkmcnt(3)
    v_mfma_f32_32x32x16_bf16 v[80:95], v[32:35], v[40:43], v[80:95]
    v_exp_f32 v59, v59
    v_exp_f32 v60, v60
    v_cvt_pk_bf16_f32 v45, v58, v59
    v_exp_f32 v61, v61
    v_exp_f32 v62, v62
    v_exp_f32 v63, v63
    v_cvt_pk_bf16_f32 v46, v60, v61
    v_cvt_pk_bf16_f32 v47, v62, v63
    s_waitcnt lgkmcnt(2)
    v_mfma_f32_32x32x16_bf16 v[48:63], v[24:27], v[12:15], 0
    v_exp_f32 v64, v64
    v_exp_f32 v65, v65
    v_exp_f32 v66, v66
    v_cvt_pk_bf16_f32 v40, v64, v65
    v_exp_f32 v67, v67
    s_waitcnt lgkmcnt(0)
    v_mfma_f32_32x32x16_bf16 v[80:95], v[36:39], v[44:47], v[80:95]
    v_exp_f32 v68, v68
    v_cvt_pk_bf16_f32 v41, v66, v67
    v_exp_f32 v69, v69
    v_exp_f32 v70, v70
    v_cvt_pk_bf16_f32 v42, v68, v69
    v_mfma_f32_32x32x8_bf16 v[48:63], v[28:29], v[20:21], v[48:63]
    v_exp_f32 v71, v71
    v_exp_f32 v72, v72
    v_cvt_pk_bf16_f32 v43, v70, v71
    v_exp_f32 v73, v73
    v_exp_f32 v74, v74
    v_cvt_pk_bf16_f32 v44, v72, v73
    v_mfma_f32_32x32x16_bf16 v[96:111], v[32:35], v[40:43], v[96:111]
    s_mov_b64 exec, s[40:41]
    ds_read_b128 v[32:35], v3 offset:47360
    s_mov_b64 exec, -1
    v_exp_f32 v75, v75
    v_exp_f32 v76, v76
    v_cvt_pk_bf16_f32 v45, v74, v75
    v_exp_f32 v77, v77
    v_exp_f32 v78, v78
    v_exp_f32 v79, v79
    v_cvt_pk_bf16_f32 v46, v76, v77
    v_cvt_pk_bf16_f32 v47, v78, v79
    v_mfma_f32_32x32x16_bf16 v[64:79], v[24:27], v[16:19], 0
    ds_read2st64_b64 v[24:27], v1 offset0:100 offset1:101
    v_exp_f32 v48, v48
    v_exp_f32 v49, v49
    v_exp_f32 v50, v50
    v_cvt_pk_bf16_f32 v40, v48, v49
    v_exp_f32 v51, v51
    v_mfma_f32_32x32x16_bf16 v[96:111], v[36:39], v[44:47], v[96:111]
    v_exp_f32 v52, v52
    v_cvt_pk_bf16_f32 v41, v50, v51
    v_exp_f32 v53, v53
    v_exp_f32 v54, v54
    v_cvt_pk_bf16_f32 v42, v52, v53
    v_mfma_f32_32x32x8_bf16 v[64:79], v[28:29], v[22:23], v[64:79]
    s_mov_b64 exec, s[40:41]
    ds_read_b128 v[36:39], v3 offset:48000
    s_mov_b64 exec, s[98:99]
    ds_read_b64 v[28:29], v2 offset:52224
    s_mov_b64 exec, -1
    v_exp_f32 v55, v55
    v_exp_f32 v56, v56
    v_cvt_pk_bf16_f32 v43, v54, v55
    v_exp_f32 v57, v57
    v_exp_f32 v58, v58
    v_cvt_pk_bf16_f32 v44, v56, v57
    s_waitcnt lgkmcnt(3)
    v_mfma_f32_32x32x16_bf16 v[80:95], v[32:35], v[40:43], v[80:95]
    v_exp_f32 v59, v59
    v_exp_f32 v60, v60
    v_cvt_pk_bf16_f32 v45, v58, v59
    v_exp_f32 v61, v61
    v_exp_f32 v62, v62
    v_exp_f32 v63, v63
    v_cvt_pk_bf16_f32 v46, v60, v61
    v_cvt_pk_bf16_f32 v47, v62, v63
    s_waitcnt lgkmcnt(2)
    v_mfma_f32_32x32x16_bf16 v[48:63], v[24:27], v[12:15], 0
    v_exp_f32 v64, v64
    v_exp_f32 v65, v65
    v_exp_f32 v66, v66
    v_cvt_pk_bf16_f32 v40, v64, v65
    v_exp_f32 v67, v67
    s_waitcnt lgkmcnt(0)
    v_mfma_f32_32x32x16_bf16 v[80:95], v[36:39], v[44:47], v[80:95]
    v_exp_f32 v68, v68
    v_cvt_pk_bf16_f32 v41, v66, v67
    v_exp_f32 v69, v69
    v_exp_f32 v70, v70
    v_cvt_pk_bf16_f32 v42, v68, v69
    v_mfma_f32_32x32x8_bf16 v[48:63], v[28:29], v[20:21], v[48:63]
    v_exp_f32 v71, v71
    v_exp_f32 v72, v72
    v_cvt_pk_bf16_f32 v43, v70, v71
    v_exp_f32 v73, v73
    v_exp_f32 v74, v74
    v_cvt_pk_bf16_f32 v44, v72, v73
    v_mfma_f32_32x32x16_bf16 v[96:111], v[32:35], v[40:43], v[96:111]
    s_mov_b64 exec, s[40:41]
    ds_read_b128 v[32:35], v3 offset:52480
    s_mov_b64 exec, -1
    v_exp_f32 v75, v75
    v_exp_f32 v76, v76
    v_cvt_pk_bf16_f32 v45, v74, v75
    v_exp_f32 v77, v77
    v_exp_f32 v78, v78
    v_exp_f32 v79, v79
    v_cvt_pk_bf16_f32 v46, v76, v77
    v_cvt_pk_bf16_f32 v47, v78, v79
    v_mfma_f32_32x32x16_bf16 v[64:79], v[24:27], v[16:19], 0
    ds_read2st64_b64 v[24:27], v1 offset0:110 offset1:111
    v_exp_f32 v48, v48
    v_exp_f32 v49, v49
    v_exp_f32 v50, v50
    v_cvt_pk_bf16_f32 v40, v48, v49
    v_exp_f32 v51, v51
    v_mfma_f32_32x32x16_bf16 v[96:111], v[36:39], v[44:47], v[96:111]
    v_exp_f32 v52, v52
    v_cvt_pk_bf16_f32 v41, v50, v51
    v_exp_f32 v53, v53
    v_exp_f32 v54, v54
    v_cvt_pk_bf16_f32 v42, v52, v53
    v_mfma_f32_32x32x8_bf16 v[64:79], v[28:29], v[22:23], v[64:79]
    s_mov_b64 exec, s[40:41]
    ds_read_b128 v[36:39], v3 offset:53120
    s_mov_b64 exec, s[98:99]
    ds_read_b64 v[28:29], v2 offset:57344
    s_mov_b64 exec, -1
    v_exp_f32 v55, v55
    v_exp_f32 v56, v56
    v_cvt_pk_bf16_f32 v43, v54, v55
    v_exp_f32 v57, v57
    v_exp_f32 v58, v58
    v_cvt_pk_bf16_f32 v44, v56, v57
    s_waitcnt lgkmcnt(3)
    v_mfma_f32_32x32x16_bf16 v[80:95], v[32:35], v[40:43], v[80:95]
    v_exp_f32 v59, v59
    v_exp_f32 v60, v60
    v_cvt_pk_bf16_f32 v45, v58, v59
    v_exp_f32 v61, v61
    v_exp_f32 v62, v62
    v_exp_f32 v63, v63
    v_cvt_pk_bf16_f32 v46, v60, v61
    v_cvt_pk_bf16_f32 v47, v62, v63
    s_waitcnt lgkmcnt(2)
    v_mfma_f32_32x32x16_bf16 v[48:63], v[24:27], v[12:15], 0
    v_exp_f32 v64, v64
    v_exp_f32 v65, v65
    v_exp_f32 v66, v66
    v_cvt_pk_bf16_f32 v40, v64, v65
    v_exp_f32 v67, v67
    s_waitcnt lgkmcnt(0)
    v_mfma_f32_32x32x16_bf16 v[80:95], v[36:39], v[44:47], v[80:95]
    v_exp_f32 v68, v68
    v_cvt_pk_bf16_f32 v41, v66, v67
    v_exp_f32 v69, v69
    v_exp_f32 v70, v70
    v_cvt_pk_bf16_f32 v42, v68, v69
    v_mfma_f32_32x32x8_bf16 v[48:63], v[28:29], v[20:21], v[48:63]
    v_exp_f32 v71, v71
    v_exp_f32 v72, v72
    v_cvt_pk_bf16_f32 v43, v70, v71
    v_exp_f32 v73, v73
    v_exp_f32 v74, v74
    v_cvt_pk_bf16_f32 v44, v72, v73
    v_mfma_f32_32x32x16_bf16 v[96:111], v[32:35], v[40:43], v[96:111]
    s_mov_b64 exec, s[40:41]
    ds_read_b128 v[32:35], v3 offset:57600
    s_mov_b64 exec, -1
    v_exp_f32 v75, v75
    v_exp_f32 v76, v76
    v_cvt_pk_bf16_f32 v45, v74, v75
    v_exp_f32 v77, v77
    v_exp_f32 v78, v78
    v_exp_f32 v79, v79
    v_cvt_pk_bf16_f32 v46, v76, v77
    v_cvt_pk_bf16_f32 v47, v78, v79
    v_mfma_f32_32x32x16_bf16 v[64:79], v[24:27], v[16:19], 0
    ds_read2st64_b64 v[24:27], v1 offset0:120 offset1:121
    v_exp_f32 v48, v48
    v_exp_f32 v49, v49
    v_exp_f32 v50, v50
    v_cvt_pk_bf16_f32 v40, v48, v49
    v_exp_f32 v51, v51
    v_mfma_f32_32x32x16_bf16 v[96:111], v[36:39], v[44:47], v[96:111]
    v_exp_f32 v52, v52
    v_cvt_pk_bf16_f32 v41, v50, v51
    v_exp_f32 v53, v53
    v_exp_f32 v54, v54
    v_cvt_pk_bf16_f32 v42, v52, v53
    v_mfma_f32_32x32x8_bf16 v[64:79], v[28:29], v[22:23], v[64:79]
    s_mov_b64 exec, s[40:41]
    ds_read_b128 v[36:39], v3 offset:58240
    s_mov_b64 exec, s[98:99]
    ds_read_b64 v[28:29], v115 offset:1024
    s_mov_b64 exec, -1
    v_exp_f32 v55, v55
    v_exp_f32 v56, v56
    v_cvt_pk_bf16_f32 v43, v54, v55
    v_exp_f32 v57, v57
    v_exp_f32 v58, v58
    v_cvt_pk_bf16_f32 v44, v56, v57
    s_waitcnt lgkmcnt(3)
    v_mfma_f32_32x32x16_bf16 v[80:95], v[32:35], v[40:43], v[80:95]
    v_exp_f32 v59, v59
    v_exp_f32 v60, v60
    v_cvt_pk_bf16_f32 v45, v58, v59
    v_exp_f32 v61, v61
    v_exp_f32 v62, v62
    v_exp_f32 v63, v63
    v_cvt_pk_bf16_f32 v46, v60, v61
    v_cvt_pk_bf16_f32 v47, v62, v63
    s_waitcnt lgkmcnt(2)
    v_mfma_f32_32x32x16_bf16 v[48:63], v[24:27], v[12:15], 0
    v_exp_f32 v64, v64
    v_exp_f32 v65, v65
    v_exp_f32 v66, v66
    v_cvt_pk_bf16_f32 v40, v64, v65
    v_exp_f32 v67, v67
    s_waitcnt lgkmcnt(0)
    v_mfma_f32_32x32x16_bf16 v[80:95], v[36:39], v[44:47], v[80:95]
    v_exp_f32 v68, v68
    v_cvt_pk_bf16_f32 v41, v66, v67
    v_exp_f32 v69, v69
    v_exp_f32 v70, v70
    v_cvt_pk_bf16_f32 v42, v68, v69
    v_mfma_f32_32x32x8_bf16 v[48:63], v[28:29], v[20:21], v[48:63]
    v_exp_f32 v71, v71
    v_exp_f32 v72, v72
    v_cvt_pk_bf16_f32 v43, v70, v71
    v_exp_f32 v73, v73
    v_exp_f32 v74, v74
    v_cvt_pk_bf16_f32 v44, v72, v73
    v_mfma_f32_32x32x16_bf16 v[96:111], v[32:35], v[40:43], v[96:111]
    s_mov_b64 exec, s[40:41]
    ds_read_b128 v[32:35], v117 offset:1280
    s_mov_b64 exec, -1
    v_exp_f32 v75, v75
    v_exp_f32 v76, v76
    v_cvt_pk_bf16_f32 v45, v74, v75
    v_exp_f32 v77, v77
    v_exp_f32 v78, v78
    v_exp_f32 v79, v79
    v_cvt_pk_bf16_f32 v46, v76, v77
    v_cvt_pk_bf16_f32 v47, v78, v79
    v_mfma_f32_32x32x16_bf16 v[64:79], v[24:27], v[16:19], 0
    ds_read2st64_b64 v[24:27], v1 offset0:130 offset1:131
    v_exp_f32 v48, v48
    v_exp_f32 v49, v49
    v_exp_f32 v50, v50
    v_cvt_pk_bf16_f32 v40, v48, v49
    v_exp_f32 v51, v51
    v_mfma_f32_32x32x16_bf16 v[96:111], v[36:39], v[44:47], v[96:111]
    v_exp_f32 v52, v52
    v_cvt_pk_bf16_f32 v41, v50, v51
    v_exp_f32 v53, v53
    v_exp_f32 v54, v54
    v_cvt_pk_bf16_f32 v42, v52, v53
    v_mfma_f32_32x32x8_bf16 v[64:79], v[28:29], v[22:23], v[64:79]
    s_mov_b64 exec, s[40:41]
    ds_read_b128 v[36:39], v117 offset:1920
    s_mov_b64 exec, s[98:99]
    ds_read_b64 v[28:29], v115 offset:6144
    s_mov_b64 exec, -1
    v_exp_f32 v55, v55
    v_exp_f32 v56, v56
    v_cvt_pk_bf16_f32 v43, v54, v55
    v_exp_f32 v57, v57
    v_exp_f32 v58, v58
    v_cvt_pk_bf16_f32 v44, v56, v57
    s_waitcnt lgkmcnt(3)
    v_mfma_f32_32x32x16_bf16 v[80:95], v[32:35], v[40:43], v[80:95]
    v_exp_f32 v59, v59
    v_exp_f32 v60, v60
    v_cvt_pk_bf16_f32 v45, v58, v59
    v_exp_f32 v61, v61
    v_exp_f32 v62, v62
    v_exp_f32 v63, v63
    v_cvt_pk_bf16_f32 v46, v60, v61
    v_cvt_pk_bf16_f32 v47, v62, v63
    s_waitcnt lgkmcnt(2)
    v_mfma_f32_32x32x16_bf16 v[48:63], v[24:27], v[12:15], 0
    v_exp_f32 v64, v64
    v_exp_f32 v65, v65
    v_exp_f32 v66, v66
    v_cvt_pk_bf16_f32 v40, v64, v65
    v_exp_f32 v67, v67
    s_waitcnt lgkmcnt(0)
    v_mfma_f32_32x32x16_bf16 v[80:95], v[36:39], v[44:47], v[80:95]
    v_exp_f32 v68, v68
    v_cvt_pk_bf16_f32 v41, v66, v67
    v_exp_f32 v69, v69
    v_exp_f32 v70, v70
    v_cvt_pk_bf16_f32 v42, v68, v69
    v_mfma_f32_32x32x8_bf16 v[48:63], v[28:29], v[20:21], v[48:63]
    v_exp_f32 v71, v71
    v_exp_f32 v72, v72
    v_cvt_pk_bf16_f32 v43, v70, v71
    v_exp_f32 v73, v73
    v_exp_f32 v74, v74
    v_cvt_pk_bf16_f32 v44, v72, v73
    v_mfma_f32_32x32x16_bf16 v[96:111], v[32:35], v[40:43], v[96:111]
    s_mov_b64 exec, s[40:41]
    ds_read_b128 v[32:35], v117 offset:6400
    s_mov_b64 exec, -1
    v_exp_f32 v75, v75
    v_exp_f32 v76, v76
    v_cvt_pk_bf16_f32 v45, v74, v75
    v_exp_f32 v77, v77
    v_exp_f32 v78, v78
    v_exp_f32 v79, v79
    v_cvt_pk_bf16_f32 v46, v76, v77
    v_cvt_pk_bf16_f32 v47, v78, v79
    v_mfma_f32_32x32x16_bf16 v[64:79], v[24:27], v[16:19], 0
    ds_read2st64_b64 v[24:27], v1 offset0:140 offset1:141
    v_exp_f32 v48, v48
    v_exp_f32 v49, v49
    v_exp_f32 v50, v50
    v_cvt_pk_bf16_f32 v40, v48, v49
    v_exp_f32 v51, v51
    v_mfma_f32_32x32x16_bf16 v[96:111], v[36:39], v[44:47], v[96:111]
    v_exp_f32 v52, v52
    v_cvt_pk_bf16_f32 v41, v50, v51
    v_exp_f32 v53, v53
    v_exp_f32 v54, v54
    v_cvt_pk_bf16_f32 v42, v52, v53
    v_mfma_f32_32x32x8_bf16 v[64:79], v[28:29], v[22:23], v[64:79]
    s_mov_b64 exec, s[40:41]
    ds_read_b128 v[36:39], v117 offset:7040
    s_mov_b64 exec, s[98:99]
    ds_read_b64 v[28:29], v115 offset:11264
    s_mov_b64 exec, -1
    v_exp_f32 v55, v55
    v_exp_f32 v56, v56
    v_cvt_pk_bf16_f32 v43, v54, v55
    v_exp_f32 v57, v57
    v_exp_f32 v58, v58
    v_cvt_pk_bf16_f32 v44, v56, v57
    s_waitcnt lgkmcnt(3)
    v_mfma_f32_32x32x16_bf16 v[80:95], v[32:35], v[40:43], v[80:95]
    v_exp_f32 v59, v59
    v_exp_f32 v60, v60
    v_cvt_pk_bf16_f32 v45, v58, v59
    v_exp_f32 v61, v61
    v_exp_f32 v62, v62
    v_exp_f32 v63, v63
    v_cvt_pk_bf16_f32 v46, v60, v61
    v_cvt_pk_bf16_f32 v47, v62, v63
    s_waitcnt lgkmcnt(2)
    v_mfma_f32_32x32x16_bf16 v[48:63], v[24:27], v[12:15], 0
    v_exp_f32 v64, v64
    v_exp_f32 v65, v65
    v_exp_f32 v66, v66
    v_cvt_pk_bf16_f32 v40, v64, v65
    v_exp_f32 v67, v67
    s_waitcnt lgkmcnt(0)
    v_mfma_f32_32x32x16_bf16 v[80:95], v[36:39], v[44:47], v[80:95]
    v_exp_f32 v68, v68
    v_cvt_pk_bf16_f32 v41, v66, v67
    v_exp_f32 v69, v69
    v_exp_f32 v70, v70
    v_cvt_pk_bf16_f32 v42, v68, v69
    v_mfma_f32_32x32x8_bf16 v[48:63], v[28:29], v[20:21], v[48:63]
    v_exp_f32 v71, v71
    v_exp_f32 v72, v72
    v_cvt_pk_bf16_f32 v43, v70, v71
    v_exp_f32 v73, v73
    v_exp_f32 v74, v74
    v_cvt_pk_bf16_f32 v44, v72, v73
    v_mfma_f32_32x32x16_bf16 v[96:111], v[32:35], v[40:43], v[96:111]
    s_mov_b64 exec, s[40:41]
    ds_read_b128 v[32:35], v117 offset:11520
    s_mov_b64 exec, -1
    v_exp_f32 v75, v75
    v_exp_f32 v76, v76
    v_cvt_pk_bf16_f32 v45, v74, v75
    v_exp_f32 v77, v77
    v_exp_f32 v78, v78
    v_exp_f32 v79, v79
    v_cvt_pk_bf16_f32 v46, v76, v77
    v_cvt_pk_bf16_f32 v47, v78, v79
    v_mfma_f32_32x32x16_bf16 v[64:79], v[24:27], v[16:19], 0
    ds_read2st64_b64 v[24:27], v1 offset0:150 offset1:151
    v_exp_f32 v48, v48
    v_exp_f32 v49, v49
    v_exp_f32 v50, v50
    v_cvt_pk_bf16_f32 v40, v48, v49
    v_exp_f32 v51, v51
    v_mfma_f32_32x32x16_bf16 v[96:111], v[36:39], v[44:47], v[96:111]
    v_exp_f32 v52, v52
    v_cvt_pk_bf16_f32 v41, v50, v51
    v_exp_f32 v53, v53
    v_exp_f32 v54, v54
    v_cvt_pk_bf16_f32 v42, v52, v53
    v_mfma_f32_32x32x8_bf16 v[64:79], v[28:29], v[22:23], v[64:79]
    s_mov_b64 exec, s[40:41]
    ds_read_b128 v[36:39], v117 offset:12160
    s_mov_b64 exec, s[98:99]
    ds_read_b64 v[28:29], v115 offset:16384
    s_mov_b64 exec, -1
    v_exp_f32 v55, v55
    v_exp_f32 v56, v56
    v_cvt_pk_bf16_f32 v43, v54, v55
    v_exp_f32 v57, v57
    v_exp_f32 v58, v58
    v_cvt_pk_bf16_f32 v44, v56, v57
    s_waitcnt lgkmcnt(3)
    v_mfma_f32_32x32x16_bf16 v[80:95], v[32:35], v[40:43], v[80:95]
    v_exp_f32 v59, v59
    v_exp_f32 v60, v60
    v_cvt_pk_bf16_f32 v45, v58, v59
    v_exp_f32 v61, v61
    v_exp_f32 v62, v62
    v_exp_f32 v63, v63
    v_cvt_pk_bf16_f32 v46, v60, v61
    v_cvt_pk_bf16_f32 v47, v62, v63
    s_waitcnt lgkmcnt(2)
    v_mfma_f32_32x32x16_bf16 v[48:63], v[24:27], v[12:15], 0
    v_exp_f32 v64, v64
    v_exp_f32 v65, v65
    v_exp_f32 v66, v66
    v_cvt_pk_bf16_f32 v40, v64, v65
    v_exp_f32 v67, v67
    s_waitcnt lgkmcnt(0)
    v_mfma_f32_32x32x16_bf16 v[80:95], v[36:39], v[44:47], v[80:95]
    v_exp_f32 v68, v68
    v_cvt_pk_bf16_f32 v41, v66, v67
    v_exp_f32 v69, v69
    v_exp_f32 v70, v70
    v_cvt_pk_bf16_f32 v42, v68, v69
    v_mfma_f32_32x32x8_bf16 v[48:63], v[28:29], v[20:21], v[48:63]
    v_exp_f32 v71, v71
    v_exp_f32 v72, v72
    v_cvt_pk_bf16_f32 v43, v70, v71
    v_exp_f32 v73, v73
    v_exp_f32 v74, v74
    v_cvt_pk_bf16_f32 v44, v72, v73
    v_mfma_f32_32x32x16_bf16 v[96:111], v[32:35], v[40:43], v[96:111]
    s_mov_b64 exec, s[40:41]
    ds_read_b128 v[32:35], v117 offset:16640
    s_mov_b64 exec, -1
    v_exp_f32 v75, v75
    v_exp_f32 v76, v76
    v_cvt_pk_bf16_f32 v45, v74, v75
    v_exp_f32 v77, v77
    v_exp_f32 v78, v78
    v_exp_f32 v79, v79
    v_cvt_pk_bf16_f32 v46, v76, v77
    v_cvt_pk_bf16_f32 v47, v78, v79
    v_mfma_f32_32x32x16_bf16 v[64:79], v[24:27], v[16:19], 0
    ds_read2st64_b64 v[24:27], v1 offset0:160 offset1:161
    v_exp_f32 v48, v48
    v_exp_f32 v49, v49
    v_exp_f32 v50, v50
    v_cvt_pk_bf16_f32 v40, v48, v49
    v_exp_f32 v51, v51
    v_mfma_f32_32x32x16_bf16 v[96:111], v[36:39], v[44:47], v[96:111]
    v_exp_f32 v52, v52
    v_cvt_pk_bf16_f32 v41, v50, v51
    v_exp_f32 v53, v53
    v_exp_f32 v54, v54
    v_cvt_pk_bf16_f32 v42, v52, v53
    v_mfma_f32_32x32x8_bf16 v[64:79], v[28:29], v[22:23], v[64:79]
    s_mov_b64 exec, s[40:41]
    ds_read_b128 v[36:39], v117 offset:17280
    s_mov_b64 exec, s[98:99]
    ds_read_b64 v[28:29], v115 offset:21504
    s_mov_b64 exec, -1
    v_exp_f32 v55, v55
    v_exp_f32 v56, v56
    v_cvt_pk_bf16_f32 v43, v54, v55
    v_exp_f32 v57, v57
    v_exp_f32 v58, v58
    v_cvt_pk_bf16_f32 v44, v56, v57
    s_waitcnt lgkmcnt(3)
    v_mfma_f32_32x32x16_bf16 v[80:95], v[32:35], v[40:43], v[80:95]
    v_exp_f32 v59, v59
    v_exp_f32 v60, v60
    v_cvt_pk_bf16_f32 v45, v58, v59
    v_exp_f32 v61, v61
    v_exp_f32 v62, v62
    v_exp_f32 v63, v63
    v_cvt_pk_bf16_f32 v46, v60, v61
    v_cvt_pk_bf16_f32 v47, v62, v63
    s_waitcnt lgkmcnt(2)
    v_mfma_f32_32x32x16_bf16 v[48:63], v[24:27], v[12:15], 0
    v_exp_f32 v64, v64
    v_exp_f32 v65, v65
    v_exp_f32 v66, v66
    v_cvt_pk_bf16_f32 v40, v64, v65
    v_exp_f32 v67, v67
    s_waitcnt lgkmcnt(0)
    v_mfma_f32_32x32x16_bf16 v[80:95], v[36:39], v[44:47], v[80:95]
    v_exp_f32 v68, v68
    v_cvt_pk_bf16_f32 v41, v66, v67
    v_exp_f32 v69, v69
    v_exp_f32 v70, v70
    v_cvt_pk_bf16_f32 v42, v68, v69
    v_mfma_f32_32x32x8_bf16 v[48:63], v[28:29], v[20:21], v[48:63]
    v_exp_f32 v71, v71
    v_exp_f32 v72, v72
    v_cvt_pk_bf16_f32 v43, v70, v71
    v_exp_f32 v73, v73
    v_exp_f32 v74, v74
    v_cvt_pk_bf16_f32 v44, v72, v73
    v_mfma_f32_32x32x16_bf16 v[96:111], v[32:35], v[40:43], v[96:111]
    s_mov_b64 exec, s[40:41]
    ds_read_b128 v[32:35], v117 offset:21760
    s_mov_b64 exec, -1
    v_exp_f32 v75, v75
    v_exp_f32 v76, v76
    v_cvt_pk_bf16_f32 v45, v74, v75
    v_exp_f32 v77, v77
    v_exp_f32 v78, v78
    v_exp_f32 v79, v79
    v_cvt_pk_bf16_f32 v46, v76, v77
    v_cvt_pk_bf16_f32 v47, v78, v79
    v_mfma_f32_32x32x16_bf16 v[64:79], v[24:27], v[16:19], 0
    s_mov_b32 s63, 0
L_A_KVW1:
    ds_read_b32 v9, v113 offset:136
    s_add_u32 s63, s63, 1
    s_waitcnt lgkmcnt(0)
    v_readfirstlane_b32 s88, v9
    s_cmp_gt_u32 s63, 200000
    s_cselect_b32 s88, 4, s88
    s_cmp_ge_u32 s88, 4
    s_cbranch_scc0 L_A_KVW1
    ds_read2st64_b64 v[24:27], v1 offset0:170 offset1:171
    v_exp_f32 v48, v48
    v_exp_f32 v49, v49
    v_exp_f32 v50, v50
    v_cvt_pk_bf16_f32 v40, v48, v49
    v_exp_f32 v51, v51
    v_mfma_f32_32x32x16_bf16 v[96:111], v[36:39], v[44:47], v[96:111]
    v_exp_f32 v52, v52
    v_cvt_pk_bf16_f32 v41, v50, v51
    v_exp_f32 v53, v53
    v_exp_f32 v54, v54
    v_cvt_pk_bf16_f32 v42, v52, v53
    v_mfma_f32_32x32x8_bf16 v[64:79], v[28:29], v[22:23], v[64:79]
    s_mov_b64 exec, s[40:41]
    ds_read_b128 v[36:39], v117 offset:22400
    s_mov_b64 exec, s[98:99]
    ds_read_b64 v[28:29], v115 offset:26624
    s_mov_b64 exec, -1
    v_exp_f32 v55, v55
    v_exp_f32 v56, v56
    v_cvt_pk_bf16_f32 v43, v54, v55
    v_exp_f32 v57, v57
    v_exp_f32 v58, v58
    v_cvt_pk_bf16_f32 v44, v56, v57
    s_waitcnt lgkmcnt(3)
    v_mfma_f32_32x32x16_bf16 v[80:95], v[32:35], v[40:43], v[80:95]
    v_exp_f32 v59, v59
    v_exp_f32 v60, v60
    v_cvt_pk_bf16_f32 v45, v58, v59
    v_exp_f32 v61, v61
    v_exp_f32 v62, v62
    v_exp_f32 v63, v63
    v_cvt_pk_bf16_f32 v46, v60, v61
    v_cvt_pk_bf16_f32 v47, v62, v63
    s_waitcnt lgkmcnt(2)
    v_mfma_f32_32x32x16_bf16 v[48:63], v[24:27], v[12:15], 0
    v_exp_f32 v64, v64
    v_exp_f32 v65, v65
    v_exp_f32 v66, v66
    v_cvt_pk_bf16_f32 v40, v64, v65
    v_exp_f32 v67, v67
    s_waitcnt lgkmcnt(0)
    v_mfma_f32_32x32x16_bf16 v[80:95], v[36:39], v[44:47], v[80:95]
    v_exp_f32 v68, v68
    v_cvt_pk_bf16_f32 v41, v66, v67
    v_exp_f32 v69, v69
    v_exp_f32 v70, v70
    v_cvt_pk_bf16_f32 v42, v68, v69
    v_mfma_f32_32x32x8_bf16 v[48:63], v[28:29], v[20:21], v[48:63]
    s_mov_b64 exec, 1
    ds_add_u32 v113, v6 offset:16
    s_mov_b64 exec, -1
    v_exp_f32 v71, v71
    v_exp_f32 v72, v72
    v_cvt_pk_bf16_f32 v43, v70, v71
    v_exp_f32 v73, v73
    v_exp_f32 v74, v74
    v_cvt_pk_bf16_f32 v44, v72, v73
    v_mfma_f32_32x32x16_bf16 v[96:111], v[32:35], v[40:43], v[96:111]
    s_mov_b64 exec, s[40:41]
    ds_read_b128 v[32:35], v117 offset:26880
    s_mov_b64 exec, -1
    v_exp_f32 v75, v75
    v_exp_f32 v76, v76
    v_cvt_pk_bf16_f32 v45, v74, v75
    v_exp_f32 v77, v77
    v_exp_f32 v78, v78
    v_exp_f32 v79, v79
    v_cvt_pk_bf16_f32 v46, v76, v77
    v_cvt_pk_bf16_f32 v47, v78, v79
    v_mfma_f32_32x32x16_bf16 v[64:79], v[24:27], v[16:19], 0
    ds_read2st64_b64 v[24:27], v1 offset0:180 offset1:181
    v_exp_f32 v48, v48
    v_exp_f32 v49, v49
    v_exp_f32 v50, v50
    v_cvt_pk_bf16_f32 v40, v48, v49
    v_exp_f32 v51, v51
    v_mfma_f32_32x32x16_bf16 v[96:111], v[36:39], v[44:47], v[96:111]
    v_exp_f32 v52, v52
    v_cvt_pk_bf16_f32 v41, v50, v51
    v_exp_f32 v53, v53
    v_exp_f32 v54, v54
    v_cvt_pk_bf16_f32 v42, v52, v53
    v_mfma_f32_32x32x8_bf16 v[64:79], v[28:29], v[22:23], v[64:79]
    s_mov_b64 exec, s[40:41]
    ds_read_b128 v[36:39], v117 offset:27520
    s_mov_b64 exec, s[98:99]
    ds_read_b64 v[28:29], v115 offset:31744
    s_mov_b64 exec, -1
    v_exp_f32 v55, v55
    v_exp_f32 v56, v56
    v_cvt_pk_bf16_f32 v43, v54, v55
    v_exp_f32 v57, v57
    v_exp_f32 v58, v58
    v_cvt_pk_bf16_f32 v44, v56, v57
    s_waitcnt lgkmcnt(3)
    v_mfma_f32_32x32x16_bf16 v[80:95], v[32:35], v[40:43], v[80:95]
    v_exp_f32 v59, v59
    v_exp_f32 v60, v60
    v_cvt_pk_bf16_f32 v45, v58, v59
    v_exp_f32 v61, v61
    v_exp_f32 v62, v62
    v_exp_f32 v63, v63
    v_cvt_pk_bf16_f32 v46, v60, v61
    v_cvt_pk_bf16_f32 v47, v62, v63
    s_waitcnt lgkmcnt(2)
    v_mfma_f32_32x32x16_bf16 v[48:63], v[24:27], v[12:15], 0
    v_exp_f32 v64, v64
    v_exp_f32 v65, v65
    v_exp_f32 v66, v66
    v_cvt_pk_bf16_f32 v40, v64, v65
    v_exp_f32 v67, v67
    s_waitcnt lgkmcnt(0)
    v_mfma_f32_32x32x16_bf16 v[80:95], v[36:39], v[44:47], v[80:95]
    v_exp_f32 v68, v68
    v_cvt_pk_bf16_f32 v41, v66, v67
    v_exp_f32 v69, v69
    v_exp_f32 v70, v70
    v_cvt_pk_bf16_f32 v42, v68, v69
    v_mfma_f32_32x32x8_bf16 v[48:63], v[28:29], v[20:21], v[48:63]
    v_exp_f32 v71, v71
    v_exp_f32 v72, v72
    v_cvt_pk_bf16_f32 v43, v70, v71
    v_exp_f32 v73, v73
    v_exp_f32 v74, v74
    v_cvt_pk_bf16_f32 v44, v72, v73
    v_mfma_f32_32x32x16_bf16 v[96:111], v[32:35], v[40:43], v[96:111]
    s_mov_b64 exec, s[40:41]
    ds_read_b128 v[32:35], v117 offset:32000
    s_mov_b64 exec, -1
    v_exp_f32 v75, v75
    v_exp_f32 v76, v76
    v_cvt_pk_bf16_f32 v45, v74, v75
    v_exp_f32 v77, v77
    v_exp_f32 v78, v78
    v_exp_f32 v79, v79
    v_cvt_pk_bf16_f32 v46, v76, v77
    v_cvt_pk_bf16_f32 v47, v78, v79
    v_mfma_f32_32x32x16_bf16 v[64:79], v[24:27], v[16:19], 0
    ds_read2st64_b64 v[24:27], v1 offset0:190 offset1:191
    v_exp_f32 v48, v48
    v_exp_f32 v49, v49
    v_exp_f32 v50, v50
    v_cvt_pk_bf16_f32 v40, v48, v49
    v_exp_f32 v51, v51
    v_mfma_f32_32x32x16_bf16 v[96:111], v[36:39], v[44:47], v[96:111]
    v_exp_f32 v52, v52
    v_cvt_pk_bf16_f32 v41, v50, v51
    v_exp_f32 v53, v53
    v_exp_f32 v54, v54
    v_cvt_pk_bf16_f32 v42, v52, v53
    v_mfma_f32_32x32x8_bf16 v[64:79], v[28:29], v[22:23], v[64:79]
    s_mov_b64 exec, s[40:41]
    ds_read_b128 v[36:39], v117 offset:32640
    s_mov_b64 exec, s[98:99]
    ds_read_b64 v[28:29], v115 offset:36864
    s_mov_b64 exec, -1
    v_exp_f32 v55, v55
    v_exp_f32 v56, v56
    v_cvt_pk_bf16_f32 v43, v54, v55
    v_exp_f32 v57, v57
    v_exp_f32 v58, v58
    v_cvt_pk_bf16_f32 v44, v56, v57
    s_waitcnt lgkmcnt(3)
    v_mfma_f32_32x32x16_bf16 v[80:95], v[32:35], v[40:43], v[80:95]
    v_exp_f32 v59, v59
    v_exp_f32 v60, v60
    v_cvt_pk_bf16_f32 v45, v58, v59
    v_exp_f32 v61, v61
    v_exp_f32 v62, v62
    v_exp_f32 v63, v63
    v_cvt_pk_bf16_f32 v46, v60, v61
    v_cvt_pk_bf16_f32 v47, v62, v63
    s_waitcnt lgkmcnt(2)
    v_mfma_f32_32x32x16_bf16 v[48:63], v[24:27], v[12:15], 0
    v_exp_f32 v64, v64
    v_exp_f32 v65, v65
    v_exp_f32 v66, v66
    v_cvt_pk_bf16_f32 v40, v64, v65
    v_exp_f32 v67, v67
    s_waitcnt lgkmcnt(0)
    v_mfma_f32_32x32x16_bf16 v[80:95], v[36:39], v[44:47], v[80:95]
    v_exp_f32 v68, v68
    v_cvt_pk_bf16_f32 v41, v66, v67
    v_exp_f32 v69, v69
    v_exp_f32 v70, v70
    v_cvt_pk_bf16_f32 v42, v68, v69
    v_mfma_f32_32x32x8_bf16 v[48:63], v[28:29], v[20:21], v[48:63]
    v_exp_f32 v71, v71
    v_exp_f32 v72, v72
    v_cvt_pk_bf16_f32 v43, v70, v71
    v_exp_f32 v73, v73
    v_exp_f32 v74, v74
    v_cvt_pk_bf16_f32 v44, v72, v73
    v_mfma_f32_32x32x16_bf16 v[96:111], v[32:35], v[40:43], v[96:111]
    s_mov_b64 exec, s[40:41]
    ds_read_b128 v[32:35], v117 offset:37120
    s_mov_b64 exec, -1
    v_exp_f32 v75, v75
    v_exp_f32 v76, v76
    v_cvt_pk_bf16_f32 v45, v74, v75
    v_exp_f32 v77, v77
    v_exp_f32 v78, v78
    v_exp_f32 v79, v79
    v_cvt_pk_bf16_f32 v46, v76, v77
    v_cvt_pk_bf16_f32 v47, v78, v79
    v_mfma_f32_32x32x16_bf16 v[64:79], v[24:27], v[16:19], 0
    ds_read2st64_b64 v[24:27], v1 offset0:200 offset1:201
    v_exp_f32 v48, v48
    v_exp_f32 v49, v49
    v_exp_f32 v50, v50
    v_cvt_pk_bf16_f32 v40, v48, v49
    v_exp_f32 v51, v51
    v_mfma_f32_32x32x16_bf16 v[96:111], v[36:39], v[44:47], v[96:111]
    v_exp_f32 v52, v52
    v_cvt_pk_bf16_f32 v41, v50, v51
    v_exp_f32 v53, v53
    v_exp_f32 v54, v54
    v_cvt_pk_bf16_f32 v42, v52, v53
    v_mfma_f32_32x32x8_bf16 v[64:79], v[28:29], v[22:23], v[64:79]
    s_mov_b64 exec, s[40:41]
    ds_read_b128 v[36:39], v117 offset:37760
    s_mov_b64 exec, s[98:99]
    ds_read_b64 v[28:29], v115 offset:41984
    s_mov_b64 exec, -1
    v_exp_f32 v55, v55
    v_exp_f32 v56, v56
    v_cvt_pk_bf16_f32 v43, v54, v55
    v_exp_f32 v57, v57
    v_exp_f32 v58, v58
    v_cvt_pk_bf16_f32 v44, v56, v57
    s_waitcnt lgkmcnt(3)
    v_mfma_f32_32x32x16_bf16 v[80:95], v[32:35], v[40:43], v[80:95]
    v_exp_f32 v59, v59
    v_exp_f32 v60, v60
    v_cvt_pk_bf16_f32 v45, v58, v59
    v_exp_f32 v61, v61
    v_exp_f32 v62, v62
    v_exp_f32 v63, v63
    v_cvt_pk_bf16_f32 v46, v60, v61
    v_cvt_pk_bf16_f32 v47, v62, v63
    s_waitcnt lgkmcnt(2)
    v_mfma_f32_32x32x16_bf16 v[48:63], v[24:27], v[12:15], 0
    v_exp_f32 v64, v64
    v_exp_f32 v65, v65
    v_exp_f32 v66, v66
    v_cvt_pk_bf16_f32 v40, v64, v65
    v_exp_f32 v67, v67
    s_waitcnt lgkmcnt(0)
    v_mfma_f32_32x32x16_bf16 v[80:95], v[36:39], v[44:47], v[80:95]
    v_exp_f32 v68, v68
    v_cvt_pk_bf16_f32 v41, v66, v67
    v_exp_f32 v69, v69
    v_exp_f32 v70, v70
    v_cvt_pk_bf16_f32 v42, v68, v69
    v_mfma_f32_32x32x8_bf16 v[48:63], v[28:29], v[20:21], v[48:63]
    v_exp_f32 v71, v71
    v_exp_f32 v72, v72
    v_cvt_pk_bf16_f32 v43, v70, v71
    v_exp_f32 v73, v73
    v_exp_f32 v74, v74
    v_cvt_pk_bf16_f32 v44, v72, v73
    v_mfma_f32_32x32x16_bf16 v[96:111], v[32:35], v[40:43], v[96:111]
    s_mov_b64 exec, s[40:41]
    ds_read_b128 v[32:35], v117 offset:42240
    s_mov_b64 exec, -1
    v_exp_f32 v75, v75
    v_exp_f32 v76, v76
    v_cvt_pk_bf16_f32 v45, v74, v75
    v_exp_f32 v77, v77
    v_exp_f32 v78, v78
    v_exp_f32 v79, v79
    v_cvt_pk_bf16_f32 v46, v76, v77
    v_cvt_pk_bf16_f32 v47, v78, v79
    s_setprio 2
    v_mfma_f32_32x32x16_bf16 v[64:79], v[24:27], v[16:19], 0
    ds_read2st64_b64 v[24:27], v1 offset0:210 offset1:211
    v_exp_f32 v48, v48
    v_exp_f32 v49, v49
    v_exp_f32 v50, v50
    v_cvt_pk_bf16_f32 v40, v48, v49
    v_exp_f32 v51, v51
    v_mfma_f32_32x32x16_bf16 v[96:111], v[36:39], v[44:47], v[96:111]
    v_exp_f32 v52, v52
    v_cvt_pk_bf16_f32 v41, v50, v51
    v_exp_f32 v53, v53
    v_exp_f32 v54, v54
    v_cvt_pk_bf16_f32 v42, v52, v53
    v_mfma_f32_32x32x8_bf16 v[64:79], v[28:29], v[22:23], v[64:79]
    s_mov_b64 exec, s[40:41]
    ds_read_b128 v[36:39], v117 offset:42880
    s_mov_b64 exec, s[98:99]
    ds_read_b64 v[28:29], v115 offset:47104
    s_mov_b64 exec, -1
    v_exp_f32 v55, v55
    v_exp_f32 v56, v56
    v_cvt_pk_bf16_f32 v43, v54, v55
    v_exp_f32 v57, v57
    v_exp_f32 v58, v58
    v_cvt_pk_bf16_f32 v44, v56, v57
    s_waitcnt lgkmcnt(3)
    v_mfma_f32_32x32x16_bf16 v[80:95], v[32:35], v[40:43], v[80:95]
    v_exp_f32 v59, v59
    v_exp_f32 v60, v60
    v_cvt_pk_bf16_f32 v45, v58, v59
    v_exp_f32 v61, v61
    v_exp_f32 v62, v62
    v_exp_f32 v63, v63
    v_cvt_pk_bf16_f32 v46, v60, v61
    v_cvt_pk_bf16_f32 v47, v62, v63
    s_waitcnt lgkmcnt(2)
    v_mfma_f32_32x32x16_bf16 v[48:63], v[24:27], v[12:15], 0
    v_exp_f32 v64, v64
    v_exp_f32 v65, v65
    v_exp_f32 v66, v66
    v_cvt_pk_bf16_f32 v40, v64, v65
    v_exp_f32 v67, v67
    s_waitcnt lgkmcnt(0)
    v_mfma_f32_32x32x16_bf16 v[80:95], v[36:39], v[44:47], v[80:95]
    v_exp_f32 v68, v68
    v_cvt_pk_bf16_f32 v41, v66, v67
    v_exp_f32 v69, v69
    v_exp_f32 v70, v70
    v_cvt_pk_bf16_f32 v42, v68, v69
    v_mfma_f32_32x32x8_bf16 v[48:63], v[28:29], v[20:21], v[48:63]
    s_mov_b64 exec, 1
    ds_add_u32 v113, v6 offset:20
    s_mov_b64 exec, -1
    v_exp_f32 v71, v71
    v_exp_f32 v72, v72
    v_cvt_pk_bf16_f32 v43, v70, v71
    v_exp_f32 v73, v73
    v_exp_f32 v74, v74
    v_cvt_pk_bf16_f32 v44, v72, v73
    v_mfma_f32_32x32x16_bf16 v[96:111], v[32:35], v[40:43], v[96:111]
    s_mov_b64 exec, s[40:41]
    ds_read_b128 v[32:35], v117 offset:47360
    s_mov_b64 exec, -1
    v_exp_f32 v75, v75
    v_exp_f32 v76, v76
    v_cvt_pk_bf16_f32 v45, v74, v75
    v_exp_f32 v77, v77
    v_exp_f32 v78, v78
    v_exp_f32 v79, v79
    v_cvt_pk_bf16_f32 v46, v76, v77
    v_cvt_pk_bf16_f32 v47, v78, v79
    v_mfma_f32_32x32x16_bf16 v[64:79], v[24:27], v[16:19], 0
    s_mov_b32 s63, 0
L_A_KVW2:
    ds_read_b32 v9, v113 offset:136
    s_add_u32 s63, s63, 1
    s_waitcnt lgkmcnt(0)
    v_readfirstlane_b32 s88, v9
    s_cmp_gt_u32 s63, 200000
    s_cselect_b32 s88, 5, s88
    s_cmp_ge_u32 s88, 5
    s_cbranch_scc0 L_A_KVW2
    ds_read2st64_b64 v[24:27], v1 offset0:220 offset1:221
    v_exp_f32 v48, v48
    v_exp_f32 v49, v49
    v_exp_f32 v50, v50
    v_cvt_pk_bf16_f32 v40, v48, v49
    v_exp_f32 v51, v51
    v_mfma_f32_32x32x16_bf16 v[96:111], v[36:39], v[44:47], v[96:111]
    v_exp_f32 v52, v52
    v_cvt_pk_bf16_f32 v41, v50, v51
    v_exp_f32 v53, v53
    v_exp_f32 v54, v54
    v_cvt_pk_bf16_f32 v42, v52, v53
    v_mfma_f32_32x32x8_bf16 v[64:79], v[28:29], v[22:23], v[64:79]
    s_mov_b64 exec, s[40:41]
    ds_read_b128 v[36:39], v117 offset:48000
    s_mov_b64 exec, s[98:99]
    ds_read_b64 v[28:29], v115 offset:52224
    s_mov_b64 exec, -1
    v_exp_f32 v55, v55
    v_exp_f32 v56, v56
    v_cvt_pk_bf16_f32 v43, v54, v55
    v_exp_f32 v57, v57
    v_exp_f32 v58, v58
    v_cvt_pk_bf16_f32 v44, v56, v57
    s_waitcnt lgkmcnt(3)
    v_mfma_f32_32x32x16_bf16 v[80:95], v[32:35], v[40:43], v[80:95]
    v_exp_f32 v59, v59
    v_exp_f32 v60, v60
    v_cvt_pk_bf16_f32 v45, v58, v59
    v_exp_f32 v61, v61
    v_exp_f32 v62, v62
    v_exp_f32 v63, v63
    v_cvt_pk_bf16_f32 v46, v60, v61
    v_cvt_pk_bf16_f32 v47, v62, v63
    s_waitcnt lgkmcnt(2)
    v_mfma_f32_32x32x16_bf16 v[48:63], v[24:27], v[12:15], 0
    v_exp_f32 v64, v64
    v_exp_f32 v65, v65
    v_exp_f32 v66, v66
    v_cvt_pk_bf16_f32 v40, v64, v65
    v_exp_f32 v67, v67
    s_waitcnt lgkmcnt(0)
    v_mfma_f32_32x32x16_bf16 v[80:95], v[36:39], v[44:47], v[80:95]
    v_exp_f32 v68, v68
    v_cvt_pk_bf16_f32 v41, v66, v67
    v_exp_f32 v69, v69
    v_exp_f32 v70, v70
    v_cvt_pk_bf16_f32 v42, v68, v69
    v_mfma_f32_32x32x8_bf16 v[48:63], v[28:29], v[20:21], v[48:63]
    v_exp_f32 v71, v71
    v_exp_f32 v72, v72
    v_cvt_pk_bf16_f32 v43, v70, v71
    v_exp_f32 v73, v73
    v_exp_f32 v74, v74
    v_cvt_pk_bf16_f32 v44, v72, v73
    v_mfma_f32_32x32x16_bf16 v[96:111], v[32:35], v[40:43], v[96:111]
    s_mov_b64 exec, s[40:41]
    ds_read_b128 v[32:35], v117 offset:52480
    s_mov_b64 exec, -1
    v_exp_f32 v75, v75
    v_exp_f32 v76, v76
    v_cvt_pk_bf16_f32 v45, v74, v75
    v_exp_f32 v77, v77
    v_exp_f32 v78, v78
    v_exp_f32 v79, v79
    v_cvt_pk_bf16_f32 v46, v76, v77
    v_cvt_pk_bf16_f32 v47, v78, v79
    v_mfma_f32_32x32x16_bf16 v[64:79], v[24:27], v[16:19], 0
    ds_read2st64_b64 v[24:27], v1 offset0:230 offset1:231
    v_exp_f32 v48, v48
    v_exp_f32 v49, v49
    v_exp_f32 v50, v50
    v_cvt_pk_bf16_f32 v40, v48, v49
    v_exp_f32 v51, v51
    v_mfma_f32_32x32x16_bf16 v[96:111], v[36:39], v[44:47], v[96:111]
    v_exp_f32 v52, v52
    v_cvt_pk_bf16_f32 v41, v50, v51
    v_exp_f32 v53, v53
    v_exp_f32 v54, v54
    v_cvt_pk_bf16_f32 v42, v52, v53
    v_mfma_f32_32x32x8_bf16 v[64:79], v[28:29], v[22:23], v[64:79]
    s_mov_b64 exec, s[40:41]
    ds_read_b128 v[36:39], v117 offset:53120
    s_mov_b64 exec, s[98:99]
    ds_read_b64 v[28:29], v115 offset:57344
    s_mov_b64 exec, -1
    v_exp_f32 v55, v55
    v_exp_f32 v56, v56
    v_cvt_pk_bf16_f32 v43, v54, v55
    v_exp_f32 v57, v57
    v_exp_f32 v58, v58
    v_cvt_pk_bf16_f32 v44, v56, v57
    s_waitcnt lgkmcnt(3)
    v_mfma_f32_32x32x16_bf16 v[80:95], v[32:35], v[40:43], v[80:95]
    v_exp_f32 v59, v59
    v_exp_f32 v60, v60
    v_cvt_pk_bf16_f32 v45, v58, v59
    v_exp_f32 v61, v61
    v_exp_f32 v62, v62
    v_exp_f32 v63, v63
    v_cvt_pk_bf16_f32 v46, v60, v61
    v_cvt_pk_bf16_f32 v47, v62, v63
    s_waitcnt lgkmcnt(2)
    v_mfma_f32_32x32x16_bf16 v[48:63], v[24:27], v[12:15], 0
    v_exp_f32 v64, v64
    v_exp_f32 v65, v65
    v_exp_f32 v66, v66
    v_cvt_pk_bf16_f32 v40, v64, v65
    v_exp_f32 v67, v67
    s_waitcnt lgkmcnt(0)
    v_mfma_f32_32x32x16_bf16 v[80:95], v[36:39], v[44:47], v[80:95]
    v_exp_f32 v68, v68
    v_cvt_pk_bf16_f32 v41, v66, v67
    v_exp_f32 v69, v69
    v_exp_f32 v70, v70
    v_cvt_pk_bf16_f32 v42, v68, v69
    v_mfma_f32_32x32x8_bf16 v[48:63], v[28:29], v[20:21], v[48:63]
    v_exp_f32 v71, v71
    v_exp_f32 v72, v72
    v_cvt_pk_bf16_f32 v43, v70, v71
    v_exp_f32 v73, v73
    v_exp_f32 v74, v74
    v_cvt_pk_bf16_f32 v44, v72, v73
    v_mfma_f32_32x32x16_bf16 v[96:111], v[32:35], v[40:43], v[96:111]
    s_mov_b64 exec, s[40:41]
    ds_read_b128 v[32:35], v117 offset:57600
    s_mov_b64 exec, -1
    v_exp_f32 v75, v75
    v_exp_f32 v76, v76
    v_cvt_pk_bf16_f32 v45, v74, v75
    v_exp_f32 v77, v77
    v_exp_f32 v78, v78
    v_exp_f32 v79, v79
    v_cvt_pk_bf16_f32 v46, v76, v77
    v_cvt_pk_bf16_f32 v47, v78, v79
    v_mfma_f32_32x32x16_bf16 v[64:79], v[24:27], v[16:19], 0
    ds_read2st64_b64 v[24:27], v114 offset0:0 offset1:1
    v_exp_f32 v48, v48
    v_exp_f32 v49, v49
    v_exp_f32 v50, v50
    v_cvt_pk_bf16_f32 v40, v48, v49
    v_exp_f32 v51, v51
    v_mfma_f32_32x32x16_bf16 v[96:111], v[36:39], v[44:47], v[96:111]
    v_exp_f32 v52, v52
    v_cvt_pk_bf16_f32 v41, v50, v51
    v_exp_f32 v53, v53
    v_exp_f32 v54, v54
    v_cvt_pk_bf16_f32 v42, v52, v53
    v_mfma_f32_32x32x8_bf16 v[64:79], v[28:29], v[22:23], v[64:79]
    s_mov_b64 exec, s[40:41]
    ds_read_b128 v[36:39], v117 offset:58240
    s_mov_b64 exec, s[98:99]
    ds_read_b64 v[28:29], v116 offset:1024
    s_mov_b64 exec, -1
    v_exp_f32 v55, v55
    v_exp_f32 v56, v56
    v_cvt_pk_bf16_f32 v43, v54, v55
    v_exp_f32 v57, v57
    v_exp_f32 v58, v58
    v_cvt_pk_bf16_f32 v44, v56, v57
    s_waitcnt lgkmcnt(3)
    v_mfma_f32_32x32x16_bf16 v[80:95], v[32:35], v[40:43], v[80:95]
    v_exp_f32 v59, v59
    v_exp_f32 v60, v60
    v_cvt_pk_bf16_f32 v45, v58, v59
    v_exp_f32 v61, v61
    v_exp_f32 v62, v62
    v_exp_f32 v63, v63
    v_cvt_pk_bf16_f32 v46, v60, v61
    v_cvt_pk_bf16_f32 v47, v62, v63
    s_waitcnt lgkmcnt(2)
    v_mfma_f32_32x32x16_bf16 v[48:63], v[24:27], v[12:15], 0
    v_exp_f32 v64, v64
    v_exp_f32 v65, v65
    v_exp_f32 v66, v66
    v_cvt_pk_bf16_f32 v40, v64, v65
    v_exp_f32 v67, v67
    s_waitcnt lgkmcnt(0)
    v_mfma_f32_32x32x16_bf16 v[80:95], v[36:39], v[44:47], v[80:95]
    v_exp_f32 v68, v68
    v_cvt_pk_bf16_f32 v41, v66, v67
    v_exp_f32 v69, v69
    v_exp_f32 v70, v70
    v_cvt_pk_bf16_f32 v42, v68, v69
    v_mfma_f32_32x32x8_bf16 v[48:63], v[28:29], v[20:21], v[48:63]
    v_exp_f32 v71, v71
    v_exp_f32 v72, v72
    v_cvt_pk_bf16_f32 v43, v70, v71
    v_exp_f32 v73, v73
    v_exp_f32 v74, v74
    v_cvt_pk_bf16_f32 v44, v72, v73
    v_mfma_f32_32x32x16_bf16 v[96:111], v[32:35], v[40:43], v[96:111]
    s_mov_b64 exec, s[40:41]
    ds_read_b128 v[32:35], v118 offset:1280
    s_mov_b64 exec, -1
    v_exp_f32 v75, v75
    v_exp_f32 v76, v76
    v_cvt_pk_bf16_f32 v45, v74, v75
    v_exp_f32 v77, v77
    v_exp_f32 v78, v78
    v_exp_f32 v79, v79
    v_cvt_pk_bf16_f32 v46, v76, v77
    v_cvt_pk_bf16_f32 v47, v78, v79
    v_mfma_f32_32x32x16_bf16 v[64:79], v[24:27], v[16:19], 0
    ds_read2st64_b64 v[24:27], v114 offset0:10 offset1:11
    v_exp_f32 v48, v48
    v_exp_f32 v49, v49
    v_exp_f32 v50, v50
    v_cvt_pk_bf16_f32 v40, v48, v49
    v_exp_f32 v51, v51
    v_mfma_f32_32x32x16_bf16 v[96:111], v[36:39], v[44:47], v[96:111]
    v_exp_f32 v52, v52
    v_cvt_pk_bf16_f32 v41, v50, v51
    v_exp_f32 v53, v53
    v_exp_f32 v54, v54
    v_cvt_pk_bf16_f32 v42, v52, v53
    v_mfma_f32_32x32x8_bf16 v[64:79], v[28:29], v[22:23], v[64:79]
    s_mov_b64 exec, s[40:41]
    ds_read_b128 v[36:39], v118 offset:1920
    s_mov_b64 exec, s[98:99]
    ds_read_b64 v[28:29], v116 offset:6144
    s_mov_b64 exec, -1
    v_exp_f32 v55, v55
    v_exp_f32 v56, v56
    v_cvt_pk_bf16_f32 v43, v54, v55
    v_exp_f32 v57, v57
    v_exp_f32 v58, v58
    v_cvt_pk_bf16_f32 v44, v56, v57
    s_waitcnt lgkmcnt(3)
    v_mfma_f32_32x32x16_bf16 v[80:95], v[32:35], v[40:43], v[80:95]
    v_exp_f32 v59, v59
    v_exp_f32 v60, v60
    v_cvt_pk_bf16_f32 v45, v58, v59
    v_exp_f32 v61, v61
    v_exp_f32 v62, v62
    v_exp_f32 v63, v63
    v_cvt_pk_bf16_f32 v46, v60, v61
    v_cvt_pk_bf16_f32 v47, v62, v63
    s_waitcnt lgkmcnt(2)
    v_mfma_f32_32x32x16_bf16 v[48:63], v[24:27], v[12:15], 0
    v_exp_f32 v64, v64
    v_exp_f32 v65, v65
    v_exp_f32 v66, v66
    v_cvt_pk_bf16_f32 v40, v64, v65
    v_exp_f32 v67, v67
    s_waitcnt lgkmcnt(0)
    v_mfma_f32_32x32x16_bf16 v[80:95], v[36:39], v[44:47], v[80:95]
    v_exp_f32 v68, v68
    v_cvt_pk_bf16_f32 v41, v66, v67
    v_exp_f32 v69, v69
    v_exp_f32 v70, v70
    v_cvt_pk_bf16_f32 v42, v68, v69
    v_mfma_f32_32x32x8_bf16 v[48:63], v[28:29], v[20:21], v[48:63]
    v_exp_f32 v71, v71
    v_exp_f32 v72, v72
    v_cvt_pk_bf16_f32 v43, v70, v71
    v_exp_f32 v73, v73
    v_exp_f32 v74, v74
    v_cvt_pk_bf16_f32 v44, v72, v73
    v_mfma_f32_32x32x16_bf16 v[96:111], v[32:35], v[40:43], v[96:111]
    s_mov_b64 exec, s[40:41]
    ds_read_b128 v[32:35], v118 offset:6400
    s_mov_b64 exec, -1
    v_exp_f32 v75, v75
    v_exp_f32 v76, v76
    v_cvt_pk_bf16_f32 v45, v74, v75
    v_exp_f32 v77, v77
    v_exp_f32 v78, v78
    v_exp_f32 v79, v79
    v_cvt_pk_bf16_f32 v46, v76, v77
    v_cvt_pk_bf16_f32 v47, v78, v79
    v_mfma_f32_32x32x16_bf16 v[64:79], v[24:27], v[16:19], 0
    ds_read2st64_b64 v[24:27], v114 offset0:20 offset1:21
    v_exp_f32 v48, v48
    v_exp_f32 v49, v49
    v_exp_f32 v50, v50
    v_cvt_pk_bf16_f32 v40, v48, v49
    v_exp_f32 v51, v51
    v_mfma_f32_32x32x16_bf16 v[96:111], v[36:39], v[44:47], v[96:111]
    v_exp_f32 v52, v52
    v_cvt_pk_bf16_f32 v41, v50, v51
    v_exp_f32 v53, v53
    v_exp_f32 v54, v54
    v_cvt_pk_bf16_f32 v42, v52, v53
    v_mfma_f32_32x32x8_bf16 v[64:79], v[28:29], v[22:23], v[64:79]
    s_mov_b64 exec, s[40:41]
    ds_read_b128 v[36:39], v118 offset:7040
    s_mov_b64 exec, s[98:99]
    ds_read_b64 v[28:29], v116 offset:11264
    s_mov_b64 exec, -1
    v_exp_f32 v55, v55
    v_exp_f32 v56, v56
    v_cvt_pk_bf16_f32 v43, v54, v55
    v_exp_f32 v57, v57
    v_exp_f32 v58, v58
    v_cvt_pk_bf16_f32 v44, v56, v57
    s_waitcnt lgkmcnt(3)
    v_mfma_f32_32x32x16_bf16 v[80:95], v[32:35], v[40:43], v[80:95]
    v_exp_f32 v59, v59
    v_exp_f32 v60, v60
    v_cvt_pk_bf16_f32 v45, v58, v59
    v_exp_f32 v61, v61
    v_exp_f32 v62, v62
    v_exp_f32 v63, v63
    v_cvt_pk_bf16_f32 v46, v60, v61
    v_cvt_pk_bf16_f32 v47, v62, v63
    s_waitcnt lgkmcnt(2)
    v_mfma_f32_32x32x16_bf16 v[48:63], v[24:27], v[12:15], 0
    v_exp_f32 v64, v64
    v_exp_f32 v65, v65
    v_exp_f32 v66, v66
    v_cvt_pk_bf16_f32 v40, v64, v65
    v_exp_f32 v67, v67
    s_waitcnt lgkmcnt(0)
    v_mfma_f32_32x32x16_bf16 v[80:95], v[36:39], v[44:47], v[80:95]
    v_exp_f32 v68, v68
    v_cvt_pk_bf16_f32 v41, v66, v67
    v_exp_f32 v69, v69
    v_exp_f32 v70, v70
    v_cvt_pk_bf16_f32 v42, v68, v69
    v_mfma_f32_32x32x8_bf16 v[48:63], v[28:29], v[20:21], v[48:63]
    v_exp_f32 v71, v71
    v_exp_f32 v72, v72
    v_cvt_pk_bf16_f32 v43, v70, v71
    v_exp_f32 v73, v73
    v_exp_f32 v74, v74
    v_cvt_pk_bf16_f32 v44, v72, v73
    v_mfma_f32_32x32x16_bf16 v[96:111], v[32:35], v[40:43], v[96:111]
    s_mov_b64 exec, s[40:41]
    ds_read_b128 v[32:35], v118 offset:11520
    s_mov_b64 exec, -1
    v_exp_f32 v75, v75
    v_exp_f32 v76, v76
    v_cvt_pk_bf16_f32 v45, v74, v75
    v_exp_f32 v77, v77
    v_exp_f32 v78, v78
    v_exp_f32 v79, v79
    v_cvt_pk_bf16_f32 v46, v76, v77
    v_cvt_pk_bf16_f32 v47, v78, v79
    v_mfma_f32_32x32x16_bf16 v[64:79], v[24:27], v[16:19], 0
    ds_read2st64_b64 v[24:27], v114 offset0:30 offset1:31
    v_exp_f32 v48, v48
    v_exp_f32 v49, v49
    v_exp_f32 v50, v50
    v_cvt_pk_bf16_f32 v40, v48, v49
    v_exp_f32 v51, v51
    v_mfma_f32_32x32x16_bf16 v[96:111], v[36:39], v[44:47], v[96:111]
    v_exp_f32 v52, v52
    v_cvt_pk_bf16_f32 v41, v50, v51
    v_exp_f32 v53, v53
    v_exp_f32 v54, v54
    v_cvt_pk_bf16_f32 v42, v52, v53
    v_mfma_f32_32x32x8_bf16 v[64:79], v[28:29], v[22:23], v[64:79]
    s_mov_b64 exec, s[40:41]
    ds_read_b128 v[36:39], v118 offset:12160
    s_mov_b64 exec, s[98:99]
    ds_read_b64 v[28:29], v116 offset:16384
    s_mov_b64 exec, -1
    v_exp_f32 v55, v55
    v_exp_f32 v56, v56
    v_cvt_pk_bf16_f32 v43, v54, v55
    v_exp_f32 v57, v57
    v_exp_f32 v58, v58
    v_cvt_pk_bf16_f32 v44, v56, v57
    s_waitcnt lgkmcnt(3)
    v_mfma_f32_32x32x16_bf16 v[80:95], v[32:35], v[40:43], v[80:95]
    v_exp_f32 v59, v59
    v_exp_f32 v60, v60
    v_cvt_pk_bf16_f32 v45, v58, v59
    v_exp_f32 v61, v61
    v_exp_f32 v62, v62
    v_exp_f32 v63, v63
    v_cvt_pk_bf16_f32 v46, v60, v61
    v_cvt_pk_bf16_f32 v47, v62, v63
    s_waitcnt lgkmcnt(2)
    v_mfma_f32_32x32x16_bf16 v[48:63], v[24:27], v[12:15], 0
    v_exp_f32 v64, v64
    v_exp_f32 v65, v65
    v_exp_f32 v66, v66
    v_cvt_pk_bf16_f32 v40, v64, v65
    v_exp_f32 v67, v67
    s_waitcnt lgkmcnt(0)
    v_mfma_f32_32x32x16_bf16 v[80:95], v[36:39], v[44:47], v[80:95]
    v_exp_f32 v68, v68
    v_cvt_pk_bf16_f32 v41, v66, v67
    v_exp_f32 v69, v69
    v_exp_f32 v70, v70
    v_cvt_pk_bf16_f32 v42, v68, v69
    v_mfma_f32_32x32x8_bf16 v[48:63], v[28:29], v[20:21], v[48:63]
    v_exp_f32 v71, v71
    v_exp_f32 v72, v72
    v_cvt_pk_bf16_f32 v43, v70, v71
    v_exp_f32 v73, v73
    v_exp_f32 v74, v74
    v_cvt_pk_bf16_f32 v44, v72, v73
    v_mfma_f32_32x32x16_bf16 v[96:111], v[32:35], v[40:43], v[96:111]
    s_mov_b64 exec, s[40:41]
    ds_read_b128 v[32:35], v118 offset:16640
    s_mov_b64 exec, -1
    v_exp_f32 v75, v75
    v_exp_f32 v76, v76
    v_cvt_pk_bf16_f32 v45, v74, v75
    v_exp_f32 v77, v77
    v_exp_f32 v78, v78
    v_exp_f32 v79, v79
    v_cvt_pk_bf16_f32 v46, v76, v77
    v_cvt_pk_bf16_f32 v47, v78, v79
    v_mfma_f32_32x32x16_bf16 v[64:79], v[24:27], v[16:19], 0
    ds_read2st64_b64 v[24:27], v114 offset0:40 offset1:41
    v_exp_f32 v48, v48
    v_exp_f32 v49, v49
    v_exp_f32 v50, v50
    v_cvt_pk_bf16_f32 v40, v48, v49
    v_exp_f32 v51, v51
    v_mfma_f32_32x32x16_bf16 v[96:111], v[36:39], v[44:47], v[96:111]
    v_exp_f32 v52, v52
    v_cvt_pk_bf16_f32 v41, v50, v51
    v_exp_f32 v53, v53
    v_exp_f32 v54, v54
    v_cvt_pk_bf16_f32 v42, v52, v53
    v_mfma_f32_32x32x8_bf16 v[64:79], v[28:29], v[22:23], v[64:79]
    s_mov_b64 exec, s[40:41]
    ds_read_b128 v[36:39], v118 offset:17280
    s_mov_b64 exec, s[98:99]
    ds_read_b64 v[28:29], v116 offset:21504
    s_mov_b64 exec, -1
    v_exp_f32 v55, v55
    v_exp_f32 v56, v56
    v_cvt_pk_bf16_f32 v43, v54, v55
    v_exp_f32 v57, v57
    v_exp_f32 v58, v58
    v_cvt_pk_bf16_f32 v44, v56, v57
    s_waitcnt lgkmcnt(3)
    v_mfma_f32_32x32x16_bf16 v[80:95], v[32:35], v[40:43], v[80:95]
    v_exp_f32 v59, v59
    v_exp_f32 v60, v60
    v_cvt_pk_bf16_f32 v45, v58, v59
    v_exp_f32 v61, v61
    v_exp_f32 v62, v62
    v_exp_f32 v63, v63
    v_cvt_pk_bf16_f32 v46, v60, v61
    v_cvt_pk_bf16_f32 v47, v62, v63
    s_waitcnt lgkmcnt(2)
    v_mfma_f32_32x32x16_bf16 v[48:63], v[24:27], v[12:15], 0
    v_exp_f32 v64, v64
    v_exp_f32 v65, v65
    v_exp_f32 v66, v66
    v_cvt_pk_bf16_f32 v40, v64, v65
    v_exp_f32 v67, v67
    s_waitcnt lgkmcnt(0)
    v_mfma_f32_32x32x16_bf16 v[80:95], v[36:39], v[44:47], v[80:95]
    v_exp_f32 v68, v68
    v_cvt_pk_bf16_f32 v41, v66, v67
    v_exp_f32 v69, v69
    v_exp_f32 v70, v70
    v_cvt_pk_bf16_f32 v42, v68, v69
    v_mfma_f32_32x32x8_bf16 v[48:63], v[28:29], v[20:21], v[48:63]
    v_exp_f32 v71, v71
    v_exp_f32 v72, v72
    v_cvt_pk_bf16_f32 v43, v70, v71
    v_exp_f32 v73, v73
    v_exp_f32 v74, v74
    v_cvt_pk_bf16_f32 v44, v72, v73
    v_mfma_f32_32x32x16_bf16 v[96:111], v[32:35], v[40:43], v[96:111]
    s_mov_b64 exec, s[40:41]
    ds_read_b128 v[32:35], v118 offset:21760
    s_mov_b64 exec, -1
    v_exp_f32 v75, v75
    v_exp_f32 v76, v76
    v_cvt_pk_bf16_f32 v45, v74, v75
    v_exp_f32 v77, v77
    v_exp_f32 v78, v78
    v_exp_f32 v79, v79
    v_cvt_pk_bf16_f32 v46, v76, v77
    v_cvt_pk_bf16_f32 v47, v78, v79
    s_setprio 1
    v_mfma_f32_32x32x16_bf16 v[64:79], v[24:27], v[16:19], 0
    ds_read2st64_b64 v[24:27], v114 offset0:50 offset1:51
    v_exp_f32 v48, v48
    v_exp_f32 v49, v49
    v_exp_f32 v50, v50
    v_cvt_pk_bf16_f32 v40, v48, v49
    v_exp_f32 v51, v51
    v_mfma_f32_32x32x16_bf16 v[96:111], v[36:39], v[44:47], v[96:111]
    v_exp_f32 v52, v52
    v_cvt_pk_bf16_f32 v41, v50, v51
    v_exp_f32 v53, v53
    v_exp_f32 v54, v54
    v_cvt_pk_bf16_f32 v42, v52, v53
    v_mfma_f32_32x32x8_bf16 v[64:79], v[28:29], v[22:23], v[64:79]
    s_mov_b64 exec, s[40:41]
    ds_read_b128 v[36:39], v118 offset:22400
    s_mov_b64 exec, s[98:99]
    ds_read_b64 v[28:29], v116 offset:26624
    s_mov_b64 exec, -1
    v_exp_f32 v55, v55
    v_exp_f32 v56, v56
    v_cvt_pk_bf16_f32 v43, v54, v55
    v_exp_f32 v57, v57
    v_exp_f32 v58, v58
    v_cvt_pk_bf16_f32 v44, v56, v57
    s_waitcnt lgkmcnt(3)
    v_mfma_f32_32x32x16_bf16 v[80:95], v[32:35], v[40:43], v[80:95]
    v_exp_f32 v59, v59
    v_exp_f32 v60, v60
    v_cvt_pk_bf16_f32 v45, v58, v59
    v_exp_f32 v61, v61
    v_exp_f32 v62, v62
    v_exp_f32 v63, v63
    v_cvt_pk_bf16_f32 v46, v60, v61
    v_cvt_pk_bf16_f32 v47, v62, v63
    s_waitcnt lgkmcnt(2)
    v_mfma_f32_32x32x16_bf16 v[48:63], v[24:27], v[12:15], 0
    v_exp_f32 v64, v64
    v_exp_f32 v65, v65
    v_exp_f32 v66, v66
    v_cvt_pk_bf16_f32 v40, v64, v65
    v_exp_f32 v67, v67
    s_waitcnt lgkmcnt(0)
    v_mfma_f32_32x32x16_bf16 v[80:95], v[36:39], v[44:47], v[80:95]
    v_exp_f32 v68, v68
    v_cvt_pk_bf16_f32 v41, v66, v67
    v_exp_f32 v69, v69
    v_exp_f32 v70, v70
    v_cvt_pk_bf16_f32 v42, v68, v69
    v_mfma_f32_32x32x8_bf16 v[48:63], v[28:29], v[20:21], v[48:63]
    s_mov_b64 exec, 1
    ds_add_u32 v113, v6 offset:28
    s_mov_b64 exec, -1
    v_exp_f32 v71, v71
    v_exp_f32 v72, v72
    v_cvt_pk_bf16_f32 v43, v70, v71
    v_exp_f32 v73, v73
    v_exp_f32 v74, v74
    v_cvt_pk_bf16_f32 v44, v72, v73
    v_mfma_f32_32x32x16_bf16 v[96:111], v[32:35], v[40:43], v[96:111]
    s_mov_b64 exec, s[40:41]
    ds_read_b128 v[32:35], v118 offset:26880
    s_mov_b64 exec, -1
    v_exp_f32 v75, v75
    v_exp_f32 v76, v76
    v_cvt_pk_bf16_f32 v45, v74, v75
    v_exp_f32 v77, v77
    v_exp_f32 v78, v78
    v_exp_f32 v79, v79
    v_cvt_pk_bf16_f32 v46, v76, v77
    v_cvt_pk_bf16_f32 v47, v78, v79
    v_mfma_f32_32x32x16_bf16 v[64:79], v[24:27], v[16:19], 0
    ds_read2st64_b64 v[24:27], v114 offset0:60 offset1:61
    v_exp_f32 v48, v48
    v_exp_f32 v49, v49
    v_exp_f32 v50, v50
    v_cvt_pk_bf16_f32 v40, v48, v49
    v_exp_f32 v51, v51
    v_mfma_f32_32x32x16_bf16 v[96:111], v[36:39], v[44:47], v[96:111]
    v_exp_f32 v52, v52
    v_cvt_pk_bf16_f32 v41, v50, v51
    v_exp_f32 v53, v53
    v_exp_f32 v54, v54
    v_cvt_pk_bf16_f32 v42, v52, v53
    v_mfma_f32_32x32x8_bf16 v[64:79], v[28:29], v[22:23], v[64:79]
    s_mov_b64 exec, s[40:41]
    ds_read_b128 v[36:39], v118 offset:27520
    s_mov_b64 exec, s[98:99]
    ds_read_b64 v[28:29], v116 offset:31744
    s_mov_b64 exec, -1
    v_exp_f32 v55, v55
    v_exp_f32 v56, v56
    v_cvt_pk_bf16_f32 v43, v54, v55
    v_exp_f32 v57, v57
    v_exp_f32 v58, v58
    v_cvt_pk_bf16_f32 v44, v56, v57
    s_waitcnt lgkmcnt(3)
    v_mfma_f32_32x32x16_bf16 v[80:95], v[32:35], v[40:43], v[80:95]
    v_exp_f32 v59, v59
    v_exp_f32 v60, v60
    v_cvt_pk_bf16_f32 v45, v58, v59
    v_exp_f32 v61, v61
    v_exp_f32 v62, v62
    v_exp_f32 v63, v63
    v_cvt_pk_bf16_f32 v46, v60, v61
    v_cvt_pk_bf16_f32 v47, v62, v63
    s_waitcnt lgkmcnt(2)
    v_mfma_f32_32x32x16_bf16 v[48:63], v[24:27], v[12:15], 0
    v_exp_f32 v64, v64
    v_exp_f32 v65, v65
    v_exp_f32 v66, v66
    v_cvt_pk_bf16_f32 v40, v64, v65
    v_exp_f32 v67, v67
    s_waitcnt lgkmcnt(0)
    v_mfma_f32_32x32x16_bf16 v[80:95], v[36:39], v[44:47], v[80:95]
    v_exp_f32 v68, v68
    v_cvt_pk_bf16_f32 v41, v66, v67
    v_exp_f32 v69, v69
    v_exp_f32 v70, v70
    v_cvt_pk_bf16_f32 v42, v68, v69
    v_mfma_f32_32x32x8_bf16 v[48:63], v[28:29], v[20:21], v[48:63]
    v_exp_f32 v71, v71
    v_exp_f32 v72, v72
    v_cvt_pk_bf16_f32 v43, v70, v71
    v_exp_f32 v73, v73
    v_exp_f32 v74, v74
    v_cvt_pk_bf16_f32 v44, v72, v73
    v_mfma_f32_32x32x16_bf16 v[96:111], v[32:35], v[40:43], v[96:111]
    s_mov_b64 exec, s[40:41]
    ds_read_b128 v[32:35], v118 offset:32000
    s_mov_b64 exec, -1
    v_exp_f32 v75, v75
    v_exp_f32 v76, v76
    v_cvt_pk_bf16_f32 v45, v74, v75
    v_exp_f32 v77, v77
    v_exp_f32 v78, v78
    v_exp_f32 v79, v79
    v_cvt_pk_bf16_f32 v46, v76, v77
    v_cvt_pk_bf16_f32 v47, v78, v79
    v_mfma_f32_32x32x16_bf16 v[64:79], v[24:27], v[16:19], 0
    ds_read2st64_b64 v[24:27], v114 offset0:70 offset1:71
    v_exp_f32 v48, v48
    v_exp_f32 v49, v49
    v_exp_f32 v50, v50
    v_cvt_pk_bf16_f32 v40, v48, v49
    v_exp_f32 v51, v51
    v_mfma_f32_32x32x16_bf16 v[96:111], v[36:39], v[44:47], v[96:111]
    v_exp_f32 v52, v52
    v_cvt_pk_bf16_f32 v41, v50, v51
    v_exp_f32 v53, v53
    v_exp_f32 v54, v54
    v_cvt_pk_bf16_f32 v42, v52, v53
    v_mfma_f32_32x32x8_bf16 v[64:79], v[28:29], v[22:23], v[64:79]
    s_mov_b64 exec, s[40:41]
    ds_read_b128 v[36:39], v118 offset:32640
    s_mov_b64 exec, s[98:99]
    ds_read_b64 v[28:29], v116 offset:36864
    s_mov_b64 exec, -1
    v_exp_f32 v55, v55
    v_exp_f32 v56, v56
    v_cvt_pk_bf16_f32 v43, v54, v55
    v_exp_f32 v57, v57
    v_exp_f32 v58, v58
    v_cvt_pk_bf16_f32 v44, v56, v57
    s_waitcnt lgkmcnt(3)
    v_mfma_f32_32x32x16_bf16 v[80:95], v[32:35], v[40:43], v[80:95]
    v_exp_f32 v59, v59
    v_exp_f32 v60, v60
    v_cvt_pk_bf16_f32 v45, v58, v59
    v_exp_f32 v61, v61
    v_exp_f32 v62, v62
    v_exp_f32 v63, v63
    v_cvt_pk_bf16_f32 v46, v60, v61
    v_cvt_pk_bf16_f32 v47, v62, v63
    s_waitcnt lgkmcnt(2)
    v_mfma_f32_32x32x16_bf16 v[48:63], v[24:27], v[12:15], 0
    v_exp_f32 v64, v64
    v_exp_f32 v65, v65
    v_exp_f32 v66, v66
    v_cvt_pk_bf16_f32 v40, v64, v65
    v_exp_f32 v67, v67
    s_waitcnt lgkmcnt(0)
    v_mfma_f32_32x32x16_bf16 v[80:95], v[36:39], v[44:47], v[80:95]
    v_exp_f32 v68, v68
    v_cvt_pk_bf16_f32 v41, v66, v67
    v_exp_f32 v69, v69
    v_exp_f32 v70, v70
    v_cvt_pk_bf16_f32 v42, v68, v69
    v_mfma_f32_32x32x8_bf16 v[48:63], v[28:29], v[20:21], v[48:63]
    v_exp_f32 v71, v71
    v_exp_f32 v72, v72
    v_cvt_pk_bf16_f32 v43, v70, v71
    v_exp_f32 v73, v73
    v_exp_f32 v74, v74
    v_cvt_pk_bf16_f32 v44, v72, v73
    v_mfma_f32_32x32x16_bf16 v[96:111], v[32:35], v[40:43], v[96:111]
    s_mov_b64 exec, s[40:41]
    ds_read_b128 v[32:35], v118 offset:37120
    s_mov_b64 exec, -1
    v_exp_f32 v75, v75
    v_exp_f32 v76, v76
    v_cvt_pk_bf16_f32 v45, v74, v75
    v_exp_f32 v77, v77
    v_exp_f32 v78, v78
    v_exp_f32 v79, v79
    v_cvt_pk_bf16_f32 v46, v76, v77
    v_cvt_pk_bf16_f32 v47, v78, v79
    s_setprio 0
    v_mfma_f32_32x32x16_bf16 v[64:79], v[24:27], v[16:19], 0
    s_mov_b32 s63, 0
L_A_W7:
    ds_read_b32 v9, v113 offset:28
    s_add_u32 s63, s63, 1
    s_waitcnt lgkmcnt(0)
    v_readfirstlane_b32 s88, v9
    s_cmp_gt_u32 s63, 200000
    s_cselect_b32 s88, 8, s88
    s_cmp_ge_u32 s88, 8
    s_cbranch_scc0 L_A_W7
    v_exp_f32 v48, v48
    v_exp_f32 v49, v49
    v_exp_f32 v50, v50
    v_cvt_pk_bf16_f32 v40, v48, v49
    v_exp_f32 v51, v51
    v_mfma_f32_32x32x16_bf16 v[96:111], v[36:39], v[44:47], v[96:111]
    v_exp_f32 v52, v52
    v_cvt_pk_bf16_f32 v41, v50, v51
    v_exp_f32 v53, v53
    v_exp_f32 v54, v54
    v_cvt_pk_bf16_f32 v42, v52, v53
    v_mfma_f32_32x32x8_bf16 v[64:79], v[28:29], v[22:23], v[64:79]
    s_mov_b64 exec, s[40:41]
    ds_read_b128 v[36:39], v118 offset:37760
    s_mov_b64 exec, -1
    v_exp_f32 v55, v55
    v_exp_f32 v56, v56
    v_cvt_pk_bf16_f32 v43, v54, v55
    v_exp_f32 v57, v57
    v_exp_f32 v58, v58
    v_cvt_pk_bf16_f32 v44, v56, v57
    s_waitcnt lgkmcnt(1)
    v_mfma_f32_32x32x16_bf16 v[80:95], v[32:35], v[40:43], v[80:95]
    v_exp_f32 v59, v59
    v_exp_f32 v60, v60
    v_cvt_pk_bf16_f32 v45, v58, v59
    v_exp_f32 v61, v61
    v_exp_f32 v62, v62
    v_exp_f32 v63, v63
    v_cvt_pk_bf16_f32 v46, v60, v61
    v_cvt_pk_bf16_f32 v47, v62, v63
    v_exp_f32 v64, v64
    v_exp_f32 v65, v65
    v_exp_f32 v66, v66
    v_cvt_pk_bf16_f32 v40, v64, v65
    v_exp_f32 v67, v67
    s_waitcnt lgkmcnt(0)
    v_mfma_f32_32x32x16_bf16 v[80:95], v[36:39], v[44:47], v[80:95]
    v_exp_f32 v68, v68
    v_cvt_pk_bf16_f32 v41, v66, v67
    v_exp_f32 v69, v69
    v_exp_f32 v70, v70
    v_cvt_pk_bf16_f32 v42, v68, v69
    v_exp_f32 v71, v71
    v_exp_f32 v72, v72
    v_cvt_pk_bf16_f32 v43, v70, v71
    v_exp_f32 v73, v73
    v_exp_f32 v74, v74
    v_cvt_pk_bf16_f32 v44, v72, v73
    v_mfma_f32_32x32x16_bf16 v[96:111], v[32:35], v[40:43], v[96:111]
    ds_write_b128 v119, v[80:83] offset:0
    v_exp_f32 v75, v75
    ds_write_b128 v119, v[84:87] offset:1024
    v_exp_f32 v76, v76
    ds_write_b128 v119, v[88:91] offset:2048
    v_cvt_pk_bf16_f32 v45, v74, v75
    ds_write_b32 v119, v92 offset:3072
    v_exp_f32 v77, v77
    ds_write_b32 v121, v6
    v_exp_f32 v78, v78
    v_exp_f32 v79, v79
    v_cvt_pk_bf16_f32 v46, v76, v77
    v_cvt_pk_bf16_f32 v47, v78, v79
    s_setprio 3
    s_nop 0
    v_mfma_f32_32x32x16_bf16 v[96:111], v[36:39], v[44:47], v[96:111]
    s_mov_b32 s63, 0
L_A_WX:
    ds_read_b32 v9, v122
    ds_read_b128 v[48:51], v120 offset:0
    ds_read_b128 v[52:55], v120 offset:1024
    ds_read_b128 v[56:59], v120 offset:2048
    ds_read_b32 v60, v120 offset:3072
    s_add_u32 s63, s63, 1
    s_waitcnt lgkmcnt(0)
    v_readfirstlane_b32 s88, v9
    s_cmp_gt_u32 s63, 200000
    s_cselect_b32 s88, 1, s88
    s_cmp_eq_u32 s88, 0
    s_cbranch_scc1 L_A_WX
    v_add_f32 v108, v108, v60
    v_add_f32 v96, v96, v48
    v_add_f32 v97, v97, v49
    v_add_f32 v98, v98, v50
    v_add_f32 v99, v99, v51
    v_add_f32 v100, v100, v52
    v_add_f32 v101, v101, v53
    v_add_f32 v102, v102, v54
    v_add_f32 v103, v103, v55
    v_add_f32 v104, v104, v56
    v_add_f32 v105, v105, v57
    v_add_f32 v106, v106, v58
    v_add_f32 v107, v107, v59
L_A_FIN:
    v_rcp_f32 v7, v108
    s_nop 0
    v_mul_f32 v48, v96, v7
    v_mul_f32 v49, v97, v7
    v_mul_f32 v50, v98, v7
    v_mul_f32 v51, v99, v7
    v_mul_f32 v52, v100, v7
    v_mul_f32 v53, v101, v7
    v_mul_f32 v54, v102, v7
    v_mul_f32 v55, v103, v7
    v_mul_f32 v56, v104, v7
    v_mul_f32 v57, v105, v7
    v_mul_f32 v58, v106, v7
    v_mul_f32 v59, v107, v7
    v_cvt_pk_bf16_f32 v40, v48, v49
    v_cvt_pk_bf16_f32 v41, v50, v51
    v_cvt_pk_bf16_f32 v42, v52, v53
    v_cvt_pk_bf16_f32 v43, v54, v55
    v_cvt_pk_bf16_f32 v44, v56, v57
    v_cvt_pk_bf16_f32 v45, v58, v59
    buffer_store_dwordx4 v[40:43], v4, s[16:19], s96 offen sc1
    s_mov_b32 exec_hi, 0
    buffer_store_dwordx2 v[44:45], v124, s[16:19], s96 offen offset:1024 sc1
    s_mov_b64 exec, -1
    v_mul_f32 v8, 0, v96
    v_fmac_f32 v8, 0, v97
    v_fmac_f32 v8, 0, v98
    v_fmac_f32 v8, 0, v99
    v_fmac_f32 v8, 0, v100
    v_fmac_f32 v8, 0, v101
    v_fmac_f32 v8, 0, v102
    v_fmac_f32 v8, 0, v103
    v_fmac_f32 v8, 0, v104
    v_fmac_f32 v8, 0, v105
    v_fmac_f32 v8, 0, v106
    v_fmac_f32 v8, 0, v107
    v_add_f32 v8, v8, v108
    v_cmp_nle_f32 vcc, 0x2b800000, v8
    s_mov_b64 s[90:91], vcc
    v_cmp_nge_f32 vcc, 0x67800000, v8
    s_or_b64 vcc, vcc, s[90:91]
    s_cselect_b32 s88, 1, 0
    s_cmp_gt_u32 s88, s42
    s_cbranch_scc1 L_A_FB
L_A_OK:
    s_mov_b64 exec, 0xff
    s_waitcnt vmcnt(0)
    buffer_atomic_add v6, v123, s[16:19], 0 offen sc1
    s_cmp_lg_u32 s3, 4
    s_cbranch_scc1 L_A_BYE
    s_lshr_b32 s88, s5, 3
    s_lshl_b32 s89, s4, 2
    s_add_u32 s88, s88, s89
    s_lshl_b32 s88, s88, 3
    s_and_b32 s89, s5, 7
    s_add_u32 s88, s88, s89
    s_lshl_b32 s88, s88, 7
    s_add_u32 s88, s88, 10489888
    v_lshl_add_u32 v9, v0, 2, s88
    v_mov_b32 v10, 132
    s_mov_b32 s62, 0
    v_mov_b32 v160, 0
    buffer_atomic_add v160, v9, s[16:19], 0 offen sc0 sc1
    s_sleep 2
    v_mov_b32 v161, 0
    buffer_atomic_add v161, v9, s[16:19], 0 offen sc0 sc1
    s_sleep 2
L_S2P:
    v_mov_b32 v162, 0
    buffer_atomic_add v162, v9, s[16:19], 0 offen sc0 sc1
    s_waitcnt vmcnt(2)
    v_cmp_eq_u32 vcc, 8, v160
    s_nop 1
    v_mov_b32 v8, vcc_lo
    ds_write_b32 v10, v8
    s_cmp_eq_u32 vcc_lo, 255
    s_cbranch_scc1 L_S2P_X
    s_sleep 2
    v_mov_b32 v160, 0
    buffer_atomic_add v160, v9, s[16:19], 0 offen sc0 sc1
    s_waitcnt vmcnt(2)
    v_cmp_eq_u32 vcc, 8, v161
    s_nop 1
    v_mov_b32 v8, vcc_lo
    ds_write_b32 v10, v8
    s_cmp_eq_u32 vcc_lo, 255
    s_cbranch_scc1 L_S2P_X
    s_sleep 2
    v_mov_b32 v161, 0
    buffer_atomic_add v161, v9, s[16:19], 0 offen sc0 sc1
    s_waitcnt vmcnt(2)
    v_cmp_eq_u32 vcc, 8, v162
    s_nop 1
    v_mov_b32 v8, vcc_lo
    ds_write_b32 v10, v8
    s_cmp_eq_u32 vcc_lo, 255
    s_cbranch_scc1 L_S2P_X
    s_sleep 2
    s_add_u32 s62, s62, 1
    s_cmp_lt_u32 s62, 20000
    s_cbranch_scc1 L_S2P
L_S2P_X:
    v_mov_b32 v8, 255
    ds_write_b32 v10, v8
L_A_BYE:
    s_endpgm
L_A_FB:
    s_mov_b32 s42, 1
L_FB0:
    v_cmp_gt_u32 vcc, 32, v0
    s_nop 1
    v_cndmask_b32 v22, 0, v22, vcc
    v_lshlrev_b32 v1, 3, v0
    v_and_b32 v7, 31, v0
    v_lshlrev_b32 v2, 3, v7
    v_lshrrev_b32 v8, 5, v0
    v_mul_u32_u24 v8, 320, v8
    v_lshl_add_u32 v3, v7, 4, v8
    v_mov_b32 v7, 0xff800000
    s_mov_b32 s57, 0
    s_mov_b32 s60, s59
L_FB1:
    buffer_load_dwordx2 v[24:25], v1, s[16:19], s60 offen offset:0 sc1
    buffer_load_dwordx2 v[26:27], v1, s[16:19], s60 offen offset:512 sc1
    buffer_load_dwordx2 v[28:29], v2, s[16:19], s60 offen offset:1024 sc1
    s_waitcnt vmcnt(0)
    v_mfma_f32_32x32x16_bf16 v[64:79], v[24:27], v[16:19], 0
    v_mfma_f32_32x32x8_bf16 v[64:79], v[28:29], v[22:23], v[64:79]
    s_nop 11
    v_max3_f32 v7, v7, v64, v65
    v_max3_f32 v7, v7, v66, v67
    v_max3_f32 v7, v7, v68, v69
    v_max3_f32 v7, v7, v70, v71
    v_max3_f32 v7, v7, v72, v73
    v_max3_f32 v7, v7, v74, v75
    v_max3_f32 v7, v7, v76, v77
    v_max3_f32 v7, v7, v78, v79
    s_add_u32 s60, s60, 2560
    s_add_u32 s57, s57, 1
    s_cmp_lt_u32 s57, 64
    s_cbranch_scc1 L_FB1
    v_mov_b32 v8, v7
    s_nop 1
    v_permlane32_swap_b32 v7, v8
    s_nop 1
    v_max_f32 v7, v7, v8
    v_sub_f32 v48, 0, v7
    v_mov_b32 v96, 0
    v_sub_f32 v49, 0, v7
    v_mov_b32 v97, 0
    v_sub_f32 v50, 0, v7
    v_mov_b32 v98, 0
    v_sub_f32 v51, 0, v7
    v_mov_b32 v99, 0
    v_sub_f32 v52, 0, v7
    v_mov_b32 v100, 0
    v_sub_f32 v53, 0, v7
    v_mov_b32 v101, 0
    v_sub_f32 v54, 0, v7
    v_mov_b32 v102, 0
    v_sub_f32 v55, 0, v7
    v_mov_b32 v103, 0
    v_sub_f32 v56, 0, v7
    v_mov_b32 v104, 0
    v_sub_f32 v57, 0, v7
    v_mov_b32 v105, 0
    v_sub_f32 v58, 0, v7
    v_mov_b32 v106, 0
    v_sub_f32 v59, 0, v7
    v_mov_b32 v107, 0
    v_sub_f32 v60, 0, v7
    v_mov_b32 v108, 0
    v_sub_f32 v61, 0, v7
    v_mov_b32 v109, 0
    v_sub_f32 v62, 0, v7
    v_mov_b32 v110, 0
    v_sub_f32 v63, 0, v7
    v_mov_b32 v111, 0
    s_mov_b32 s57, 0
    s_mov_b32 s60, s59
L_FB2:
    buffer_load_dwordx2 v[24:25], v1, s[16:19], s60 offen offset:0 sc1
    buffer_load_dwordx2 v[26:27], v1, s[16:19], s60 offen offset:512 sc1
    buffer_load_dwordx2 v[28:29], v2, s[16:19], s60 offen offset:1024 sc1
    s_mov_b64 exec, s[40:41]
    buffer_load_dwordx4 v[32:35], v3, s[16:19], s60 offen offset:1280 sc1
    buffer_load_dwordx4 v[36:39], v3, s[16:19], s60 offen offset:1920 sc1
    s_mov_b64 exec, -1
    s_waitcnt vmcnt(0)
    v_mfma_f32_32x32x16_bf16 v[64:79], v[24:27], v[16:19], v[48:63]
    v_mfma_f32_32x32x8_bf16 v[64:79], v[28:29], v[22:23], v[64:79]
    s_nop 11
    v_exp_f32 v64, v64
    v_exp_f32 v65, v65
    v_exp_f32 v66, v66
    v_exp_f32 v67, v67
    v_exp_f32 v68, v68
    v_exp_f32 v69, v69
    v_exp_f32 v70, v70
    v_exp_f32 v71, v71
    v_exp_f32 v72, v72
    v_exp_f32 v73, v73
    v_exp_f32 v74, v74
    v_exp_f32 v75, v75
    v_exp_f32 v76, v76
    v_exp_f32 v77, v77
    v_exp_f32 v78, v78
    v_exp_f32 v79, v79
    s_nop 0
    v_cvt_pk_bf16_f32 v40, v64, v65
    v_cvt_pk_bf16_f32 v41, v66, v67
    v_cvt_pk_bf16_f32 v42, v68, v69
    v_cvt_pk_bf16_f32 v43, v70, v71
    v_cvt_pk_bf16_f32 v44, v72, v73
    v_cvt_pk_bf16_f32 v45, v74, v75
    v_cvt_pk_bf16_f32 v46, v76, v77
    v_cvt_pk_bf16_f32 v47, v78, v79
    s_nop 1
    v_mfma_f32_32x32x16_bf16 v[96:111], v[32:35], v[40:43], v[96:111]
    v_mfma_f32_32x32x16_bf16 v[96:111], v[36:39], v[44:47], v[96:111]
    s_add_u32 s60, s60, 2560
    s_add_u32 s57, s57, 1
    s_cmp_lt_u32 s57, 64
    s_cbranch_scc1 L_FB2
    s_nop 11
    s_branch L_A_FIN
L_GEMM:
    v_lshlrev_b32 v2, 2, v0
    v_add_u32 v2, 114432, v2
    v_mov_b32 v3, 0
    ds_write_b32 v2, v3
    s_waitcnt lgkmcnt(0)
    s_mov_b32 s16, s60
    s_and_b32 s17, s61, 0xffff
    s_mov_b32 s18, 0x1000000
    s_mov_b32 s19, 0x00020000
    s_lshr_b32 s36, s3, 1
    s_and_b32 s37, s3, 1
    v_and_b32 v8, 31, v0
    v_lshrrev_b32 v9, 5, v0
    v_bfe_u32 v10, v0, 1, 3
    v_xor_b32 v10, v10, v9
    v_lshlrev_b32 v10, 4, v10
    v_lshl_add_u32 v10, v8, 7, v10
    s_lshl_b32 s88, s36, 13
    v_add_u32 v2, s88, v10
    v_xor_b32 v3, 32, v2
    v_xor_b32 v4, 64, v2
    v_xor_b32 v5, 96, v2
    v_bfe_u32 v10, v0, 2, 2
    v_lshl_add_u32 v11, v9, 3, v10
    v_lshlrev_b32 v11, 8, v11
    v_and_b32 v12, 3, v0
    v_lshl_add_u32 v11, v12, 3, v11
    v_bfe_u32 v12, v0, 4, 1
    v_lshl_add_u32 v11, v12, 5, v11
    s_lshl_b32 s88, s37, 1
    v_xor_b32 v12, s88, v10
    v_lshl_add_u32 v6, v12, 6, v11
    v_xor_b32 v7, 64, v6
    s_lshl_b32 s38, s6, 2
    s_lshl_b32 s88, s36, 1
    s_add_u32 s38, s38, s88
    s_mul_i32 s39, s7, 13108
    s_lshr_b32 s39, s39, 16
    s_mul_i32 s40, s39, 5
    s_sub_u32 s40, s7, s40
    s_lshl_b32 s88, s40, 7
    s_add_u32 s89, s88, 127
    s_mul_i32 s88, s88, 3277
    s_lshr_b32 s88, s88, 16
    s_mul_i32 s89, s89, 3277
    s_lshr_b32 s89, s89, 16
    v_lshrrev_b32 v10, 3, v0
    v_add_u32 v10, s88, v10
    v_cmp_ge_u32 s[92:93], s89, v10
    v_and_b32 v11, 7, v0
    s_lshr_b32 s89, s6, 1
    v_cmp_eq_u32 vcc, s89, v11
    s_lshl_b32 s88, s88, 10
    s_add_u32 s88, s88, 10489856
    s_cmp_eq_u32 s39, 0
    s_cselect_b32 s89, 4, 0
    s_cselect_b64 vcc, vcc, -1
    s_add_u32 s88, s88, s89
    v_lshl_add_u32 v120, v0, 7, s88
    s_and_b64 vcc, vcc, s[92:93]
    v_mov_b32 v10, 0x7ff00000
    v_cndmask_b32 v120, v10, v120, vcc
    s_cmp_ge_u32 s7, 10
    s_cbranch_scc1 L_G_V
    s_add_u32 s39, s39, 1
    s_cmp_lt_u32 s7, 5
    s_cselect_b32 s41, 0, 2621440
    s_mov_b32 s42, 0x3ea52b5c
    s_mul_i32 s56, s39, 1280
    s_mul_i32 s57, s39, 81920
    s_mul_i32 s88, s38, s56
    s_add_u32 s41, s41, s88
    s_add_u32 s58, s41, s56
    s_lshl_b32 s88, s40, 5
    s_lshl_b32 s89, s37, 4
    s_add_u32 s88, s88, s89
    v_add_u32 v10, s88, v9
    v_lshlrev_b32 v8, 3, v8
    v_mul_u32_u24 v11, 13108, v10
    v_lshrrev_b32 v11, 16, v11
    v_mul_u32_u24 v12, 5, v11
    v_sub_u32 v12, v10, v12
    v_mul_lo_u32 v11, v11, s57
    v_lshl_add_u32 v12, v12, 8, v8
    v_add_u32 v112, v11, v12
    v_add_u32 v10, 2, v10
    v_mul_u32_u24 v11, 13108, v10
    v_lshrrev_b32 v11, 16, v11
    v_mul_u32_u24 v12, 5, v11
    v_sub_u32 v12, v10, v12
    v_mul_lo_u32 v11, v11, s57
    v_lshl_add_u32 v12, v12, 8, v8
    v_add_u32 v113, v11, v12
    v_add_u32 v10, 2, v10
    v_mul_u32_u24 v11, 13108, v10
    v_lshrrev_b32 v11, 16, v11
    v_mul_u32_u24 v12, 5, v11
    v_sub_u32 v12, v10, v12
    v_mul_lo_u32 v11, v11, s57
    v_lshl_add_u32 v12, v12, 8, v8
    v_add_u32 v114, v11, v12
    v_add_u32 v10, 2, v10
    v_mul_u32_u24 v11, 13108, v10
    v_lshrrev_b32 v11, 16, v11
    v_mul_u32_u24 v12, 5, v11
    v_sub_u32 v12, v10, v12
    v_mul_lo_u32 v11, v11, s57
    v_lshl_add_u32 v12, v12, 8, v8
    v_add_u32 v115, v11, v12
    v_add_u32 v10, 2, v10
    v_mul_u32_u24 v11, 13108, v10
    v_lshrrev_b32 v11, 16, v11
    v_mul_u32_u24 v12, 5, v11
    v_sub_u32 v12, v10, v12
    v_mul_lo_u32 v11, v11, s57
    v_lshl_add_u32 v12, v12, 8, v8
    v_add_u32 v116, v11, v12
    v_add_u32 v10, 2, v10
    v_mul_u32_u24 v11, 13108, v10
    v_lshrrev_b32 v11, 16, v11
    v_mul_u32_u24 v12, 5, v11
    v_sub_u32 v12, v10, v12
    v_mul_lo_u32 v11, v11, s57
    v_lshl_add_u32 v12, v12, 8, v8
    v_add_u32 v117, v11, v12
    v_add_u32 v10, 2, v10
    v_mul_u32_u24 v11, 13108, v10
    v_lshrrev_b32 v11, 16, v11
    v_mul_u32_u24 v12, 5, v11
    v_sub_u32 v12, v10, v12
    v_mul_lo_u32 v11, v11, s57
    v_lshl_add_u32 v12, v12, 8, v8
    v_add_u32 v118, v11, v12
    v_add_u32 v10, 2, v10
    v_mul_u32_u24 v11, 13108, v10
    v_lshrrev_b32 v11, 16, v11
    v_mul_u32_u24 v12, 5, v11
    v_sub_u32 v12, v10, v12
    v_mul_lo_u32 v11, v11, s57
    v_lshl_add_u32 v12, v12, 8, v8
    v_add_u32 v119, v11, v12
    s_barrier
    ds_read_b128 v[80:83], v2 offset:0
    ds_read_b64_tr_b16 v[88:89], v6 offset:16384
    ds_read_b64_tr_b16 v[90:91], v6 offset:17408
    ds_read_b128 v[84:87], v2 offset:4096
    ds_read_b64_tr_b16 v[92:93], v7 offset:16384
    ds_read_b64_tr_b16 v[94:95], v7 offset:17408
    s_waitcnt lgkmcnt(0)
    v_mfma_f32_32x32x16_bf16 v[16:31], v[88:91], v[80:83], 0
    ds_read_b128 v[96:99], v3 offset:0
    ds_read_b64_tr_b16 v[104:105], v6 offset:20480
    v_mfma_f32_32x32x16_bf16 v[32:47], v[92:95], v[80:83], 0
    ds_read_b64_tr_b16 v[106:107], v6 offset:21504
    ds_read_b128 v[100:103], v3 offset:4096
    v_mfma_f32_32x32x16_bf16 v[48:63], v[88:91], v[84:87], 0
    ds_read_b64_tr_b16 v[108:109], v7 offset:20480
    ds_read_b64_tr_b16 v[110:111], v7 offset:21504
    v_mfma_f32_32x32x16_bf16 v[64:79], v[92:95], v[84:87], 0
    s_waitcnt lgkmcnt(0)
    v_mfma_f32_32x32x16_bf16 v[16:31], v[104:107], v[96:99], v[16:31]
    ds_read_b128 v[80:83], v4 offset:0
    ds_read_b64_tr_b16 v[88:89], v6 offset:24576
    v_mfma_f32_32x32x16_bf16 v[32:47], v[108:111], v[96:99], v[32:47]
    ds_read_b64_tr_b16 v[90:91], v6 offset:25600
    ds_read_b128 v[84:87], v4 offset:4096
    v_mfma_f32_32x32x16_bf16 v[48:63], v[104:107], v[100:103], v[48:63]
    ds_read_b64_tr_b16 v[92:93], v7 offset:24576
    ds_read_b64_tr_b16 v[94:95], v7 offset:25600
    v_mfma_f32_32x32x16_bf16 v[64:79], v[108:111], v[100:103], v[64:79]
    s_waitcnt lgkmcnt(0)
    v_mfma_f32_32x32x16_bf16 v[16:31], v[88:91], v[80:83], v[16:31]
    ds_read_b128 v[96:99], v5 offset:0
    ds_read_b64_tr_b16 v[104:105], v6 offset:28672
    v_mfma_f32_32x32x16_bf16 v[32:47], v[92:95], v[80:83], v[32:47]
    ds_read_b64_tr_b16 v[106:107], v6 offset:29696
    ds_read_b128 v[100:103], v5 offset:4096
    v_mfma_f32_32x32x16_bf16 v[48:63], v[88:91], v[84:87], v[48:63]
    ds_read_b64_tr_b16 v[108:109], v7 offset:28672
    ds_read_b64_tr_b16 v[110:111], v7 offset:29696
    v_mfma_f32_32x32x16_bf16 v[64:79], v[92:95], v[84:87], v[64:79]
    v_add_u32 v2, 0x8000, v2
    v_add_u32 v3, 0x8000, v3
    v_add_u32 v4, 0x8000, v4
    v_add_u32 v5, 0x8000, v5
    v_add_u32 v6, 0x8000, v6
    v_add_u32 v7, 0x8000, v7
    s_waitcnt lgkmcnt(0)
    s_barrier
    v_mfma_f32_32x32x16_bf16 v[16:31], v[104:107], v[96:99], v[16:31]
    ds_read_b128 v[80:83], v2 offset:0
    ds_read_b64_tr_b16 v[88:89], v6 offset:16384
    v_mfma_f32_32x32x16_bf16 v[32:47], v[108:111], v[96:99], v[32:47]
    ds_read_b64_tr_b16 v[90:91], v6 offset:17408
    ds_read_b128 v[84:87], v2 offset:4096
    v_mfma_f32_32x32x16_bf16 v[48:63], v[104:107], v[100:103], v[48:63]
    ds_read_b64_tr_b16 v[92:93], v7 offset:16384
    ds_read_b64_tr_b16 v[94:95], v7 offset:17408
    v_mfma_f32_32x32x16_bf16 v[64:79], v[108:111], v[100:103], v[64:79]
    s_waitcnt lgkmcnt(0)
    v_mfma_f32_32x32x16_bf16 v[16:31], v[88:91], v[80:83], v[16:31]
    ds_read_b128 v[96:99], v3 offset:0
    ds_read_b64_tr_b16 v[104:105], v6 offset:20480
    v_mfma_f32_32x32x16_bf16 v[32:47], v[92:95], v[80:83], v[32:47]
    ds_read_b64_tr_b16 v[106:107], v6 offset:21504
    ds_read_b128 v[100:103], v3 offset:4096
    v_mfma_f32_32x32x16_bf16 v[48:63], v[88:91], v[84:87], v[48:63]
    ds_read_b64_tr_b16 v[108:109], v7 offset:20480
    ds_read_b64_tr_b16 v[110:111], v7 offset:21504
    v_mfma_f32_32x32x16_bf16 v[64:79], v[92:95], v[84:87], v[64:79]
    s_waitcnt lgkmcnt(0)
    v_mfma_f32_32x32x16_bf16 v[16:31], v[104:107], v[96:99], v[16:31]
    ds_read_b128 v[80:83], v4 offset:0
    ds_read_b64_tr_b16 v[88:89], v6 offset:24576
    v_mfma_f32_32x32x16_bf16 v[32:47], v[108:111], v[96:99], v[32:47]
    ds_read_b64_tr_b16 v[90:91], v6 offset:25600
    ds_read_b128 v[84:87], v4 offset:4096
    v_mfma_f32_32x32x16_bf16 v[48:63], v[104:107], v[100:103], v[48:63]
    ds_read_b64_tr_b16 v[92:93], v7 offset:24576
    ds_read_b64_tr_b16 v[94:95], v7 offset:25600
    v_mfma_f32_32x32x16_bf16 v[64:79], v[108:111], v[100:103], v[64:79]
    s_waitcnt lgkmcnt(0)
    v_mfma_f32_32x32x16_bf16 v[16:31], v[88:91], v[80:83], v[16:31]
    ds_read_b128 v[96:99], v5 offset:0
    ds_read_b64_tr_b16 v[104:105], v6 offset:28672
    v_mfma_f32_32x32x16_bf16 v[32:47], v[92:95], v[80:83], v[32:47]
    ds_read_b64_tr_b16 v[106:107], v6 offset:29696
    ds_read_b128 v[100:103], v5 offset:4096
    v_mfma_f32_32x32x16_bf16 v[48:63], v[88:91], v[84:87], v[48:63]
    ds_read_b64_tr_b16 v[108:109], v7 offset:28672
    ds_read_b64_tr_b16 v[110:111], v7 offset:29696
    v_mfma_f32_32x32x16_bf16 v[64:79], v[92:95], v[84:87], v[64:79]
    v_add_u32 v2, 0x8000, v2
    v_add_u32 v3, 0x8000, v3
    v_add_u32 v4, 0x8000, v4
    v_add_u32 v5, 0x8000, v5
    v_add_u32 v6, 0x8000, v6
    v_add_u32 v7, 0x8000, v7
    s_waitcnt lgkmcnt(0)
    s_barrier
    v_mfma_f32_32x32x16_bf16 v[16:31], v[104:107], v[96:99], v[16:31]
    ds_read_b128 v[80:83], v2 offset:0
    ds_read_b64_tr_b16 v[88:89], v6 offset:16384
    v_mfma_f32_32x32x16_bf16 v[32:47], v[108:111], v[96:99], v[32:47]
    ds_read_b64_tr_b16 v[90:91], v6 offset:17408
    ds_read_b128 v[84:87], v2 offset:4096
    v_mfma_f32_32x32x16_bf16 v[48:63], v[104:107], v[100:103], v[48:63]
    ds_read_b64_tr_b16 v[92:93], v7 offset:16384
    ds_read_b64_tr_b16 v[94:95], v7 offset:17408
    v_mfma_f32_32x32x16_bf16 v[64:79], v[108:111], v[100:103], v[64:79]
    s_waitcnt lgkmcnt(0)
    v_mfma_f32_32x32x16_bf16 v[16:31], v[88:91], v[80:83], v[16:31]
    ds_read_b128 v[96:99], v3 offset:0
    ds_read_b64_tr_b16 v[104:105], v6 offset:20480
    v_mfma_f32_32x32x16_bf16 v[32:47], v[92:95], v[80:83], v[32:47]
    ds_read_b64_tr_b16 v[106:107], v6 offset:21504
    ds_read_b128 v[100:103], v3 offset:4096
    v_mfma_f32_32x32x16_bf16 v[48:63], v[88:91], v[84:87], v[48:63]
    ds_read_b64_tr_b16 v[108:109], v7 offset:20480
    ds_read_b64_tr_b16 v[110:111], v7 offset:21504
    v_mfma_f32_32x32x16_bf16 v[64:79], v[92:95], v[84:87], v[64:79]
    s_waitcnt lgkmcnt(0)
    v_mfma_f32_32x32x16_bf16 v[16:31], v[104:107], v[96:99], v[16:31]
    ds_read_b128 v[80:83], v4 offset:0
    ds_read_b64_tr_b16 v[88:89], v6 offset:24576
    v_mfma_f32_32x32x16_bf16 v[32:47], v[108:111], v[96:99], v[32:47]
    ds_read_b64_tr_b16 v[90:91], v6 offset:25600
    ds_read_b128 v[84:87], v4 offset:4096
    v_mfma_f32_32x32x16_bf16 v[48:63], v[104:107], v[100:103], v[48:63]
    ds_read_b64_tr_b16 v[92:93], v7 offset:24576
    ds_read_b64_tr_b16 v[94:95], v7 offset:25600
    v_mfma_f32_32x32x16_bf16 v[64:79], v[108:111], v[100:103], v[64:79]
    s_waitcnt lgkmcnt(0)
    v_mfma_f32_32x32x16_bf16 v[16:31], v[88:91], v[80:83], v[16:31]
    ds_read_b128 v[96:99], v5 offset:0
    ds_read_b64_tr_b16 v[104:105], v6 offset:28672
    v_mfma_f32_32x32x16_bf16 v[32:47], v[92:95], v[80:83], v[32:47]
    ds_read_b64_tr_b16 v[106:107], v6 offset:29696
    ds_read_b128 v[100:103], v5 offset:4096
    v_mfma_f32_32x32x16_bf16 v[48:63], v[88:91], v[84:87], v[48:63]
    ds_read_b64_tr_b16 v[108:109], v7 offset:28672
    ds_read_b64_tr_b16 v[110:111], v7 offset:29696
    v_mfma_f32_32x32x16_bf16 v[64:79], v[92:95], v[84:87], v[64:79]
    v_add_u32 v2, 0xffff0000, v2
    v_add_u32 v3, 0xffff0000, v3
    v_add_u32 v4, 0xffff0000, v4
    v_add_u32 v5, 0xffff0000, v5
    v_add_u32 v6, 0xffff0000, v6
    v_add_u32 v7, 0xffff0000, v7
    s_waitcnt lgkmcnt(0)
    s_barrier
    v_mfma_f32_32x32x16_bf16 v[16:31], v[104:107], v[96:99], v[16:31]
    ds_read_b128 v[80:83], v2 offset:0
    ds_read_b64_tr_b16 v[88:89], v6 offset:16384
    v_mfma_f32_32x32x16_bf16 v[32:47], v[108:111], v[96:99], v[32:47]
    ds_read_b64_tr_b16 v[90:91], v6 offset:17408
    ds_read_b128 v[84:87], v2 offset:4096
    v_mfma_f32_32x32x16_bf16 v[48:63], v[104:107], v[100:103], v[48:63]
    ds_read_b64_tr_b16 v[92:93], v7 offset:16384
    ds_read_b64_tr_b16 v[94:95], v7 offset:17408
    v_mfma_f32_32x32x16_bf16 v[64:79], v[108:111], v[100:103], v[64:79]
    s_waitcnt lgkmcnt(0)
    v_mfma_f32_32x32x16_bf16 v[16:31], v[88:91], v[80:83], v[16:31]
    ds_read_b128 v[96:99], v3 offset:0
    ds_read_b64_tr_b16 v[104:105], v6 offset:20480
    v_mfma_f32_32x32x16_bf16 v[32:47], v[92:95], v[80:83], v[32:47]
    ds_read_b64_tr_b16 v[106:107], v6 offset:21504
    ds_read_b128 v[100:103], v3 offset:4096
    v_mfma_f32_32x32x16_bf16 v[48:63], v[88:91], v[84:87], v[48:63]
    ds_read_b64_tr_b16 v[108:109], v7 offset:20480
    ds_read_b64_tr_b16 v[110:111], v7 offset:21504
    v_mfma_f32_32x32x16_bf16 v[64:79], v[92:95], v[84:87], v[64:79]
    s_waitcnt lgkmcnt(0)
    v_mfma_f32_32x32x16_bf16 v[16:31], v[104:107], v[96:99], v[16:31]
    ds_read_b128 v[80:83], v4 offset:0
    ds_read_b64_tr_b16 v[88:89], v6 offset:24576
    v_mfma_f32_32x32x16_bf16 v[32:47], v[108:111], v[96:99], v[32:47]
    ds_read_b64_tr_b16 v[90:91], v6 offset:25600
    ds_read_b128 v[84:87], v4 offset:4096
    v_mfma_f32_32x32x16_bf16 v[48:63], v[104:107], v[100:103], v[48:63]
    ds_read_b64_tr_b16 v[92:93], v7 offset:24576
    ds_read_b64_tr_b16 v[94:95], v7 offset:25600
    v_mfma_f32_32x32x16_bf16 v[64:79], v[108:111], v[100:103], v[64:79]
    s_waitcnt lgkmcnt(0)
    v_mfma_f32_32x32x16_bf16 v[16:31], v[88:91], v[80:83], v[16:31]
    ds_read_b128 v[96:99], v5 offset:0
    ds_read_b64_tr_b16 v[104:105], v6 offset:28672
    v_mfma_f32_32x32x16_bf16 v[32:47], v[92:95], v[80:83], v[32:47]
    ds_read_b64_tr_b16 v[106:107], v6 offset:29696
    ds_read_b128 v[100:103], v5 offset:4096
    v_mfma_f32_32x32x16_bf16 v[48:63], v[88:91], v[84:87], v[48:63]
    ds_read_b64_tr_b16 v[108:109], v7 offset:28672
    ds_read_b64_tr_b16 v[110:111], v7 offset:29696
    v_mfma_f32_32x32x16_bf16 v[64:79], v[92:95], v[84:87], v[64:79]
    v_add_u32 v2, 0x8000, v2
    v_add_u32 v3, 0x8000, v3
    v_add_u32 v4, 0x8000, v4
    v_add_u32 v5, 0x8000, v5
    v_add_u32 v6, 0x8000, v6
    v_add_u32 v7, 0x8000, v7
    s_waitcnt lgkmcnt(0)
    s_barrier
    v_mfma_f32_32x32x16_bf16 v[16:31], v[104:107], v[96:99], v[16:31]
    ds_read_b128 v[80:83], v2 offset:0
    ds_read_b64_tr_b16 v[88:89], v6 offset:16384
    v_mfma_f32_32x32x16_bf16 v[32:47], v[108:111], v[96:99], v[32:47]
    ds_read_b64_tr_b16 v[90:91], v6 offset:17408
    ds_read_b128 v[84:87], v2 offset:4096
    v_mfma_f32_32x32x16_bf16 v[48:63], v[104:107], v[100:103], v[48:63]
    ds_read_b64_tr_b16 v[92:93], v7 offset:16384
    ds_read_b64_tr_b16 v[94:95], v7 offset:17408
    v_mfma_f32_32x32x16_bf16 v[64:79], v[108:111], v[100:103], v[64:79]
    s_waitcnt lgkmcnt(0)
    v_mfma_f32_32x32x16_bf16 v[16:31], v[88:91], v[80:83], v[16:31]
    ds_read_b128 v[96:99], v3 offset:0
    ds_read_b64_tr_b16 v[104:105], v6 offset:20480
    v_mfma_f32_32x32x16_bf16 v[32:47], v[92:95], v[80:83], v[32:47]
    ds_read_b64_tr_b16 v[106:107], v6 offset:21504
    ds_read_b128 v[100:103], v3 offset:4096
    v_mfma_f32_32x32x16_bf16 v[48:63], v[88:91], v[84:87], v[48:63]
    ds_read_b64_tr_b16 v[108:109], v7 offset:20480
    ds_read_b64_tr_b16 v[110:111], v7 offset:21504
    v_mfma_f32_32x32x16_bf16 v[64:79], v[92:95], v[84:87], v[64:79]
    s_waitcnt lgkmcnt(0)
    v_mfma_f32_32x32x16_bf16 v[16:31], v[104:107], v[96:99], v[16:31]
    ds_read_b128 v[80:83], v4 offset:0
    ds_read_b64_tr_b16 v[88:89], v6 offset:24576
    v_mfma_f32_32x32x16_bf16 v[32:47], v[108:111], v[96:99], v[32:47]
    ds_read_b64_tr_b16 v[90:91], v6 offset:25600
    ds_read_b128 v[84:87], v4 offset:4096
    v_mfma_f32_32x32x16_bf16 v[48:63], v[104:107], v[100:103], v[48:63]
    ds_read_b64_tr_b16 v[92:93], v7 offset:24576
    ds_read_b64_tr_b16 v[94:95], v7 offset:25600
    v_mfma_f32_32x32x16_bf16 v[64:79], v[108:111], v[100:103], v[64:79]
    s_waitcnt lgkmcnt(0)
    v_mfma_f32_32x32x16_bf16 v[16:31], v[88:91], v[80:83], v[16:31]
    ds_read_b128 v[96:99], v5 offset:0
    ds_read_b64_tr_b16 v[104:105], v6 offset:28672
    v_mfma_f32_32x32x16_bf16 v[32:47], v[92:95], v[80:83], v[32:47]
    ds_read_b64_tr_b16 v[106:107], v6 offset:29696
    ds_read_b128 v[100:103], v5 offset:4096
    v_mfma_f32_32x32x16_bf16 v[48:63], v[88:91], v[84:87], v[48:63]
    ds_read_b64_tr_b16 v[108:109], v7 offset:28672
    ds_read_b64_tr_b16 v[110:111], v7 offset:29696
    v_mfma_f32_32x32x16_bf16 v[64:79], v[92:95], v[84:87], v[64:79]
    v_add_u32 v2, 0x8000, v2
    v_add_u32 v3, 0x8000, v3
    v_add_u32 v4, 0x8000, v4
    v_add_u32 v5, 0x8000, v5
    v_add_u32 v6, 0x8000, v6
    v_add_u32 v7, 0x8000, v7
    s_waitcnt lgkmcnt(0)
    s_barrier
    v_mfma_f32_32x32x16_bf16 v[16:31], v[104:107], v[96:99], v[16:31]
    ds_read_b128 v[80:83], v2 offset:0
    ds_read_b64_tr_b16 v[88:89], v6 offset:16384
    v_mfma_f32_32x32x16_bf16 v[32:47], v[108:111], v[96:99], v[32:47]
    ds_read_b64_tr_b16 v[90:91], v6 offset:17408
    ds_read_b128 v[84:87], v2 offset:4096
    v_mfma_f32_32x32x16_bf16 v[48:63], v[104:107], v[100:103], v[48:63]
    ds_read_b64_tr_b16 v[92:93], v7 offset:16384
    ds_read_b64_tr_b16 v[94:95], v7 offset:17408
    v_mfma_f32_32x32x16_bf16 v[64:79], v[108:111], v[100:103], v[64:79]
    s_waitcnt lgkmcnt(0)
    v_mfma_f32_32x32x16_bf16 v[16:31], v[88:91], v[80:83], v[16:31]
    ds_read_b128 v[96:99], v3 offset:0
    ds_read_b64_tr_b16 v[104:105], v6 offset:20480
    v_mfma_f32_32x32x16_bf16 v[32:47], v[92:95], v[80:83], v[32:47]
    ds_read_b64_tr_b16 v[106:107], v6 offset:21504
    ds_read_b128 v[100:103], v3 offset:4096
    v_mfma_f32_32x32x16_bf16 v[48:63], v[88:91], v[84:87], v[48:63]
    ds_read_b64_tr_b16 v[108:109], v7 offset:20480
    ds_read_b64_tr_b16 v[110:111], v7 offset:21504
    v_mfma_f32_32x32x16_bf16 v[64:79], v[92:95], v[84:87], v[64:79]
    s_waitcnt lgkmcnt(0)
    v_mfma_f32_32x32x16_bf16 v[16:31], v[104:107], v[96:99], v[16:31]
    ds_read_b128 v[80:83], v4 offset:0
    ds_read_b64_tr_b16 v[88:89], v6 offset:24576
    v_mfma_f32_32x32x16_bf16 v[32:47], v[108:111], v[96:99], v[32:47]
    ds_read_b64_tr_b16 v[90:91], v6 offset:25600
    ds_read_b128 v[84:87], v4 offset:4096
    v_mfma_f32_32x32x16_bf16 v[48:63], v[104:107], v[100:103], v[48:63]
    ds_read_b64_tr_b16 v[92:93], v7 offset:24576
    ds_read_b64_tr_b16 v[94:95], v7 offset:25600
    v_mfma_f32_32x32x16_bf16 v[64:79], v[108:111], v[100:103], v[64:79]
    s_waitcnt lgkmcnt(0)
    v_mfma_f32_32x32x16_bf16 v[16:31], v[88:91], v[80:83], v[16:31]
    ds_read_b128 v[96:99], v5 offset:0
    ds_read_b64_tr_b16 v[104:105], v6 offset:28672
    v_mfma_f32_32x32x16_bf16 v[32:47], v[92:95], v[80:83], v[32:47]
    ds_read_b64_tr_b16 v[106:107], v6 offset:29696
    ds_read_b128 v[100:103], v5 offset:4096
    v_mfma_f32_32x32x16_bf16 v[48:63], v[88:91], v[84:87], v[48:63]
    ds_read_b64_tr_b16 v[108:109], v7 offset:28672
    ds_read_b64_tr_b16 v[110:111], v7 offset:29696
    v_mfma_f32_32x32x16_bf16 v[64:79], v[92:95], v[84:87], v[64:79]
    v_add_u32 v2, 0xffff0000, v2
    v_add_u32 v3, 0xffff0000, v3
    v_add_u32 v4, 0xffff0000, v4
    v_add_u32 v5, 0xffff0000, v5
    v_add_u32 v6, 0xffff0000, v6
    v_add_u32 v7, 0xffff0000, v7
    s_waitcnt lgkmcnt(0)
    s_barrier
    v_mfma_f32_32x32x16_bf16 v[16:31], v[104:107], v[96:99], v[16:31]
    ds_read_b128 v[80:83], v2 offset:0
    ds_read_b64_tr_b16 v[88:89], v6 offset:16384
    v_mfma_f32_32x32x16_bf16 v[32:47], v[108:111], v[96:99], v[32:47]
    ds_read_b64_tr_b16 v[90:91], v6 offset:17408
    ds_read_b128 v[84:87], v2 offset:4096
    v_mfma_f32_32x32x16_bf16 v[48:63], v[104:107], v[100:103], v[48:63]
    ds_read_b64_tr_b16 v[92:93], v7 offset:16384
    ds_read_b64_tr_b16 v[94:95], v7 offset:17408
    v_mfma_f32_32x32x16_bf16 v[64:79], v[108:111], v[100:103], v[64:79]
    s_waitcnt lgkmcnt(0)
    v_mfma_f32_32x32x16_bf16 v[16:31], v[88:91], v[80:83], v[16:31]
    ds_read_b128 v[96:99], v3 offset:0
    ds_read_b64_tr_b16 v[104:105], v6 offset:20480
    v_mfma_f32_32x32x16_bf16 v[32:47], v[92:95], v[80:83], v[32:47]
    ds_read_b64_tr_b16 v[106:107], v6 offset:21504
    ds_read_b128 v[100:103], v3 offset:4096
    v_mfma_f32_32x32x16_bf16 v[48:63], v[88:91], v[84:87], v[48:63]
    ds_read_b64_tr_b16 v[108:109], v7 offset:20480
    ds_read_b64_tr_b16 v[110:111], v7 offset:21504
    v_mfma_f32_32x32x16_bf16 v[64:79], v[92:95], v[84:87], v[64:79]
    s_waitcnt lgkmcnt(0)
    v_mfma_f32_32x32x16_bf16 v[16:31], v[104:107], v[96:99], v[16:31]
    ds_read_b128 v[80:83], v4 offset:0
    ds_read_b64_tr_b16 v[88:89], v6 offset:24576
    v_mfma_f32_32x32x16_bf16 v[32:47], v[108:111], v[96:99], v[32:47]
    ds_read_b64_tr_b16 v[90:91], v6 offset:25600
    ds_read_b128 v[84:87], v4 offset:4096
    v_mfma_f32_32x32x16_bf16 v[48:63], v[104:107], v[100:103], v[48:63]
    ds_read_b64_tr_b16 v[92:93], v7 offset:24576
    ds_read_b64_tr_b16 v[94:95], v7 offset:25600
    v_mfma_f32_32x32x16_bf16 v[64:79], v[108:111], v[100:103], v[64:79]
    s_waitcnt lgkmcnt(0)
    v_mfma_f32_32x32x16_bf16 v[16:31], v[88:91], v[80:83], v[16:31]
    ds_read_b128 v[96:99], v5 offset:0
    ds_read_b64_tr_b16 v[104:105], v6 offset:28672
    v_mfma_f32_32x32x16_bf16 v[32:47], v[92:95], v[80:83], v[32:47]
    ds_read_b64_tr_b16 v[106:107], v6 offset:29696
    ds_read_b128 v[100:103], v5 offset:4096
    v_mfma_f32_32x32x16_bf16 v[48:63], v[88:91], v[84:87], v[48:63]
    ds_read_b64_tr_b16 v[108:109], v7 offset:28672
    ds_read_b64_tr_b16 v[110:111], v7 offset:29696
    v_mfma_f32_32x32x16_bf16 v[64:79], v[92:95], v[84:87], v[64:79]
    v_add_u32 v2, 0x8000, v2
    v_add_u32 v3, 0x8000, v3
    v_add_u32 v4, 0x8000, v4
    v_add_u32 v5, 0x8000, v5
    v_add_u32 v6, 0x8000, v6
    v_add_u32 v7, 0x8000, v7
    s_waitcnt lgkmcnt(0)
    s_barrier
    v_mfma_f32_32x32x16_bf16 v[16:31], v[104:107], v[96:99], v[16:31]
    ds_read_b128 v[80:83], v2 offset:0
    ds_read_b64_tr_b16 v[88:89], v6 offset:16384
    v_mfma_f32_32x32x16_bf16 v[32:47], v[108:111], v[96:99], v[32:47]
    ds_read_b64_tr_b16 v[90:91], v6 offset:17408
    ds_read_b128 v[84:87], v2 offset:4096
    v_mfma_f32_32x32x16_bf16 v[48:63], v[104:107], v[100:103], v[48:63]
    ds_read_b64_tr_b16 v[92:93], v7 offset:16384
    ds_read_b64_tr_b16 v[94:95], v7 offset:17408
    v_mfma_f32_32x32x16_bf16 v[64:79], v[108:111], v[100:103], v[64:79]
    s_waitcnt lgkmcnt(0)
    v_mfma_f32_32x32x16_bf16 v[16:31], v[88:91], v[80:83], v[16:31]
    ds_read_b128 v[96:99], v3 offset:0
    ds_read_b64_tr_b16 v[104:105], v6 offset:20480
    v_mfma_f32_32x32x16_bf16 v[32:47], v[92:95], v[80:83], v[32:47]
    ds_read_b64_tr_b16 v[106:107], v6 offset:21504
    ds_read_b128 v[100:103], v3 offset:4096
    v_mfma_f32_32x32x16_bf16 v[48:63], v[88:91], v[84:87], v[48:63]
    ds_read_b64_tr_b16 v[108:109], v7 offset:20480
    ds_read_b64_tr_b16 v[110:111], v7 offset:21504
    v_mfma_f32_32x32x16_bf16 v[64:79], v[92:95], v[84:87], v[64:79]
    s_waitcnt lgkmcnt(0)
    v_mfma_f32_32x32x16_bf16 v[16:31], v[104:107], v[96:99], v[16:31]
    ds_read_b128 v[80:83], v4 offset:0
    ds_read_b64_tr_b16 v[88:89], v6 offset:24576
    v_mfma_f32_32x32x16_bf16 v[32:47], v[108:111], v[96:99], v[32:47]
    ds_read_b64_tr_b16 v[90:91], v6 offset:25600
    ds_read_b128 v[84:87], v4 offset:4096
    v_mfma_f32_32x32x16_bf16 v[48:63], v[104:107], v[100:103], v[48:63]
    ds_read_b64_tr_b16 v[92:93], v7 offset:24576
    ds_read_b64_tr_b16 v[94:95], v7 offset:25600
    v_mfma_f32_32x32x16_bf16 v[64:79], v[108:111], v[100:103], v[64:79]
    s_waitcnt lgkmcnt(0)
    v_mfma_f32_32x32x16_bf16 v[16:31], v[88:91], v[80:83], v[16:31]
    ds_read_b128 v[96:99], v5 offset:0
    ds_read_b64_tr_b16 v[104:105], v6 offset:28672
    v_mfma_f32_32x32x16_bf16 v[32:47], v[92:95], v[80:83], v[32:47]
    ds_read_b64_tr_b16 v[106:107], v6 offset:29696
    ds_read_b128 v[100:103], v5 offset:4096
    v_mfma_f32_32x32x16_bf16 v[48:63], v[88:91], v[84:87], v[48:63]
    ds_read_b64_tr_b16 v[108:109], v7 offset:28672
    ds_read_b64_tr_b16 v[110:111], v7 offset:29696
    v_mfma_f32_32x32x16_bf16 v[64:79], v[92:95], v[84:87], v[64:79]
    v_add_u32 v2, 0x8000, v2
    v_add_u32 v3, 0x8000, v3
    v_add_u32 v4, 0x8000, v4
    v_add_u32 v5, 0x8000, v5
    v_add_u32 v6, 0x8000, v6
    v_add_u32 v7, 0x8000, v7
    s_waitcnt lgkmcnt(0)
    s_barrier
    v_mfma_f32_32x32x16_bf16 v[16:31], v[104:107], v[96:99], v[16:31]
    ds_read_b128 v[80:83], v2 offset:0
    ds_read_b64_tr_b16 v[88:89], v6 offset:16384
    v_mfma_f32_32x32x16_bf16 v[32:47], v[108:111], v[96:99], v[32:47]
    ds_read_b64_tr_b16 v[90:91], v6 offset:17408
    ds_read_b128 v[84:87], v2 offset:4096
    v_mfma_f32_32x32x16_bf16 v[48:63], v[104:107], v[100:103], v[48:63]
    ds_read_b64_tr_b16 v[92:93], v7 offset:16384
    ds_read_b64_tr_b16 v[94:95], v7 offset:17408
    v_mfma_f32_32x32x16_bf16 v[64:79], v[108:111], v[100:103], v[64:79]
    s_waitcnt lgkmcnt(0)
    v_mfma_f32_32x32x16_bf16 v[16:31], v[88:91], v[80:83], v[16:31]
    ds_read_b128 v[96:99], v3 offset:0
    ds_read_b64_tr_b16 v[104:105], v6 offset:20480
    v_mfma_f32_32x32x16_bf16 v[32:47], v[92:95], v[80:83], v[32:47]
    ds_read_b64_tr_b16 v[106:107], v6 offset:21504
    ds_read_b128 v[100:103], v3 offset:4096
    v_mfma_f32_32x32x16_bf16 v[48:63], v[88:91], v[84:87], v[48:63]
    ds_read_b64_tr_b16 v[108:109], v7 offset:20480
    ds_read_b64_tr_b16 v[110:111], v7 offset:21504
    v_mfma_f32_32x32x16_bf16 v[64:79], v[92:95], v[84:87], v[64:79]
    s_waitcnt lgkmcnt(0)
    v_mfma_f32_32x32x16_bf16 v[16:31], v[104:107], v[96:99], v[16:31]
    ds_read_b128 v[80:83], v4 offset:0
    ds_read_b64_tr_b16 v[88:89], v6 offset:24576
    v_mfma_f32_32x32x16_bf16 v[32:47], v[108:111], v[96:99], v[32:47]
    ds_read_b64_tr_b16 v[90:91], v6 offset:25600
    ds_read_b128 v[84:87], v4 offset:4096
    v_mfma_f32_32x32x16_bf16 v[48:63], v[104:107], v[100:103], v[48:63]
    ds_read_b64_tr_b16 v[92:93], v7 offset:24576
    ds_read_b64_tr_b16 v[94:95], v7 offset:25600
    v_mfma_f32_32x32x16_bf16 v[64:79], v[108:111], v[100:103], v[64:79]
    s_waitcnt lgkmcnt(0)
    v_mfma_f32_32x32x16_bf16 v[16:31], v[88:91], v[80:83], v[16:31]
    ds_read_b128 v[96:99], v5 offset:0
    ds_read_b64_tr_b16 v[104:105], v6 offset:28672
    v_mfma_f32_32x32x16_bf16 v[32:47], v[92:95], v[80:83], v[32:47]
    ds_read_b64_tr_b16 v[106:107], v6 offset:29696
    ds_read_b128 v[100:103], v5 offset:4096
    v_mfma_f32_32x32x16_bf16 v[48:63], v[88:91], v[84:87], v[48:63]
    ds_read_b64_tr_b16 v[108:109], v7 offset:28672
    ds_read_b64_tr_b16 v[110:111], v7 offset:29696
    v_mfma_f32_32x32x16_bf16 v[64:79], v[92:95], v[84:87], v[64:79]
    v_add_u32 v2, 0xffff0000, v2
    v_add_u32 v3, 0xffff0000, v3
    v_add_u32 v4, 0xffff0000, v4
    v_add_u32 v5, 0xffff0000, v5
    v_add_u32 v6, 0xffff0000, v6
    v_add_u32 v7, 0xffff0000, v7
    s_cmp_lt_u32 s7, 5
    s_cbranch_scc1 L_G_Q
    s_waitcnt lgkmcnt(0)
    s_barrier
    ds_read_b128 v[80:83], v2 offset:0
    ds_read_b64_tr_b16 v[88:89], v6 offset:16384
    ds_read_b64_tr_b16 v[90:91], v6 offset:17408
    v_mfma_f32_32x32x16_bf16 v[16:31], v[104:107], v[96:99], v[16:31]
    ds_read_b128 v[124:127], v3 offset:0
    ds_read_b64_tr_b16 v[132:133], v6 offset:20480
    v_mfma_f32_32x32x16_bf16 v[32:47], v[108:111], v[96:99], v[32:47]
    ds_read_b64_tr_b16 v[134:135], v6 offset:21504
    ds_read_b128 v[140:143], v4 offset:0
    v_mfma_f32_32x32x16_bf16 v[48:63], v[104:107], v[100:103], v[48:63]
    ds_read_b64_tr_b16 v[148:149], v6 offset:24576
    ds_read_b64_tr_b16 v[150:151], v6 offset:25600
    v_mfma_f32_32x32x16_bf16 v[64:79], v[108:111], v[100:103], v[64:79]
    ds_read_b128 v[96:99], v5 offset:0
    ds_read_b64_tr_b16 v[104:105], v6 offset:28672
    ds_read_b64_tr_b16 v[106:107], v6 offset:29696
    s_waitcnt lgkmcnt(9)
    v_mfma_f32_32x32x16_bf16 v[16:31], v[88:91], v[80:83], v[16:31]
    ds_read_b64_tr_b16 v[92:93], v7 offset:16384
    ds_read_b64_tr_b16 v[94:95], v7 offset:17408
    ds_read_b64_tr_b16 v[136:137], v7 offset:20480
    s_waitcnt lgkmcnt(9)
    v_mfma_f32_32x32x16_bf16 v[16:31], v[132:135], v[124:127], v[16:31]
    ds_read_b64_tr_b16 v[138:139], v7 offset:21504
    ds_read_b64_tr_b16 v[152:153], v7 offset:24576
    ds_read_b64_tr_b16 v[154:155], v7 offset:25600
    s_waitcnt lgkmcnt(9)
    v_mfma_f32_32x32x16_bf16 v[16:31], v[148:151], v[140:143], v[16:31]
    ds_read_b64_tr_b16 v[108:109], v7 offset:28672
    ds_read_b64_tr_b16 v[110:111], v7 offset:29696
    ds_read_b128 v[84:87], v2 offset:4096
    s_waitcnt lgkmcnt(9)
    v_mfma_f32_32x32x16_bf16 v[16:31], v[104:107], v[96:99], v[16:31]
    ds_read_b128 v[128:131], v3 offset:4096
    ds_read_b128 v[144:147], v4 offset:4096
    ds_read_b128 v[100:103], v5 offset:4096
    s_waitcnt lgkmcnt(10)
    v_mfma_f32_32x32x16_bf16 v[32:47], v[92:95], v[80:83], v[32:47]
    s_nop 6
    s_waitcnt lgkmcnt(8)
    v_mfma_f32_32x32x16_bf16 v[32:47], v[136:139], v[124:127], v[32:47]
    s_nop 1
    v_cvt_pk_bf16_f32 v16, v16, v17
    v_cvt_pk_bf16_f32 v17, v18, v19
    buffer_store_dwordx2 v[16:17], v112, s[16:19], s41 offen sc1
    v_cvt_pk_bf16_f32 v20, v20, v21
    s_waitcnt lgkmcnt(6)
    v_mfma_f32_32x32x16_bf16 v[32:47], v[152:155], v[140:143], v[32:47]
    v_cvt_pk_bf16_f32 v21, v22, v23
    buffer_store_dwordx2 v[20:21], v113, s[16:19], s41 offen sc1
    v_cvt_pk_bf16_f32 v24, v24, v25
    v_cvt_pk_bf16_f32 v25, v26, v27
    s_waitcnt lgkmcnt(4)
    v_mfma_f32_32x32x16_bf16 v[32:47], v[108:111], v[96:99], v[32:47]
    buffer_store_dwordx2 v[24:25], v114, s[16:19], s41 offen sc1
    v_cvt_pk_bf16_f32 v28, v28, v29
    v_cvt_pk_bf16_f32 v29, v30, v31
    buffer_store_dwordx2 v[28:29], v115, s[16:19], s41 offen sc1
    s_waitcnt lgkmcnt(3)
    v_mfma_f32_32x32x16_bf16 v[48:63], v[88:91], v[84:87], v[48:63]
    s_nop 6
    s_waitcnt lgkmcnt(2)
    v_mfma_f32_32x32x16_bf16 v[48:63], v[132:135], v[128:131], v[48:63]
    v_cvt_pk_bf16_f32 v32, v32, v33
    v_cvt_pk_bf16_f32 v33, v34, v35
    buffer_store_dwordx2 v[32:33], v116, s[16:19], s41 offen sc1
    v_cvt_pk_bf16_f32 v36, v36, v37
    s_waitcnt lgkmcnt(1)
    v_mfma_f32_32x32x16_bf16 v[48:63], v[148:151], v[144:147], v[48:63]
    v_cvt_pk_bf16_f32 v37, v38, v39
    buffer_store_dwordx2 v[36:37], v117, s[16:19], s41 offen sc1
    v_cvt_pk_bf16_f32 v40, v40, v41
    v_cvt_pk_bf16_f32 v41, v42, v43
    s_waitcnt lgkmcnt(0)
    v_mfma_f32_32x32x16_bf16 v[48:63], v[104:107], v[100:103], v[48:63]
    buffer_store_dwordx2 v[40:41], v118, s[16:19], s41 offen sc1
    v_cvt_pk_bf16_f32 v44, v44, v45
    v_cvt_pk_bf16_f32 v45, v46, v47
    buffer_store_dwordx2 v[44:45], v119, s[16:19], s41 offen sc1
    v_mfma_f32_32x32x16_bf16 v[64:79], v[92:95], v[84:87], v[64:79]
    s_nop 6
    v_mfma_f32_32x32x16_bf16 v[64:79], v[136:139], v[128:131], v[64:79]
    v_cvt_pk_bf16_f32 v48, v48, v49
    v_cvt_pk_bf16_f32 v49, v50, v51
    buffer_store_dwordx2 v[48:49], v112, s[16:19], s58 offen sc1
    v_cvt_pk_bf16_f32 v52, v52, v53
    v_mfma_f32_32x32x16_bf16 v[64:79], v[152:155], v[144:147], v[64:79]
    v_cvt_pk_bf16_f32 v53, v54, v55
    buffer_store_dwordx2 v[52:53], v113, s[16:19], s58 offen sc1
    v_cvt_pk_bf16_f32 v56, v56, v57
    v_cvt_pk_bf16_f32 v57, v58, v59
    v_mfma_f32_32x32x16_bf16 v[64:79], v[108:111], v[100:103], v[64:79]
    buffer_store_dwordx2 v[56:57], v114, s[16:19], s58 offen sc1
    v_cvt_pk_bf16_f32 v60, v60, v61
    v_cvt_pk_bf16_f32 v61, v62, v63
    buffer_store_dwordx2 v[60:61], v115, s[16:19], s58 offen sc1
    s_nop 11
    v_cvt_pk_bf16_f32 v64, v64, v65
    v_cvt_pk_bf16_f32 v65, v66, v67
    buffer_store_dwordx2 v[64:65], v116, s[16:19], s58 offen sc1
    v_cvt_pk_bf16_f32 v68, v68, v69
    v_cvt_pk_bf16_f32 v69, v70, v71
    buffer_store_dwordx2 v[68:69], v117, s[16:19], s58 offen sc1
    v_cvt_pk_bf16_f32 v72, v72, v73
    v_cvt_pk_bf16_f32 v73, v74, v75
    buffer_store_dwordx2 v[72:73], v118, s[16:19], s58 offen sc1
    v_cvt_pk_bf16_f32 v76, v76, v77
    v_cvt_pk_bf16_f32 v77, v78, v79
    buffer_store_dwordx2 v[76:77], v119, s[16:19], s58 offen sc1
    s_branch L_G_SIG
L_G_Q:
    s_waitcnt lgkmcnt(0)
    s_barrier
    ds_read_b128 v[80:83], v2 offset:0
    ds_read_b64_tr_b16 v[88:89], v6 offset:16384
    ds_read_b64_tr_b16 v[90:91], v6 offset:17408
    v_mfma_f32_32x32x16_bf16 v[16:31], v[104:107], v[96:99], v[16:31]
    ds_read_b128 v[124:127], v3 offset:0
    ds_read_b64_tr_b16 v[132:133], v6 offset:20480
    v_mfma_f32_32x32x16_bf16 v[32:47], v[108:111], v[96:99], v[32:47]
    ds_read_b64_tr_b16 v[134:135], v6 offset:21504
    ds_read_b128 v[140:143], v4 offset:0
    v_mfma_f32_32x32x16_bf16 v[48:63], v[104:107], v[100:103], v[48:63]
    ds_read_b64_tr_b16 v[148:149], v6 offset:24576
    ds_read_b64_tr_b16 v[150:151], v6 offset:25600
    v_mfma_f32_32x32x16_bf16 v[64:79], v[108:111], v[100:103], v[64:79]
    ds_read_b128 v[96:99], v5 offset:0
    ds_read_b64_tr_b16 v[104:105], v6 offset:28672
    ds_read_b64_tr_b16 v[106:107], v6 offset:29696
    s_waitcnt lgkmcnt(9)
    v_mfma_f32_32x32x16_bf16 v[16:31], v[88:91], v[80:83], v[16:31]
    ds_read_b64_tr_b16 v[92:93], v7 offset:16384
    ds_read_b64_tr_b16 v[94:95], v7 offset:17408
    ds_read_b64_tr_b16 v[136:137], v7 offset:20480
    s_waitcnt lgkmcnt(9)
    v_mfma_f32_32x32x16_bf16 v[16:31], v[132:135], v[124:127], v[16:31]
    ds_read_b64_tr_b16 v[138:139], v7 offset:21504
    ds_read_b64_tr_b16 v[152:153], v7 offset:24576
    ds_read_b64_tr_b16 v[154:155], v7 offset:25600
    s_waitcnt lgkmcnt(9)
    v_mfma_f32_32x32x16_bf16 v[16:31], v[148:151], v[140:143], v[16:31]
    ds_read_b64_tr_b16 v[108:109], v7 offset:28672
    ds_read_b64_tr_b16 v[110:111], v7 offset:29696
    ds_read_b128 v[84:87], v2 offset:4096
    s_waitcnt lgkmcnt(9)
    v_mfma_f32_32x32x16_bf16 v[16:31], v[104:107], v[96:99], v[16:31]
    ds_read_b128 v[128:131], v3 offset:4096
    ds_read_b128 v[144:147], v4 offset:4096
    ds_read_b128 v[100:103], v5 offset:4096
    s_waitcnt lgkmcnt(10)
    v_mfma_f32_32x32x16_bf16 v[32:47], v[92:95], v[80:83], v[32:47]
    s_nop 6
    s_waitcnt lgkmcnt(8)
    v_mfma_f32_32x32x16_bf16 v[32:47], v[136:139], v[124:127], v[32:47]
    s_nop 1
    v_mul_f32 v16, s42, v16
    v_mul_f32 v17, s42, v17
    v_mul_f32 v18, s42, v18
    v_mul_f32 v19, s42, v19
    v_cvt_pk_bf16_f32 v16, v16, v17
    v_cvt_pk_bf16_f32 v17, v18, v19
    buffer_store_dwordx2 v[16:17], v112, s[16:19], s41 offen sc1
    v_mul_f32 v20, s42, v20
    v_mul_f32 v21, s42, v21
    v_mul_f32 v22, s42, v22
    s_waitcnt lgkmcnt(6)
    v_mfma_f32_32x32x16_bf16 v[32:47], v[152:155], v[140:143], v[32:47]
    v_mul_f32 v23, s42, v23
    v_cvt_pk_bf16_f32 v20, v20, v21
    v_cvt_pk_bf16_f32 v21, v22, v23
    buffer_store_dwordx2 v[20:21], v113, s[16:19], s41 offen sc1
    v_mul_f32 v24, s42, v24
    v_mul_f32 v25, s42, v25
    v_mul_f32 v26, s42, v26
    v_mul_f32 v27, s42, v27
    v_cvt_pk_bf16_f32 v24, v24, v25
    s_waitcnt lgkmcnt(4)
    v_mfma_f32_32x32x16_bf16 v[32:47], v[108:111], v[96:99], v[32:47]
    v_cvt_pk_bf16_f32 v25, v26, v27
    buffer_store_dwordx2 v[24:25], v114, s[16:19], s41 offen sc1
    v_mul_f32 v28, s42, v28
    v_mul_f32 v29, s42, v29
    v_mul_f32 v30, s42, v30
    v_mul_f32 v31, s42, v31
    v_cvt_pk_bf16_f32 v28, v28, v29
    v_cvt_pk_bf16_f32 v29, v30, v31
    buffer_store_dwordx2 v[28:29], v115, s[16:19], s41 offen sc1
    s_waitcnt lgkmcnt(3)
    v_mfma_f32_32x32x16_bf16 v[48:63], v[88:91], v[84:87], v[48:63]
    s_nop 6
    s_waitcnt lgkmcnt(2)
    v_mfma_f32_32x32x16_bf16 v[48:63], v[132:135], v[128:131], v[48:63]
    v_mul_f32 v32, s42, v32
    v_mul_f32 v33, s42, v33
    v_mul_f32 v34, s42, v34
    v_mul_f32 v35, s42, v35
    v_cvt_pk_bf16_f32 v32, v32, v33
    v_cvt_pk_bf16_f32 v33, v34, v35
    buffer_store_dwordx2 v[32:33], v116, s[16:19], s41 offen sc1
    v_mul_f32 v36, s42, v36
    v_mul_f32 v37, s42, v37
    v_mul_f32 v38, s42, v38
    s_waitcnt lgkmcnt(1)
    v_mfma_f32_32x32x16_bf16 v[48:63], v[148:151], v[144:147], v[48:63]
    v_mul_f32 v39, s42, v39
    v_cvt_pk_bf16_f32 v36, v36, v37
    v_cvt_pk_bf16_f32 v37, v38, v39
    buffer_store_dwordx2 v[36:37], v117, s[16:19], s41 offen sc1
    v_mul_f32 v40, s42, v40
    v_mul_f32 v41, s42, v41
    v_mul_f32 v42, s42, v42
    v_mul_f32 v43, s42, v43
    v_cvt_pk_bf16_f32 v40, v40, v41
    s_waitcnt lgkmcnt(0)
    v_mfma_f32_32x32x16_bf16 v[48:63], v[104:107], v[100:103], v[48:63]
    v_cvt_pk_bf16_f32 v41, v42, v43
    buffer_store_dwordx2 v[40:41], v118, s[16:19], s41 offen sc1
    v_mul_f32 v44, s42, v44
    v_mul_f32 v45, s42, v45
    v_mul_f32 v46, s42, v46
    v_mul_f32 v47, s42, v47
    v_cvt_pk_bf16_f32 v44, v44, v45
    v_cvt_pk_bf16_f32 v45, v46, v47
    buffer_store_dwordx2 v[44:45], v119, s[16:19], s41 offen sc1
    v_mfma_f32_32x32x16_bf16 v[64:79], v[92:95], v[84:87], v[64:79]
    s_nop 6
    v_mfma_f32_32x32x16_bf16 v[64:79], v[136:139], v[128:131], v[64:79]
    v_mul_f32 v48, s42, v48
    v_mul_f32 v49, s42, v49
    v_mul_f32 v50, s42, v50
    v_mul_f32 v51, s42, v51
    v_cvt_pk_bf16_f32 v48, v48, v49
    v_cvt_pk_bf16_f32 v49, v50, v51
    buffer_store_dwordx2 v[48:49], v112, s[16:19], s58 offen sc1
    v_mul_f32 v52, s42, v52
    v_mul_f32 v53, s42, v53
    v_mul_f32 v54, s42, v54
    v_mfma_f32_32x32x16_bf16 v[64:79], v[152:155], v[144:147], v[64:79]
    v_mul_f32 v55, s42, v55
    v_cvt_pk_bf16_f32 v52, v52, v53
    v_cvt_pk_bf16_f32 v53, v54, v55
    buffer_store_dwordx2 v[52:53], v113, s[16:19], s58 offen sc1
    v_mul_f32 v56, s42, v56
    v_mul_f32 v57, s42, v57
    v_mul_f32 v58, s42, v58
    v_mul_f32 v59, s42, v59
    v_cvt_pk_bf16_f32 v56, v56, v57
    v_mfma_f32_32x32x16_bf16 v[64:79], v[108:111], v[100:103], v[64:79]
    v_cvt_pk_bf16_f32 v57, v58, v59
    buffer_store_dwordx2 v[56:57], v114, s[16:19], s58 offen sc1
    v_mul_f32 v60, s42, v60
    v_mul_f32 v61, s42, v61
    v_mul_f32 v62, s42, v62
    v_mul_f32 v63, s42, v63
    v_cvt_pk_bf16_f32 v60, v60, v61
    v_cvt_pk_bf16_f32 v61, v62, v63
    buffer_store_dwordx2 v[60:61], v115, s[16:19], s58 offen sc1
    s_nop 11
    v_mul_f32 v64, s42, v64
    v_mul_f32 v65, s42, v65
    v_mul_f32 v66, s42, v66
    v_mul_f32 v67, s42, v67
    v_cvt_pk_bf16_f32 v64, v64, v65
    v_cvt_pk_bf16_f32 v65, v66, v67
    buffer_store_dwordx2 v[64:65], v116, s[16:19], s58 offen sc1
    v_mul_f32 v68, s42, v68
    v_mul_f32 v69, s42, v69
    v_mul_f32 v70, s42, v70
    v_mul_f32 v71, s42, v71
    v_cvt_pk_bf16_f32 v68, v68, v69
    v_cvt_pk_bf16_f32 v69, v70, v71
    buffer_store_dwordx2 v[68:69], v117, s[16:19], s58 offen sc1
    v_mul_f32 v72, s42, v72
    v_mul_f32 v73, s42, v73
    v_mul_f32 v74, s42, v74
    v_mul_f32 v75, s42, v75
    v_cvt_pk_bf16_f32 v72, v72, v73
    v_cvt_pk_bf16_f32 v73, v74, v75
    buffer_store_dwordx2 v[72:73], v118, s[16:19], s58 offen sc1
    v_mul_f32 v76, s42, v76
    v_mul_f32 v77, s42, v77
    v_mul_f32 v78, s42, v78
    v_mul_f32 v79, s42, v79
    v_cvt_pk_bf16_f32 v76, v76, v77
    v_cvt_pk_bf16_f32 v77, v78, v79
    buffer_store_dwordx2 v[76:77], v119, s[16:19], s58 offen sc1
    s_branch L_G_SIG
L_G_V:
    s_mul_i32 s41, s38, 2560
    s_add_u32 s41, s41, 2622720
    s_mov_b32 s57, 163840
    s_lshl_b32 s88, s40, 7
    s_lshl_b32 s89, s37, 6
    s_add_u32 s88, s88, s89
    v_add_u32 v10, s88, v8
    v_mul_u32_u24 v9, 320, v9
    v_mul_u32_u24 v11, 3277, v10
    v_lshrrev_b32 v11, 16, v11
    v_mul_u32_u24 v12, 20, v11
    v_sub_u32 v12, v10, v12
    v_mul_lo_u32 v11, v11, s57
    v_lshl_add_u32 v12, v12, 4, v9
    v_add_u32 v112, v11, v12
    v_add_u32 v10, 32, v10
    v_mul_u32_u24 v11, 3277, v10
    v_lshrrev_b32 v11, 16, v11
    v_mul_u32_u24 v12, 20, v11
    v_sub_u32 v12, v10, v12
    v_mul_lo_u32 v11, v11, s57
    v_lshl_add_u32 v12, v12, 4, v9
    v_add_u32 v113, v11, v12
    s_barrier
    ds_read_b128 v[80:83], v2 offset:0
    ds_read_b64_tr_b16 v[88:89], v6 offset:16384
    ds_read_b64_tr_b16 v[90:91], v6 offset:17408
    ds_read_b128 v[84:87], v2 offset:4096
    ds_read_b64_tr_b16 v[92:93], v7 offset:16384
    ds_read_b64_tr_b16 v[94:95], v7 offset:17408
    s_waitcnt lgkmcnt(0)
    v_mfma_f32_32x32x16_bf16 v[16:31], v[80:83], v[88:91], 0
    ds_read_b128 v[96:99], v3 offset:0
    ds_read_b64_tr_b16 v[104:105], v6 offset:20480
    v_mfma_f32_32x32x16_bf16 v[32:47], v[80:83], v[92:95], 0
    ds_read_b64_tr_b16 v[106:107], v6 offset:21504
    ds_read_b128 v[100:103], v3 offset:4096
    v_mfma_f32_32x32x16_bf16 v[48:63], v[84:87], v[88:91], 0
    ds_read_b64_tr_b16 v[108:109], v7 offset:20480
    ds_read_b64_tr_b16 v[110:111], v7 offset:21504
    v_mfma_f32_32x32x16_bf16 v[64:79], v[84:87], v[92:95], 0
    s_waitcnt lgkmcnt(0)
    v_mfma_f32_32x32x16_bf16 v[16:31], v[96:99], v[104:107], v[16:31]
    ds_read_b128 v[80:83], v4 offset:0
    ds_read_b64_tr_b16 v[88:89], v6 offset:24576
    v_mfma_f32_32x32x16_bf16 v[32:47], v[96:99], v[108:111], v[32:47]
    ds_read_b64_tr_b16 v[90:91], v6 offset:25600
    ds_read_b128 v[84:87], v4 offset:4096
    v_mfma_f32_32x32x16_bf16 v[48:63], v[100:103], v[104:107], v[48:63]
    ds_read_b64_tr_b16 v[92:93], v7 offset:24576
    ds_read_b64_tr_b16 v[94:95], v7 offset:25600
    v_mfma_f32_32x32x16_bf16 v[64:79], v[100:103], v[108:111], v[64:79]
    s_waitcnt lgkmcnt(0)
    v_mfma_f32_32x32x16_bf16 v[16:31], v[80:83], v[88:91], v[16:31]
    ds_read_b128 v[96:99], v5 offset:0
    ds_read_b64_tr_b16 v[104:105], v6 offset:28672
    v_mfma_f32_32x32x16_bf16 v[32:47], v[80:83], v[92:95], v[32:47]
    ds_read_b64_tr_b16 v[106:107], v6 offset:29696
    ds_read_b128 v[100:103], v5 offset:4096
    v_mfma_f32_32x32x16_bf16 v[48:63], v[84:87], v[88:91], v[48:63]
    ds_read_b64_tr_b16 v[108:109], v7 offset:28672
    ds_read_b64_tr_b16 v[110:111], v7 offset:29696
    v_mfma_f32_32x32x16_bf16 v[64:79], v[84:87], v[92:95], v[64:79]
    v_add_u32 v2, 0x8000, v2
    v_add_u32 v3, 0x8000, v3
    v_add_u32 v4, 0x8000, v4
    v_add_u32 v5, 0x8000, v5
    v_add_u32 v6, 0x8000, v6
    v_add_u32 v7, 0x8000, v7
    s_waitcnt lgkmcnt(0)
    s_barrier
    v_mfma_f32_32x32x16_bf16 v[16:31], v[96:99], v[104:107], v[16:31]
    ds_read_b128 v[80:83], v2 offset:0
    ds_read_b64_tr_b16 v[88:89], v6 offset:16384
    v_mfma_f32_32x32x16_bf16 v[32:47], v[96:99], v[108:111], v[32:47]
    ds_read_b64_tr_b16 v[90:91], v6 offset:17408
    ds_read_b128 v[84:87], v2 offset:4096
    v_mfma_f32_32x32x16_bf16 v[48:63], v[100:103], v[104:107], v[48:63]
    ds_read_b64_tr_b16 v[92:93], v7 offset:16384
    ds_read_b64_tr_b16 v[94:95], v7 offset:17408
    v_mfma_f32_32x32x16_bf16 v[64:79], v[100:103], v[108:111], v[64:79]
    s_waitcnt lgkmcnt(0)
    v_mfma_f32_32x32x16_bf16 v[16:31], v[80:83], v[88:91], v[16:31]
    ds_read_b128 v[96:99], v3 offset:0
    ds_read_b64_tr_b16 v[104:105], v6 offset:20480
    v_mfma_f32_32x32x16_bf16 v[32:47], v[80:83], v[92:95], v[32:47]
    ds_read_b64_tr_b16 v[106:107], v6 offset:21504
    ds_read_b128 v[100:103], v3 offset:4096
    v_mfma_f32_32x32x16_bf16 v[48:63], v[84:87], v[88:91], v[48:63]
    ds_read_b64_tr_b16 v[108:109], v7 offset:20480
    ds_read_b64_tr_b16 v[110:111], v7 offset:21504
    v_mfma_f32_32x32x16_bf16 v[64:79], v[84:87], v[92:95], v[64:79]
    s_waitcnt lgkmcnt(0)
    v_mfma_f32_32x32x16_bf16 v[16:31], v[96:99], v[104:107], v[16:31]
    ds_read_b128 v[80:83], v4 offset:0
    ds_read_b64_tr_b16 v[88:89], v6 offset:24576
    v_mfma_f32_32x32x16_bf16 v[32:47], v[96:99], v[108:111], v[32:47]
    ds_read_b64_tr_b16 v[90:91], v6 offset:25600
    ds_read_b128 v[84:87], v4 offset:4096
    v_mfma_f32_32x32x16_bf16 v[48:63], v[100:103], v[104:107], v[48:63]
    ds_read_b64_tr_b16 v[92:93], v7 offset:24576
    ds_read_b64_tr_b16 v[94:95], v7 offset:25600
    v_mfma_f32_32x32x16_bf16 v[64:79], v[100:103], v[108:111], v[64:79]
    s_waitcnt lgkmcnt(0)
    v_mfma_f32_32x32x16_bf16 v[16:31], v[80:83], v[88:91], v[16:31]
    ds_read_b128 v[96:99], v5 offset:0
    ds_read_b64_tr_b16 v[104:105], v6 offset:28672
    v_mfma_f32_32x32x16_bf16 v[32:47], v[80:83], v[92:95], v[32:47]
    ds_read_b64_tr_b16 v[106:107], v6 offset:29696
    ds_read_b128 v[100:103], v5 offset:4096
    v_mfma_f32_32x32x16_bf16 v[48:63], v[84:87], v[88:91], v[48:63]
    ds_read_b64_tr_b16 v[108:109], v7 offset:28672
    ds_read_b64_tr_b16 v[110:111], v7 offset:29696
    v_mfma_f32_32x32x16_bf16 v[64:79], v[84:87], v[92:95], v[64:79]
    v_add_u32 v2, 0x8000, v2
    v_add_u32 v3, 0x8000, v3
    v_add_u32 v4, 0x8000, v4
    v_add_u32 v5, 0x8000, v5
    v_add_u32 v6, 0x8000, v6
    v_add_u32 v7, 0x8000, v7
    s_waitcnt lgkmcnt(0)
    s_barrier
    v_mfma_f32_32x32x16_bf16 v[16:31], v[96:99], v[104:107], v[16:31]
    ds_read_b128 v[80:83], v2 offset:0
    ds_read_b64_tr_b16 v[88:89], v6 offset:16384
    v_mfma_f32_32x32x16_bf16 v[32:47], v[96:99], v[108:111], v[32:47]
    ds_read_b64_tr_b16 v[90:91], v6 offset:17408
    ds_read_b128 v[84:87], v2 offset:4096
    v_mfma_f32_32x32x16_bf16 v[48:63], v[100:103], v[104:107], v[48:63]
    ds_read_b64_tr_b16 v[92:93], v7 offset:16384
    ds_read_b64_tr_b16 v[94:95], v7 offset:17408
    v_mfma_f32_32x32x16_bf16 v[64:79], v[100:103], v[108:111], v[64:79]
    s_waitcnt lgkmcnt(0)
    v_mfma_f32_32x32x16_bf16 v[16:31], v[80:83], v[88:91], v[16:31]
    ds_read_b128 v[96:99], v3 offset:0
    ds_read_b64_tr_b16 v[104:105], v6 offset:20480
    v_mfma_f32_32x32x16_bf16 v[32:47], v[80:83], v[92:95], v[32:47]
    ds_read_b64_tr_b16 v[106:107], v6 offset:21504
    ds_read_b128 v[100:103], v3 offset:4096
    v_mfma_f32_32x32x16_bf16 v[48:63], v[84:87], v[88:91], v[48:63]
    ds_read_b64_tr_b16 v[108:109], v7 offset:20480
    ds_read_b64_tr_b16 v[110:111], v7 offset:21504
    v_mfma_f32_32x32x16_bf16 v[64:79], v[84:87], v[92:95], v[64:79]
    s_waitcnt lgkmcnt(0)
    v_mfma_f32_32x32x16_bf16 v[16:31], v[96:99], v[104:107], v[16:31]
    ds_read_b128 v[80:83], v4 offset:0
    ds_read_b64_tr_b16 v[88:89], v6 offset:24576
    v_mfma_f32_32x32x16_bf16 v[32:47], v[96:99], v[108:111], v[32:47]
    ds_read_b64_tr_b16 v[90:91], v6 offset:25600
    ds_read_b128 v[84:87], v4 offset:4096
    v_mfma_f32_32x32x16_bf16 v[48:63], v[100:103], v[104:107], v[48:63]
    ds_read_b64_tr_b16 v[92:93], v7 offset:24576
    ds_read_b64_tr_b16 v[94:95], v7 offset:25600
    v_mfma_f32_32x32x16_bf16 v[64:79], v[100:103], v[108:111], v[64:79]
    s_waitcnt lgkmcnt(0)
    v_mfma_f32_32x32x16_bf16 v[16:31], v[80:83], v[88:91], v[16:31]
    ds_read_b128 v[96:99], v5 offset:0
    ds_read_b64_tr_b16 v[104:105], v6 offset:28672
    v_mfma_f32_32x32x16_bf16 v[32:47], v[80:83], v[92:95], v[32:47]
    ds_read_b64_tr_b16 v[106:107], v6 offset:29696
    ds_read_b128 v[100:103], v5 offset:4096
    v_mfma_f32_32x32x16_bf16 v[48:63], v[84:87], v[88:91], v[48:63]
    ds_read_b64_tr_b16 v[108:109], v7 offset:28672
    ds_read_b64_tr_b16 v[110:111], v7 offset:29696
    v_mfma_f32_32x32x16_bf16 v[64:79], v[84:87], v[92:95], v[64:79]
    v_add_u32 v2, 0xffff0000, v2
    v_add_u32 v3, 0xffff0000, v3
    v_add_u32 v4, 0xffff0000, v4
    v_add_u32 v5, 0xffff0000, v5
    v_add_u32 v6, 0xffff0000, v6
    v_add_u32 v7, 0xffff0000, v7
    s_waitcnt lgkmcnt(0)
    s_barrier
    v_mfma_f32_32x32x16_bf16 v[16:31], v[96:99], v[104:107], v[16:31]
    ds_read_b128 v[80:83], v2 offset:0
    ds_read_b64_tr_b16 v[88:89], v6 offset:16384
    v_mfma_f32_32x32x16_bf16 v[32:47], v[96:99], v[108:111], v[32:47]
    ds_read_b64_tr_b16 v[90:91], v6 offset:17408
    ds_read_b128 v[84:87], v2 offset:4096
    v_mfma_f32_32x32x16_bf16 v[48:63], v[100:103], v[104:107], v[48:63]
    ds_read_b64_tr_b16 v[92:93], v7 offset:16384
    ds_read_b64_tr_b16 v[94:95], v7 offset:17408
    v_mfma_f32_32x32x16_bf16 v[64:79], v[100:103], v[108:111], v[64:79]
    s_waitcnt lgkmcnt(0)
    v_mfma_f32_32x32x16_bf16 v[16:31], v[80:83], v[88:91], v[16:31]
    ds_read_b128 v[96:99], v3 offset:0
    ds_read_b64_tr_b16 v[104:105], v6 offset:20480
    v_mfma_f32_32x32x16_bf16 v[32:47], v[80:83], v[92:95], v[32:47]
    ds_read_b64_tr_b16 v[106:107], v6 offset:21504
    ds_read_b128 v[100:103], v3 offset:4096
    v_mfma_f32_32x32x16_bf16 v[48:63], v[84:87], v[88:91], v[48:63]
    ds_read_b64_tr_b16 v[108:109], v7 offset:20480
    ds_read_b64_tr_b16 v[110:111], v7 offset:21504
    v_mfma_f32_32x32x16_bf16 v[64:79], v[84:87], v[92:95], v[64:79]
    s_waitcnt lgkmcnt(0)
    v_mfma_f32_32x32x16_bf16 v[16:31], v[96:99], v[104:107], v[16:31]
    ds_read_b128 v[80:83], v4 offset:0
    ds_read_b64_tr_b16 v[88:89], v6 offset:24576
    v_mfma_f32_32x32x16_bf16 v[32:47], v[96:99], v[108:111], v[32:47]
    ds_read_b64_tr_b16 v[90:91], v6 offset:25600
    ds_read_b128 v[84:87], v4 offset:4096
    v_mfma_f32_32x32x16_bf16 v[48:63], v[100:103], v[104:107], v[48:63]
    ds_read_b64_tr_b16 v[92:93], v7 offset:24576
    ds_read_b64_tr_b16 v[94:95], v7 offset:25600
    v_mfma_f32_32x32x16_bf16 v[64:79], v[100:103], v[108:111], v[64:79]
    s_waitcnt lgkmcnt(0)
    v_mfma_f32_32x32x16_bf16 v[16:31], v[80:83], v[88:91], v[16:31]
    ds_read_b128 v[96:99], v5 offset:0
    ds_read_b64_tr_b16 v[104:105], v6 offset:28672
    v_mfma_f32_32x32x16_bf16 v[32:47], v[80:83], v[92:95], v[32:47]
    ds_read_b64_tr_b16 v[106:107], v6 offset:29696
    ds_read_b128 v[100:103], v5 offset:4096
    v_mfma_f32_32x32x16_bf16 v[48:63], v[84:87], v[88:91], v[48:63]
    ds_read_b64_tr_b16 v[108:109], v7 offset:28672
    ds_read_b64_tr_b16 v[110:111], v7 offset:29696
    v_mfma_f32_32x32x16_bf16 v[64:79], v[84:87], v[92:95], v[64:79]
    v_add_u32 v2, 0x8000, v2
    v_add_u32 v3, 0x8000, v3
    v_add_u32 v4, 0x8000, v4
    v_add_u32 v5, 0x8000, v5
    v_add_u32 v6, 0x8000, v6
    v_add_u32 v7, 0x8000, v7
    s_waitcnt lgkmcnt(0)
    s_barrier
    v_mfma_f32_32x32x16_bf16 v[16:31], v[96:99], v[104:107], v[16:31]
    ds_read_b128 v[80:83], v2 offset:0
    ds_read_b64_tr_b16 v[88:89], v6 offset:16384
    v_mfma_f32_32x32x16_bf16 v[32:47], v[96:99], v[108:111], v[32:47]
    ds_read_b64_tr_b16 v[90:91], v6 offset:17408
    ds_read_b128 v[84:87], v2 offset:4096
    v_mfma_f32_32x32x16_bf16 v[48:63], v[100:103], v[104:107], v[48:63]
    ds_read_b64_tr_b16 v[92:93], v7 offset:16384
    ds_read_b64_tr_b16 v[94:95], v7 offset:17408
    v_mfma_f32_32x32x16_bf16 v[64:79], v[100:103], v[108:111], v[64:79]
    s_waitcnt lgkmcnt(0)
    v_mfma_f32_32x32x16_bf16 v[16:31], v[80:83], v[88:91], v[16:31]
    ds_read_b128 v[96:99], v3 offset:0
    ds_read_b64_tr_b16 v[104:105], v6 offset:20480
    v_mfma_f32_32x32x16_bf16 v[32:47], v[80:83], v[92:95], v[32:47]
    ds_read_b64_tr_b16 v[106:107], v6 offset:21504
    ds_read_b128 v[100:103], v3 offset:4096
    v_mfma_f32_32x32x16_bf16 v[48:63], v[84:87], v[88:91], v[48:63]
    ds_read_b64_tr_b16 v[108:109], v7 offset:20480
    ds_read_b64_tr_b16 v[110:111], v7 offset:21504
    v_mfma_f32_32x32x16_bf16 v[64:79], v[84:87], v[92:95], v[64:79]
    s_waitcnt lgkmcnt(0)
    v_mfma_f32_32x32x16_bf16 v[16:31], v[96:99], v[104:107], v[16:31]
    ds_read_b128 v[80:83], v4 offset:0
    ds_read_b64_tr_b16 v[88:89], v6 offset:24576
    v_mfma_f32_32x32x16_bf16 v[32:47], v[96:99], v[108:111], v[32:47]
    ds_read_b64_tr_b16 v[90:91], v6 offset:25600
    ds_read_b128 v[84:87], v4 offset:4096
    v_mfma_f32_32x32x16_bf16 v[48:63], v[100:103], v[104:107], v[48:63]
    ds_read_b64_tr_b16 v[92:93], v7 offset:24576
    ds_read_b64_tr_b16 v[94:95], v7 offset:25600
    v_mfma_f32_32x32x16_bf16 v[64:79], v[100:103], v[108:111], v[64:79]
    s_waitcnt lgkmcnt(0)
    v_mfma_f32_32x32x16_bf16 v[16:31], v[80:83], v[88:91], v[16:31]
    ds_read_b128 v[96:99], v5 offset:0
    ds_read_b64_tr_b16 v[104:105], v6 offset:28672
    v_mfma_f32_32x32x16_bf16 v[32:47], v[80:83], v[92:95], v[32:47]
    ds_read_b64_tr_b16 v[106:107], v6 offset:29696
    ds_read_b128 v[100:103], v5 offset:4096
    v_mfma_f32_32x32x16_bf16 v[48:63], v[84:87], v[88:91], v[48:63]
    ds_read_b64_tr_b16 v[108:109], v7 offset:28672
    ds_read_b64_tr_b16 v[110:111], v7 offset:29696
    v_mfma_f32_32x32x16_bf16 v[64:79], v[84:87], v[92:95], v[64:79]
    v_add_u32 v2, 0x8000, v2
    v_add_u32 v3, 0x8000, v3
    v_add_u32 v4, 0x8000, v4
    v_add_u32 v5, 0x8000, v5
    v_add_u32 v6, 0x8000, v6
    v_add_u32 v7, 0x8000, v7
    s_waitcnt lgkmcnt(0)
    s_barrier
    v_mfma_f32_32x32x16_bf16 v[16:31], v[96:99], v[104:107], v[16:31]
    ds_read_b128 v[80:83], v2 offset:0
    ds_read_b64_tr_b16 v[88:89], v6 offset:16384
    v_mfma_f32_32x32x16_bf16 v[32:47], v[96:99], v[108:111], v[32:47]
    ds_read_b64_tr_b16 v[90:91], v6 offset:17408
    ds_read_b128 v[84:87], v2 offset:4096
    v_mfma_f32_32x32x16_bf16 v[48:63], v[100:103], v[104:107], v[48:63]
    ds_read_b64_tr_b16 v[92:93], v7 offset:16384
    ds_read_b64_tr_b16 v[94:95], v7 offset:17408
    v_mfma_f32_32x32x16_bf16 v[64:79], v[100:103], v[108:111], v[64:79]
    s_waitcnt lgkmcnt(0)
    v_mfma_f32_32x32x16_bf16 v[16:31], v[80:83], v[88:91], v[16:31]
    ds_read_b128 v[96:99], v3 offset:0
    ds_read_b64_tr_b16 v[104:105], v6 offset:20480
    v_mfma_f32_32x32x16_bf16 v[32:47], v[80:83], v[92:95], v[32:47]
    ds_read_b64_tr_b16 v[106:107], v6 offset:21504
    ds_read_b128 v[100:103], v3 offset:4096
    v_mfma_f32_32x32x16_bf16 v[48:63], v[84:87], v[88:91], v[48:63]
    ds_read_b64_tr_b16 v[108:109], v7 offset:20480
    ds_read_b64_tr_b16 v[110:111], v7 offset:21504
    v_mfma_f32_32x32x16_bf16 v[64:79], v[84:87], v[92:95], v[64:79]
    s_waitcnt lgkmcnt(0)
    v_mfma_f32_32x32x16_bf16 v[16:31], v[96:99], v[104:107], v[16:31]
    ds_read_b128 v[80:83], v4 offset:0
    ds_read_b64_tr_b16 v[88:89], v6 offset:24576
    v_mfma_f32_32x32x16_bf16 v[32:47], v[96:99], v[108:111], v[32:47]
    ds_read_b64_tr_b16 v[90:91], v6 offset:25600
    ds_read_b128 v[84:87], v4 offset:4096
    v_mfma_f32_32x32x16_bf16 v[48:63], v[100:103], v[104:107], v[48:63]
    ds_read_b64_tr_b16 v[92:93], v7 offset:24576
    ds_read_b64_tr_b16 v[94:95], v7 offset:25600
    v_mfma_f32_32x32x16_bf16 v[64:79], v[100:103], v[108:111], v[64:79]
    s_waitcnt lgkmcnt(0)
    v_mfma_f32_32x32x16_bf16 v[16:31], v[80:83], v[88:91], v[16:31]
    ds_read_b128 v[96:99], v5 offset:0
    ds_read_b64_tr_b16 v[104:105], v6 offset:28672
    v_mfma_f32_32x32x16_bf16 v[32:47], v[80:83], v[92:95], v[32:47]
    ds_read_b64_tr_b16 v[106:107], v6 offset:29696
    ds_read_b128 v[100:103], v5 offset:4096
    v_mfma_f32_32x32x16_bf16 v[48:63], v[84:87], v[88:91], v[48:63]
    ds_read_b64_tr_b16 v[108:109], v7 offset:28672
    ds_read_b64_tr_b16 v[110:111], v7 offset:29696
    v_mfma_f32_32x32x16_bf16 v[64:79], v[84:87], v[92:95], v[64:79]
    v_add_u32 v2, 0xffff0000, v2
    v_add_u32 v3, 0xffff0000, v3
    v_add_u32 v4, 0xffff0000, v4
    v_add_u32 v5, 0xffff0000, v5
    v_add_u32 v6, 0xffff0000, v6
    v_add_u32 v7, 0xffff0000, v7
    s_waitcnt lgkmcnt(0)
    s_barrier
    v_mfma_f32_32x32x16_bf16 v[16:31], v[96:99], v[104:107], v[16:31]
    ds_read_b128 v[80:83], v2 offset:0
    ds_read_b64_tr_b16 v[88:89], v6 offset:16384
    v_mfma_f32_32x32x16_bf16 v[32:47], v[96:99], v[108:111], v[32:47]
    ds_read_b64_tr_b16 v[90:91], v6 offset:17408
    ds_read_b128 v[84:87], v2 offset:4096
    v_mfma_f32_32x32x16_bf16 v[48:63], v[100:103], v[104:107], v[48:63]
    ds_read_b64_tr_b16 v[92:93], v7 offset:16384
    ds_read_b64_tr_b16 v[94:95], v7 offset:17408
    v_mfma_f32_32x32x16_bf16 v[64:79], v[100:103], v[108:111], v[64:79]
    s_waitcnt lgkmcnt(0)
    v_mfma_f32_32x32x16_bf16 v[16:31], v[80:83], v[88:91], v[16:31]
    ds_read_b128 v[96:99], v3 offset:0
    ds_read_b64_tr_b16 v[104:105], v6 offset:20480
    v_mfma_f32_32x32x16_bf16 v[32:47], v[80:83], v[92:95], v[32:47]
    ds_read_b64_tr_b16 v[106:107], v6 offset:21504
    ds_read_b128 v[100:103], v3 offset:4096
    v_mfma_f32_32x32x16_bf16 v[48:63], v[84:87], v[88:91], v[48:63]
    ds_read_b64_tr_b16 v[108:109], v7 offset:20480
    ds_read_b64_tr_b16 v[110:111], v7 offset:21504
    v_mfma_f32_32x32x16_bf16 v[64:79], v[84:87], v[92:95], v[64:79]
    s_waitcnt lgkmcnt(0)
    v_mfma_f32_32x32x16_bf16 v[16:31], v[96:99], v[104:107], v[16:31]
    ds_read_b128 v[80:83], v4 offset:0
    ds_read_b64_tr_b16 v[88:89], v6 offset:24576
    v_mfma_f32_32x32x16_bf16 v[32:47], v[96:99], v[108:111], v[32:47]
    ds_read_b64_tr_b16 v[90:91], v6 offset:25600
    ds_read_b128 v[84:87], v4 offset:4096
    v_mfma_f32_32x32x16_bf16 v[48:63], v[100:103], v[104:107], v[48:63]
    ds_read_b64_tr_b16 v[92:93], v7 offset:24576
    ds_read_b64_tr_b16 v[94:95], v7 offset:25600
    v_mfma_f32_32x32x16_bf16 v[64:79], v[100:103], v[108:111], v[64:79]
    s_waitcnt lgkmcnt(0)
    v_mfma_f32_32x32x16_bf16 v[16:31], v[80:83], v[88:91], v[16:31]
    ds_read_b128 v[96:99], v5 offset:0
    ds_read_b64_tr_b16 v[104:105], v6 offset:28672
    v_mfma_f32_32x32x16_bf16 v[32:47], v[80:83], v[92:95], v[32:47]
    ds_read_b64_tr_b16 v[106:107], v6 offset:29696
    ds_read_b128 v[100:103], v5 offset:4096
    v_mfma_f32_32x32x16_bf16 v[48:63], v[84:87], v[88:91], v[48:63]
    ds_read_b64_tr_b16 v[108:109], v7 offset:28672
    ds_read_b64_tr_b16 v[110:111], v7 offset:29696
    v_mfma_f32_32x32x16_bf16 v[64:79], v[84:87], v[92:95], v[64:79]
    v_add_u32 v2, 0x8000, v2
    v_add_u32 v3, 0x8000, v3
    v_add_u32 v4, 0x8000, v4
    v_add_u32 v5, 0x8000, v5
    v_add_u32 v6, 0x8000, v6
    v_add_u32 v7, 0x8000, v7
    s_waitcnt lgkmcnt(0)
    s_barrier
    v_mfma_f32_32x32x16_bf16 v[16:31], v[96:99], v[104:107], v[16:31]
    ds_read_b128 v[80:83], v2 offset:0
    ds_read_b64_tr_b16 v[88:89], v6 offset:16384
    v_mfma_f32_32x32x16_bf16 v[32:47], v[96:99], v[108:111], v[32:47]
    ds_read_b64_tr_b16 v[90:91], v6 offset:17408
    ds_read_b128 v[84:87], v2 offset:4096
    v_mfma_f32_32x32x16_bf16 v[48:63], v[100:103], v[104:107], v[48:63]
    ds_read_b64_tr_b16 v[92:93], v7 offset:16384
    ds_read_b64_tr_b16 v[94:95], v7 offset:17408
    v_mfma_f32_32x32x16_bf16 v[64:79], v[100:103], v[108:111], v[64:79]
    s_waitcnt lgkmcnt(0)
    v_mfma_f32_32x32x16_bf16 v[16:31], v[80:83], v[88:91], v[16:31]
    ds_read_b128 v[96:99], v3 offset:0
    ds_read_b64_tr_b16 v[104:105], v6 offset:20480
    v_mfma_f32_32x32x16_bf16 v[32:47], v[80:83], v[92:95], v[32:47]
    ds_read_b64_tr_b16 v[106:107], v6 offset:21504
    ds_read_b128 v[100:103], v3 offset:4096
    v_mfma_f32_32x32x16_bf16 v[48:63], v[84:87], v[88:91], v[48:63]
    ds_read_b64_tr_b16 v[108:109], v7 offset:20480
    ds_read_b64_tr_b16 v[110:111], v7 offset:21504
    v_mfma_f32_32x32x16_bf16 v[64:79], v[84:87], v[92:95], v[64:79]
    s_waitcnt lgkmcnt(0)
    v_mfma_f32_32x32x16_bf16 v[16:31], v[96:99], v[104:107], v[16:31]
    ds_read_b128 v[80:83], v4 offset:0
    ds_read_b64_tr_b16 v[88:89], v6 offset:24576
    v_mfma_f32_32x32x16_bf16 v[32:47], v[96:99], v[108:111], v[32:47]
    ds_read_b64_tr_b16 v[90:91], v6 offset:25600
    ds_read_b128 v[84:87], v4 offset:4096
    v_mfma_f32_32x32x16_bf16 v[48:63], v[100:103], v[104:107], v[48:63]
    ds_read_b64_tr_b16 v[92:93], v7 offset:24576
    ds_read_b64_tr_b16 v[94:95], v7 offset:25600
    v_mfma_f32_32x32x16_bf16 v[64:79], v[100:103], v[108:111], v[64:79]
    s_waitcnt lgkmcnt(0)
    v_mfma_f32_32x32x16_bf16 v[16:31], v[80:83], v[88:91], v[16:31]
    ds_read_b128 v[96:99], v5 offset:0
    ds_read_b64_tr_b16 v[104:105], v6 offset:28672
    v_mfma_f32_32x32x16_bf16 v[32:47], v[80:83], v[92:95], v[32:47]
    ds_read_b64_tr_b16 v[106:107], v6 offset:29696
    ds_read_b128 v[100:103], v5 offset:4096
    v_mfma_f32_32x32x16_bf16 v[48:63], v[84:87], v[88:91], v[48:63]
    ds_read_b64_tr_b16 v[108:109], v7 offset:28672
    ds_read_b64_tr_b16 v[110:111], v7 offset:29696
    v_mfma_f32_32x32x16_bf16 v[64:79], v[84:87], v[92:95], v[64:79]
    v_add_u32 v2, 0x8000, v2
    v_add_u32 v3, 0x8000, v3
    v_add_u32 v4, 0x8000, v4
    v_add_u32 v5, 0x8000, v5
    v_add_u32 v6, 0x8000, v6
    v_add_u32 v7, 0x8000, v7
    s_waitcnt lgkmcnt(0)
    s_barrier
    v_mfma_f32_32x32x16_bf16 v[16:31], v[96:99], v[104:107], v[16:31]
    ds_read_b128 v[80:83], v2 offset:0
    ds_read_b64_tr_b16 v[88:89], v6 offset:16384
    v_mfma_f32_32x32x16_bf16 v[32:47], v[96:99], v[108:111], v[32:47]
    ds_read_b64_tr_b16 v[90:91], v6 offset:17408
    ds_read_b128 v[84:87], v2 offset:4096
    v_mfma_f32_32x32x16_bf16 v[48:63], v[100:103], v[104:107], v[48:63]
    ds_read_b64_tr_b16 v[92:93], v7 offset:16384
    ds_read_b64_tr_b16 v[94:95], v7 offset:17408
    v_mfma_f32_32x32x16_bf16 v[64:79], v[100:103], v[108:111], v[64:79]
    s_waitcnt lgkmcnt(0)
    v_mfma_f32_32x32x16_bf16 v[16:31], v[80:83], v[88:91], v[16:31]
    ds_read_b128 v[96:99], v3 offset:0
    ds_read_b64_tr_b16 v[104:105], v6 offset:20480
    v_mfma_f32_32x32x16_bf16 v[32:47], v[80:83], v[92:95], v[32:47]
    ds_read_b64_tr_b16 v[106:107], v6 offset:21504
    ds_read_b128 v[100:103], v3 offset:4096
    v_mfma_f32_32x32x16_bf16 v[48:63], v[84:87], v[88:91], v[48:63]
    ds_read_b64_tr_b16 v[108:109], v7 offset:20480
    ds_read_b64_tr_b16 v[110:111], v7 offset:21504
    v_mfma_f32_32x32x16_bf16 v[64:79], v[84:87], v[92:95], v[64:79]
    s_waitcnt lgkmcnt(0)
    v_mfma_f32_32x32x16_bf16 v[16:31], v[96:99], v[104:107], v[16:31]
    ds_read_b128 v[80:83], v4 offset:0
    ds_read_b64_tr_b16 v[88:89], v6 offset:24576
    v_mfma_f32_32x32x16_bf16 v[32:47], v[96:99], v[108:111], v[32:47]
    ds_read_b64_tr_b16 v[90:91], v6 offset:25600
    ds_read_b128 v[84:87], v4 offset:4096
    v_mfma_f32_32x32x16_bf16 v[48:63], v[100:103], v[104:107], v[48:63]
    ds_read_b64_tr_b16 v[92:93], v7 offset:24576
    ds_read_b64_tr_b16 v[94:95], v7 offset:25600
    v_mfma_f32_32x32x16_bf16 v[64:79], v[100:103], v[108:111], v[64:79]
    s_waitcnt lgkmcnt(0)
    v_mfma_f32_32x32x16_bf16 v[16:31], v[80:83], v[88:91], v[16:31]
    ds_read_b128 v[96:99], v5 offset:0
    ds_read_b64_tr_b16 v[104:105], v6 offset:28672
    v_mfma_f32_32x32x16_bf16 v[32:47], v[80:83], v[92:95], v[32:47]
    ds_read_b64_tr_b16 v[106:107], v6 offset:29696
    ds_read_b128 v[100:103], v5 offset:4096
    v_mfma_f32_32x32x16_bf16 v[48:63], v[84:87], v[88:91], v[48:63]
    ds_read_b64_tr_b16 v[108:109], v7 offset:28672
    ds_read_b64_tr_b16 v[110:111], v7 offset:29696
    v_mfma_f32_32x32x16_bf16 v[64:79], v[84:87], v[92:95], v[64:79]
    v_add_u32 v2, 0xffff0000, v2
    v_add_u32 v3, 0xffff0000, v3
    v_add_u32 v4, 0xffff0000, v4
    v_add_u32 v5, 0xffff0000, v5
    v_add_u32 v6, 0xffff0000, v6
    v_add_u32 v7, 0xffff0000, v7
    s_waitcnt lgkmcnt(0)
    s_barrier
    ds_read_b128 v[80:83], v2 offset:0
    ds_read_b64_tr_b16 v[88:89], v6 offset:16384
    ds_read_b64_tr_b16 v[90:91], v6 offset:17408
    v_mfma_f32_32x32x16_bf16 v[16:31], v[96:99], v[104:107], v[16:31]
    ds_read_b128 v[124:127], v3 offset:0
    ds_read_b64_tr_b16 v[132:133], v6 offset:20480
    v_mfma_f32_32x32x16_bf16 v[32:47], v[96:99], v[108:111], v[32:47]
    ds_read_b64_tr_b16 v[134:135], v6 offset:21504
    ds_read_b128 v[140:143], v4 offset:0
    v_mfma_f32_32x32x16_bf16 v[48:63], v[100:103], v[104:107], v[48:63]
    ds_read_b64_tr_b16 v[148:149], v6 offset:24576
    ds_read_b64_tr_b16 v[150:151], v6 offset:25600
    v_mfma_f32_32x32x16_bf16 v[64:79], v[100:103], v[108:111], v[64:79]
    ds_read_b128 v[96:99], v5 offset:0
    ds_read_b64_tr_b16 v[104:105], v6 offset:28672
    ds_read_b64_tr_b16 v[106:107], v6 offset:29696
    s_waitcnt lgkmcnt(9)
    v_mfma_f32_32x32x16_bf16 v[16:31], v[80:83], v[88:91], v[16:31]
    ds_read_b64_tr_b16 v[92:93], v7 offset:16384
    ds_read_b64_tr_b16 v[94:95], v7 offset:17408
    ds_read_b64_tr_b16 v[136:137], v7 offset:20480
    s_waitcnt lgkmcnt(9)
    v_mfma_f32_32x32x16_bf16 v[16:31], v[124:127], v[132:135], v[16:31]
    ds_read_b64_tr_b16 v[138:139], v7 offset:21504
    ds_read_b64_tr_b16 v[152:153], v7 offset:24576
    ds_read_b64_tr_b16 v[154:155], v7 offset:25600
    s_waitcnt lgkmcnt(9)
    v_mfma_f32_32x32x16_bf16 v[16:31], v[140:143], v[148:151], v[16:31]
    ds_read_b64_tr_b16 v[108:109], v7 offset:28672
    ds_read_b64_tr_b16 v[110:111], v7 offset:29696
    ds_read_b128 v[84:87], v2 offset:4096
    s_waitcnt lgkmcnt(9)
    v_mfma_f32_32x32x16_bf16 v[16:31], v[96:99], v[104:107], v[16:31]
    ds_read_b128 v[128:131], v3 offset:4096
    ds_read_b128 v[144:147], v4 offset:4096
    ds_read_b128 v[100:103], v5 offset:4096
    s_waitcnt lgkmcnt(10)
    v_mfma_f32_32x32x16_bf16 v[32:47], v[80:83], v[92:95], v[32:47]
    s_nop 6
    s_waitcnt lgkmcnt(8)
    v_mfma_f32_32x32x16_bf16 v[32:47], v[124:127], v[136:139], v[32:47]
    s_nop 1
    v_cvt_pk_bf16_f32 v16, v16, v17
    v_cvt_pk_bf16_f32 v17, v18, v19
    v_cvt_pk_bf16_f32 v18, v20, v21
    v_cvt_pk_bf16_f32 v19, v22, v23
    s_waitcnt lgkmcnt(6)
    v_mfma_f32_32x32x16_bf16 v[32:47], v[140:143], v[152:155], v[32:47]
    buffer_store_dwordx4 v[16:19], v112, s[16:19], s41 offen offset:0 sc1
    v_cvt_pk_bf16_f32 v24, v24, v25
    v_cvt_pk_bf16_f32 v25, v26, v27
    s_waitcnt lgkmcnt(4)
    v_mfma_f32_32x32x16_bf16 v[32:47], v[96:99], v[108:111], v[32:47]
    v_cvt_pk_bf16_f32 v26, v28, v29
    v_cvt_pk_bf16_f32 v27, v30, v31
    buffer_store_dwordx4 v[24:27], v112, s[16:19], s41 offen offset:640 sc1
    s_waitcnt lgkmcnt(3)
    v_mfma_f32_32x32x16_bf16 v[48:63], v[84:87], v[88:91], v[48:63]
    s_nop 6
    s_waitcnt lgkmcnt(2)
    v_mfma_f32_32x32x16_bf16 v[48:63], v[128:131], v[132:135], v[48:63]
    v_cvt_pk_bf16_f32 v32, v32, v33
    v_cvt_pk_bf16_f32 v33, v34, v35
    v_cvt_pk_bf16_f32 v34, v36, v37
    v_cvt_pk_bf16_f32 v35, v38, v39
    s_waitcnt lgkmcnt(1)
    v_mfma_f32_32x32x16_bf16 v[48:63], v[144:147], v[148:151], v[48:63]
    buffer_store_dwordx4 v[32:35], v113, s[16:19], s41 offen offset:0 sc1
    v_cvt_pk_bf16_f32 v40, v40, v41
    v_cvt_pk_bf16_f32 v41, v42, v43
    s_waitcnt lgkmcnt(0)
    v_mfma_f32_32x32x16_bf16 v[48:63], v[100:103], v[104:107], v[48:63]
    v_cvt_pk_bf16_f32 v42, v44, v45
    v_cvt_pk_bf16_f32 v43, v46, v47
    buffer_store_dwordx4 v[40:43], v113, s[16:19], s41 offen offset:640 sc1
    v_mfma_f32_32x32x16_bf16 v[64:79], v[84:87], v[92:95], v[64:79]
    s_nop 6
    v_mfma_f32_32x32x16_bf16 v[64:79], v[128:131], v[136:139], v[64:79]
    v_cvt_pk_bf16_f32 v48, v48, v49
    v_cvt_pk_bf16_f32 v49, v50, v51
    v_cvt_pk_bf16_f32 v50, v52, v53
    v_cvt_pk_bf16_f32 v51, v54, v55
    v_mfma_f32_32x32x16_bf16 v[64:79], v[144:147], v[152:155], v[64:79]
    buffer_store_dwordx4 v[48:51], v112, s[16:19], s41 offen offset:2560 sc1
    v_cvt_pk_bf16_f32 v56, v56, v57
    v_cvt_pk_bf16_f32 v57, v58, v59
    v_mfma_f32_32x32x16_bf16 v[64:79], v[100:103], v[108:111], v[64:79]
    v_cvt_pk_bf16_f32 v58, v60, v61
    v_cvt_pk_bf16_f32 v59, v62, v63
    buffer_store_dwordx4 v[56:59], v112, s[16:19], s41 offen offset:3200 sc1
    s_nop 11
    v_cvt_pk_bf16_f32 v64, v64, v65
    v_cvt_pk_bf16_f32 v65, v66, v67
    v_cvt_pk_bf16_f32 v66, v68, v69
    v_cvt_pk_bf16_f32 v67, v70, v71
    buffer_store_dwordx4 v[64:67], v113, s[16:19], s41 offen offset:2560 sc1
    v_cvt_pk_bf16_f32 v72, v72, v73
    v_cvt_pk_bf16_f32 v73, v74, v75
    v_cvt_pk_bf16_f32 v74, v76, v77
    v_cvt_pk_bf16_f32 v75, v78, v79
    buffer_store_dwordx4 v[72:75], v113, s[16:19], s41 offen offset:3200 sc1
L_G_SIG:
L_G_CNT:
    v_mov_b32 v2, 114432
    v_mov_b32 v3, 1
    s_mov_b64 exec, 1
    ds_add_u32 v2, v3 offset:32
    s_waitcnt vmcnt(0)
    ds_add_rtn_u32 v4, v2, v3 offset:0
    ds_read_b32 v5, v2 offset:36
    s_waitcnt lgkmcnt(0)
    v_cmp_eq_u32 vcc, 3, v4
    s_cbranch_vccz L_G_DONE
    v_cmp_eq_u32 vcc, 1, v5
    s_cbranch_vccnz L_G_FL
    s_mov_b32 s63, 0
L_GGO:
    ds_read_b32 v5, v2 offset:36
    s_add_u32 s63, s63, 1
    s_waitcnt lgkmcnt(0)
    v_readfirstlane_b32 s88, v5
    s_cmp_gt_u32 s63, 200000
    s_cselect_b32 s88, 1, s88
    s_cmp_ge_u32 s88, 1
    s_cbranch_scc0 L_GGO
L_G_FL:
    s_mov_b64 exec, -1
    buffer_atomic_add v3, v120, s[16:19], 0 offen sc1
L_G_DONE:
    s_waitcnt lgkmcnt(0)
    s_mov_b64 exec, -1
    s_branch L_ATT
L_SSM:
    s_mov_b32 s16, s60
    s_and_b32 s17, s61, 0xffff
    s_mov_b32 s18, 0x1000000
    s_mov_b32 s19, 0x00020000
    s_mov_b32 s24, s56
    s_and_b32 s25, s57, 0xffff
    s_mov_b32 s26, 0x500000
    s_mov_b32 s27, 0x00020000
    s_mov_b32 s28, s40
    s_and_b32 s29, s41, 0xffff
    s_mov_b32 s30, 0xc8000
    s_mov_b32 s31, 0x00020000
    s_mov_b32 s32, s58
    s_and_b32 s33, s59, 0xffff
    s_mov_b32 s34, 0x100
    s_mov_b32 s35, 0x00020000
    s_lshl_b32 s36, s90, 14
    s_add_u32 s37, s36, 98304
    s_mov_b32 s36, s37
    v_mov_b32 v1, 114432
    v_lshl_add_u32 v2, v0, 2, s37
    v_mul_u32_u24 v13, 240, v0
    v_add_u32 v3, s36, v13
    v_and_b32 v26, 31, v0
    v_lshrrev_b32 v27, 5, v0
    v_bfe_u32 v13, v0, 2, 2
    v_lshl_add_u32 v13, v13, 2, v27
    v_mul_u32_u24 v13, 240, v13
    v_bfe_u32 v14, v0, 4, 1
    v_lshl_add_u32 v13, v14, 5, v13
    v_and_b32 v14, 3, v0
    v_lshl_add_u32 v13, v14, 3, v13
    v_add_u32 v4, s36, v13
    v_lshl_add_u32 v13, v27, 3, s37
    v_lshl_add_u32 v5, v26, 4, v13
    v_cmp_eq_u32 vcc, 0, v27
    v_lshl_add_u32 v13, v26, 3, s37
    v_lshl_add_u32 v14, v26, 2, s37
    v_add_u32 v9, 512, v13
    v_add_u32 v15, 768, v14
    v_cndmask_b32 v6, v15, v9, vcc
    v_add_u32 v9, 516, v13
    v_add_u32 v15, 896, v14
    v_cndmask_b32 v7, v15, v9, vcc
    v_lshl_add_u32 v13, v27, 8, s37
    v_lshl_add_u32 v8, v26, 1, v13
    v_lshl_add_u32 v13, v0, 3, s37
    v_lshlrev_b32 v14, 6, v27
    s_mul_i32 s38, s90, 16384
    s_add_u32 s38, s38, 102912
    v_lshl_add_u32 v10, v26, 4, s38
    v_sub_u32 v10, v10, v14
    v_bfe_u32 v12, v0, 4, 1
    v_lshl_add_u32 v14, v12, 5, v14
    v_and_b32 v12, 3, v0
    v_bfe_u32 v15, v0, 2, 2
    v_add_u32 v12, v12, v15
    v_lshl_add_u32 v14, v12, 3, v14
    v_add_u32 v11, s37, v14
    v_lshl_add_u32 v12, v0, 1, s37
    v_lshl_add_u32 v14, v0, 4, s37
    v_lshl_add_u32 v15, v0, 5, s37
    v_add_u32 v9, 14464, v2
    s_mov_b32 s56, 0x01000100
    s_mov_b32 s57, 0x03020302
    s_mov_b32 s58, 0x05040302
    s_lshr_b32 s88, s91, 6
    s_lshl_b32 s101, s88, 11
    s_add_u32 s101, s101, 10489864
    s_mul_i32 s100, s88, 278528
    s_and_b32 s88, s91, 60
    s_lshl_b32 s88, s88, 4
    s_add_u32 s100, s100, s88
    s_lshl_b32 s88, s90, 10
    s_add_u32 s100, s100, s88
    s_add_u32 s100, s100, 11534336
    s_waitcnt vmcnt(0)
    v_lshlrev_b32 v16, 16, v17
    v_and_b32 v17, 0xffff0000, v17
    v_lshlrev_b32 v18, 16, v19
    v_and_b32 v19, 0xffff0000, v19
    v_lshlrev_b32 v20, 16, v21
    v_and_b32 v21, 0xffff0000, v21
    v_lshlrev_b32 v22, 16, v23
    v_and_b32 v23, 0xffff0000, v23
    v_lshlrev_b32 v24, 16, v24
    v_lshlrev_b32 v25, 16, v25
    v_mul_f32 v24, 0x3fb8aa3b, v24
    v_mul_f32 v16, 0x3fb8aa3b, v16
    v_mul_f32 v17, 0x3fb8aa3b, v17
    v_exp_f32 v24, v24
    v_exp_f32 v16, v16
    v_exp_f32 v17, v17
    v_cmp_eq_u32 vcc, 0, v0
    v_cvt_pk_bf16_f32 v24, v24, v24
    v_and_b32 v24, 0xffff0000, v24
    v_cvt_pk_bf16_f32 v16, v16, v16
    v_and_b32 v16, 0xffff0000, v16
    v_cvt_pk_bf16_f32 v17, v17, v17
    v_and_b32 v17, 0xffff0000, v17
    v_cndmask_b32 v25, 0, v25, vcc
    v_mul_f32 v16, v16, v24
    v_mul_f32 v16, 0xbfb8aa3b, v16
    v_mul_f32 v18, v18, v24
    v_mul_f32 v18, 0.15915494, v18
    v_mul_f32 v17, v17, v24
    v_mul_f32 v17, 0xbfb8aa3b, v17
    v_mul_f32 v19, v19, v24
    v_mul_f32 v19, 0.15915494, v19
    v_add_f32 v24, v24, v24
    v_mul_f32 v20, v20, v24
    v_mul_f32 v21, v21, v24
    v_mul_f32 v22, v22, v24
    v_mul_f32 v23, v23, v24
    v_cmp_eq_u32 vcc, 63, v0
    v_mul_f32 v162, 0x43800000, v16
    v_mul_f32 v164, 0x41000000, v16
    v_exp_f32 v166, v16
    v_mul_f32 v163, 0x43800000, v18
    v_mul_f32 v165, 0x41000000, v18
    v_fract_f32 v167, v18
    v_exp_f32 v162, v162
    v_exp_f32 v164, v164
    v_cos_f32 v140, v167
    v_fract_f32 v163, v163
    v_fract_f32 v165, v165
    v_sin_f32 v141, v167
    v_cos_f32 v148, v163
    v_cos_f32 v160, v165
    v_mul_f32 v140, v140, v166
    v_sin_f32 v149, v163
    v_sin_f32 v161, v165
    v_mul_f32 v141, v141, v166
    v_mul_f32 v148, v148, v162
    v_mul_f32 v160, v160, v164
    v_mul_f32 v149, v149, v162
    v_mul_f32 v161, v161, v164
    v_cvt_pk_bf16_f32 v60, 1.0, v140
    v_cvt_pk_bf16_f32 v72, 0, v141
    v_pk_mul_f32 v[142:143], v[140:141], v[140:141] op_sel:[0,0] op_sel_hi:[1,0]
    v_pk_fma_f32 v[142:143], v[140:141], v[140:141], v[142:143] op_sel:[1,1,0] op_sel_hi:[0,1,1] neg_lo:[1,0,0]
    v_pk_mul_f32 v[158:159], v[142:143], v[140:141] op_sel:[0,0] op_sel_hi:[1,0]
    v_pk_fma_f32 v[158:159], v[142:143], v[140:141], v[158:159] op_sel:[1,1,0] op_sel_hi:[0,1,1] neg_lo:[1,0,0]
    v_cvt_pk_bf16_f32 v61, v142, v158
    v_cvt_pk_bf16_f32 v73, v143, v159
    v_pk_mul_f32 v[144:145], v[142:143], v[142:143] op_sel:[0,0] op_sel_hi:[1,0]
    v_pk_fma_f32 v[144:145], v[142:143], v[142:143], v[144:145] op_sel:[1,1,0] op_sel_hi:[0,1,1] neg_lo:[1,0,0]
    v_pk_mul_f32 v[158:159], v[144:145], v[140:141] op_sel:[0,0] op_sel_hi:[1,0]
    v_pk_fma_f32 v[158:159], v[144:145], v[140:141], v[158:159] op_sel:[1,1,0] op_sel_hi:[0,1,1] neg_lo:[1,0,0]
    v_cvt_pk_bf16_f32 v62, v144, v158
    v_cvt_pk_bf16_f32 v74, v145, v159
    v_pk_mul_f32 v[146:147], v[144:145], v[142:143] op_sel:[0,0] op_sel_hi:[1,0]
    v_pk_fma_f32 v[146:147], v[144:145], v[142:143], v[146:147] op_sel:[1,1,0] op_sel_hi:[0,1,1] neg_lo:[1,0,0]
    v_pk_mul_f32 v[158:159], v[146:147], v[140:141] op_sel:[0,0] op_sel_hi:[1,0]
    v_pk_fma_f32 v[158:159], v[146:147], v[140:141], v[158:159] op_sel:[1,1,0] op_sel_hi:[0,1,1] neg_lo:[1,0,0]
    v_cvt_pk_bf16_f32 v63, v146, v158
    v_cvt_pk_bf16_f32 v75, v147, v159
    v_pk_mul_f32 v[158:159], v[148:149], v[142:143] op_sel:[0,0] op_sel_hi:[1,0]
    v_pk_fma_f32 v[158:159], v[148:149], v[142:143], v[158:159] op_sel:[1,1,0] op_sel_hi:[0,1,1] neg_lo:[1,0,0]
    v_cvt_pk_bf16_f32 v64, v148, v158
    v_cvt_pk_bf16_f32 v76, v149, v159
    v_pk_mul_f32 v[156:157], v[148:149], v[144:145] op_sel:[0,0] op_sel_hi:[1,0]
    v_pk_fma_f32 v[156:157], v[148:149], v[144:145], v[156:157] op_sel:[1,1,0] op_sel_hi:[0,1,1] neg_lo:[1,0,0]
    v_pk_mul_f32 v[158:159], v[148:149], v[146:147] op_sel:[0,0] op_sel_hi:[1,0]
    v_pk_fma_f32 v[158:159], v[148:149], v[146:147], v[158:159] op_sel:[1,1,0] op_sel_hi:[0,1,1] neg_lo:[1,0,0]
    v_cvt_pk_bf16_f32 v65, v156, v158
    v_cvt_pk_bf16_f32 v77, v157, v159
    v_pk_mul_f32 v[150:151], v[148:149], v[148:149] op_sel:[0,0] op_sel_hi:[1,0]
    v_pk_fma_f32 v[150:151], v[148:149], v[148:149], v[150:151] op_sel:[1,1,0] op_sel_hi:[0,1,1] neg_lo:[1,0,0]
    v_pk_mul_f32 v[158:159], v[150:151], v[144:145] op_sel:[0,0] op_sel_hi:[1,0]
    v_pk_fma_f32 v[158:159], v[150:151], v[144:145], v[158:159] op_sel:[1,1,0] op_sel_hi:[0,1,1] neg_lo:[1,0,0]
    v_cvt_pk_bf16_f32 v66, v150, v158
    v_cvt_pk_bf16_f32 v78, v151, v159
    v_pk_mul_f32 v[152:153], v[150:151], v[148:149] op_sel:[0,0] op_sel_hi:[1,0]
    v_pk_fma_f32 v[152:153], v[150:151], v[148:149], v[152:153] op_sel:[1,1,0] op_sel_hi:[0,1,1] neg_lo:[1,0,0]
    v_pk_mul_f32 v[158:159], v[152:153], v[144:145] op_sel:[0,0] op_sel_hi:[1,0]
    v_pk_fma_f32 v[158:159], v[152:153], v[144:145], v[158:159] op_sel:[1,1,0] op_sel_hi:[0,1,1] neg_lo:[1,0,0]
    v_cvt_pk_bf16_f32 v67, v152, v158
    v_cvt_pk_bf16_f32 v79, v153, v159
    v_pk_mul_f32 v[154:155], v[150:151], v[150:151] op_sel:[0,0] op_sel_hi:[1,0]
    v_pk_fma_f32 v[154:155], v[150:151], v[150:151], v[154:155] op_sel:[1,1,0] op_sel_hi:[0,1,1] neg_lo:[1,0,0]
    v_pk_mul_f32 v[158:159], v[154:155], v[148:149] op_sel:[0,0] op_sel_hi:[1,0]
    v_pk_fma_f32 v[158:159], v[154:155], v[148:149], v[158:159] op_sel:[1,1,0] op_sel_hi:[0,1,1] neg_lo:[1,0,0]
    v_cvt_pk_bf16_f32 v68, v154, v158
    v_cvt_pk_bf16_f32 v80, v155, v159
    v_pk_mul_f32 v[156:157], v[154:155], v[150:151] op_sel:[0,0] op_sel_hi:[1,0]
    v_pk_fma_f32 v[156:157], v[154:155], v[150:151], v[156:157] op_sel:[1,1,0] op_sel_hi:[0,1,1] neg_lo:[1,0,0]
    v_pk_mul_f32 v[158:159], v[154:155], v[152:153] op_sel:[0,0] op_sel_hi:[1,0]
    v_pk_fma_f32 v[158:159], v[154:155], v[152:153], v[158:159] op_sel:[1,1,0] op_sel_hi:[0,1,1] neg_lo:[1,0,0]
    v_cvt_pk_bf16_f32 v69, v156, v158
    v_cvt_pk_bf16_f32 v81, v157, v159
    v_pk_mul_f32 v[156:157], v[154:155], v[154:155] op_sel:[0,0] op_sel_hi:[1,0]
    v_pk_fma_f32 v[156:157], v[154:155], v[154:155], v[156:157] op_sel:[1,1,0] op_sel_hi:[0,1,1] neg_lo:[1,0,0]
    v_cvt_pk_bf16_f32 v70, v156, v156
    v_cvt_pk_bf16_f32 v82, v157, v157
    v_mov_b32 v156, v20
    v_mov_b32 v157, v22
    v_pk_mul_f32 v[158:159], v[156:157], v[160:161] op_sel:[0,0] op_sel_hi:[1,0]
    v_pk_fma_f32 v[158:159], v[156:157], v[160:161], v[158:159] op_sel:[1,1,0] op_sel_hi:[0,1,1] neg_lo:[1,0,0]
    v_cvt_pk_bf16_f32 v28, v156, v158
    v_cvt_pk_bf16_f32 v44, -v157, -v159
    v_pk_mul_f32 v[156:157], v[158:159], v[160:161] op_sel:[0,0] op_sel_hi:[1,0]
    v_pk_fma_f32 v[156:157], v[158:159], v[160:161], v[156:157] op_sel:[1,1,0] op_sel_hi:[0,1,1] neg_lo:[1,0,0]
    ds_write_b128 v3, v[60:63] offset:128
    v_pk_mul_f32 v[158:159], v[156:157], v[160:161] op_sel:[0,0] op_sel_hi:[1,0]
    v_pk_fma_f32 v[158:159], v[156:157], v[160:161], v[158:159] op_sel:[1,1,0] op_sel_hi:[0,1,1] neg_lo:[1,0,0]
    v_cvt_pk_bf16_f32 v29, v156, v158
    v_cvt_pk_bf16_f32 v45, -v157, -v159
    v_pk_mul_f32 v[156:157], v[158:159], v[160:161] op_sel:[0,0] op_sel_hi:[1,0]
    v_pk_fma_f32 v[156:157], v[158:159], v[160:161], v[156:157] op_sel:[1,1,0] op_sel_hi:[0,1,1] neg_lo:[1,0,0]
    ds_write_b128 v3, v[64:67] offset:144
    v_pk_mul_f32 v[158:159], v[156:157], v[160:161] op_sel:[0,0] op_sel_hi:[1,0]
    v_pk_fma_f32 v[158:159], v[156:157], v[160:161], v[158:159] op_sel:[1,1,0] op_sel_hi:[0,1,1] neg_lo:[1,0,0]
    v_cvt_pk_bf16_f32 v30, v156, v158
    v_cvt_pk_bf16_f32 v46, -v157, -v159
    v_pk_mul_f32 v[156:157], v[158:159], v[160:161] op_sel:[0,0] op_sel_hi:[1,0]
    v_pk_fma_f32 v[156:157], v[158:159], v[160:161], v[156:157] op_sel:[1,1,0] op_sel_hi:[0,1,1] neg_lo:[1,0,0]
    ds_write_b128 v3, v[68:71] offset:160
    v_pk_mul_f32 v[158:159], v[156:157], v[160:161] op_sel:[0,0] op_sel_hi:[1,0]
    v_pk_fma_f32 v[158:159], v[156:157], v[160:161], v[158:159] op_sel:[1,1,0] op_sel_hi:[0,1,1] neg_lo:[1,0,0]
    v_cvt_pk_bf16_f32 v31, v156, v158
    v_cvt_pk_bf16_f32 v47, -v157, -v159
    v_pk_mul_f32 v[156:157], v[158:159], v[160:161] op_sel:[0,0] op_sel_hi:[1,0]
    v_pk_fma_f32 v[156:157], v[158:159], v[160:161], v[156:157] op_sel:[1,1,0] op_sel_hi:[0,1,1] neg_lo:[1,0,0]
    ds_write_b128 v3, v[72:75] offset:176
    v_pk_mul_f32 v[158:159], v[156:157], v[160:161] op_sel:[0,0] op_sel_hi:[1,0]
    v_pk_fma_f32 v[158:159], v[156:157], v[160:161], v[158:159] op_sel:[1,1,0] op_sel_hi:[0,1,1] neg_lo:[1,0,0]
    v_cvt_pk_bf16_f32 v32, v156, v158
    v_cvt_pk_bf16_f32 v48, -v157, -v159
    v_pk_mul_f32 v[156:157], v[158:159], v[160:161] op_sel:[0,0] op_sel_hi:[1,0]
    v_pk_fma_f32 v[156:157], v[158:159], v[160:161], v[156:157] op_sel:[1,1,0] op_sel_hi:[0,1,1] neg_lo:[1,0,0]
    ds_write_b128 v3, v[76:79] offset:192
    v_pk_mul_f32 v[158:159], v[156:157], v[160:161] op_sel:[0,0] op_sel_hi:[1,0]
    v_pk_fma_f32 v[158:159], v[156:157], v[160:161], v[158:159] op_sel:[1,1,0] op_sel_hi:[0,1,1] neg_lo:[1,0,0]
    v_cvt_pk_bf16_f32 v33, v156, v158
    v_cvt_pk_bf16_f32 v49, -v157, -v159
    v_pk_mul_f32 v[156:157], v[158:159], v[160:161] op_sel:[0,0] op_sel_hi:[1,0]
    v_pk_fma_f32 v[156:157], v[158:159], v[160:161], v[156:157] op_sel:[1,1,0] op_sel_hi:[0,1,1] neg_lo:[1,0,0]
    ds_write_b128 v3, v[80:83] offset:208
    v_pk_mul_f32 v[158:159], v[156:157], v[160:161] op_sel:[0,0] op_sel_hi:[1,0]
    v_pk_fma_f32 v[158:159], v[156:157], v[160:161], v[158:159] op_sel:[1,1,0] op_sel_hi:[0,1,1] neg_lo:[1,0,0]
    v_cvt_pk_bf16_f32 v34, v156, v158
    v_cvt_pk_bf16_f32 v50, -v157, -v159
    v_pk_mul_f32 v[156:157], v[158:159], v[160:161] op_sel:[0,0] op_sel_hi:[1,0]
    v_pk_fma_f32 v[156:157], v[158:159], v[160:161], v[156:157] op_sel:[1,1,0] op_sel_hi:[0,1,1] neg_lo:[1,0,0]
    ds_write_b128 v3, v[28:31] offset:0
    v_pk_mul_f32 v[158:159], v[156:157], v[160:161] op_sel:[0,0] op_sel_hi:[1,0]
    v_pk_fma_f32 v[158:159], v[156:157], v[160:161], v[158:159] op_sel:[1,1,0] op_sel_hi:[0,1,1] neg_lo:[1,0,0]
    v_cvt_pk_bf16_f32 v35, v156, v158
    v_cvt_pk_bf16_f32 v51, -v157, -v159
    v_pk_mul_f32 v[156:157], v[158:159], v[160:161] op_sel:[0,0] op_sel_hi:[1,0]
    v_pk_fma_f32 v[156:157], v[158:159], v[160:161], v[156:157] op_sel:[1,1,0] op_sel_hi:[0,1,1] neg_lo:[1,0,0]
    ds_write_b128 v3, v[44:47] offset:64
    v_pk_mul_f32 v[158:159], v[156:157], v[160:161] op_sel:[0,0] op_sel_hi:[1,0]
    v_pk_fma_f32 v[158:159], v[156:157], v[160:161], v[158:159] op_sel:[1,1,0] op_sel_hi:[0,1,1] neg_lo:[1,0,0]
    v_cvt_pk_bf16_f32 v36, v156, v158
    v_cvt_pk_bf16_f32 v52, -v157, -v159
    v_pk_mul_f32 v[156:157], v[158:159], v[160:161] op_sel:[0,0] op_sel_hi:[1,0]
    v_pk_fma_f32 v[156:157], v[158:159], v[160:161], v[156:157] op_sel:[1,1,0] op_sel_hi:[0,1,1] neg_lo:[1,0,0]
    ds_write_b128 v3, v[32:35] offset:16
    v_pk_mul_f32 v[158:159], v[156:157], v[160:161] op_sel:[0,0] op_sel_hi:[1,0]
    v_pk_fma_f32 v[158:159], v[156:157], v[160:161], v[158:159] op_sel:[1,1,0] op_sel_hi:[0,1,1] neg_lo:[1,0,0]
    v_cvt_pk_bf16_f32 v37, v156, v158
    v_cvt_pk_bf16_f32 v53, -v157, -v159
    v_pk_mul_f32 v[156:157], v[158:159], v[160:161] op_sel:[0,0] op_sel_hi:[1,0]
    v_pk_fma_f32 v[156:157], v[158:159], v[160:161], v[156:157] op_sel:[1,1,0] op_sel_hi:[0,1,1] neg_lo:[1,0,0]
    ds_write_b128 v3, v[48:51] offset:80
    v_pk_mul_f32 v[158:159], v[156:157], v[160:161] op_sel:[0,0] op_sel_hi:[1,0]
    v_pk_fma_f32 v[158:159], v[156:157], v[160:161], v[158:159] op_sel:[1,1,0] op_sel_hi:[0,1,1] neg_lo:[1,0,0]
    v_cvt_pk_bf16_f32 v38, v156, v158
    v_cvt_pk_bf16_f32 v54, -v157, -v159
    v_pk_mul_f32 v[156:157], v[158:159], v[160:161] op_sel:[0,0] op_sel_hi:[1,0]
    v_pk_fma_f32 v[156:157], v[158:159], v[160:161], v[156:157] op_sel:[1,1,0] op_sel_hi:[0,1,1] neg_lo:[1,0,0]
    v_pk_mul_f32 v[158:159], v[156:157], v[160:161] op_sel:[0,0] op_sel_hi:[1,0]
    v_pk_fma_f32 v[158:159], v[156:157], v[160:161], v[158:159] op_sel:[1,1,0] op_sel_hi:[0,1,1] neg_lo:[1,0,0]
    v_cvt_pk_bf16_f32 v39, v156, v158
    v_cvt_pk_bf16_f32 v55, -v157, -v159
    v_pk_mul_f32 v[156:157], v[158:159], v[160:161] op_sel:[0,0] op_sel_hi:[1,0]
    v_pk_fma_f32 v[156:157], v[158:159], v[160:161], v[156:157] op_sel:[1,1,0] op_sel_hi:[0,1,1] neg_lo:[1,0,0]
    ds_write_b128 v3, v[36:39] offset:32
    v_pk_mul_f32 v[158:159], v[156:157], v[160:161] op_sel:[0,0] op_sel_hi:[1,0]
    v_pk_fma_f32 v[158:159], v[156:157], v[160:161], v[158:159] op_sel:[1,1,0] op_sel_hi:[0,1,1] neg_lo:[1,0,0]
    v_cvt_pk_bf16_f32 v40, v156, v158
    v_cvt_pk_bf16_f32 v56, -v157, -v159
    v_pk_mul_f32 v[156:157], v[158:159], v[160:161] op_sel:[0,0] op_sel_hi:[1,0]
    v_pk_fma_f32 v[156:157], v[158:159], v[160:161], v[156:157] op_sel:[1,1,0] op_sel_hi:[0,1,1] neg_lo:[1,0,0]
    ds_write_b128 v3, v[52:55] offset:96
    v_pk_mul_f32 v[158:159], v[156:157], v[160:161] op_sel:[0,0] op_sel_hi:[1,0]
    v_pk_fma_f32 v[158:159], v[156:157], v[160:161], v[158:159] op_sel:[1,1,0] op_sel_hi:[0,1,1] neg_lo:[1,0,0]
    v_cvt_pk_bf16_f32 v41, v156, v158
    v_cvt_pk_bf16_f32 v57, -v157, -v159
    v_pk_mul_f32 v[156:157], v[158:159], v[160:161] op_sel:[0,0] op_sel_hi:[1,0]
    v_pk_fma_f32 v[156:157], v[158:159], v[160:161], v[156:157] op_sel:[1,1,0] op_sel_hi:[0,1,1] neg_lo:[1,0,0]
    v_pk_mul_f32 v[158:159], v[156:157], v[160:161] op_sel:[0,0] op_sel_hi:[1,0]
    v_pk_fma_f32 v[158:159], v[156:157], v[160:161], v[158:159] op_sel:[1,1,0] op_sel_hi:[0,1,1] neg_lo:[1,0,0]
    v_cvt_pk_bf16_f32 v42, v156, v158
    v_cvt_pk_bf16_f32 v58, -v157, -v159
    v_pk_mul_f32 v[156:157], v[158:159], v[160:161] op_sel:[0,0] op_sel_hi:[1,0]
    v_pk_fma_f32 v[156:157], v[158:159], v[160:161], v[156:157] op_sel:[1,1,0] op_sel_hi:[0,1,1] neg_lo:[1,0,0]
    v_pk_mul_f32 v[158:159], v[156:157], v[160:161] op_sel:[0,0] op_sel_hi:[1,0]
    v_pk_fma_f32 v[158:159], v[156:157], v[160:161], v[158:159] op_sel:[1,1,0] op_sel_hi:[0,1,1] neg_lo:[1,0,0]
    v_cvt_pk_bf16_f32 v43, v156, v158
    v_cvt_pk_bf16_f32 v59, -v157, -v159
    ds_write_b128 v3, v[40:43] offset:48
    ds_write_b128 v3, v[56:59] offset:112
    s_waitcnt lgkmcnt(3)
    v_mul_f32 v162, 0x43800000, v17
    ds_read_b64_tr_b16 v[100:101], v4 offset:128
    v_mul_f32 v164, 0x41000000, v17
    ds_read_b64_tr_b16 v[102:103], v4 offset:176
    v_exp_f32 v166, v17
    ds_read_b64_tr_b16 v[104:105], v4 offset:0
    v_mul_f32 v163, 0x43800000, v19
    ds_read_b64_tr_b16 v[106:107], v4 offset:64
    v_mul_f32 v165, 0x41000000, v19
    ds_read_b64_tr_b16 v[108:109], v4 offset:608
    v_fract_f32 v167, v19
    ds_read_b64_tr_b16 v[110:111], v4 offset:656
    v_exp_f32 v162, v162
    ds_read_b64_tr_b16 v[112:113], v4 offset:480
    v_exp_f32 v164, v164
    ds_read_b64_tr_b16 v[114:115], v4 offset:544
    v_cos_f32 v140, v167
    ds_read_b64_tr_b16 v[116:117], v4 offset:3968
    v_fract_f32 v163, v163
    ds_read_b64_tr_b16 v[118:119], v4 offset:4016
    v_fract_f32 v165, v165
    ds_read_b64_tr_b16 v[120:121], v4 offset:3840
    v_sin_f32 v141, v167
    ds_read_b64_tr_b16 v[122:123], v4 offset:3904
    v_cos_f32 v148, v163
    s_waitcnt lgkmcnt(8)
    v_cos_f32 v160, v165
    v_mfma_f32_32x32x16_bf16 v[84:99], v[100:103], v[104:107], 0
    v_mul_f32 v140, v140, v166
    ds_read_b64_tr_b16 v[124:125], v4 offset:4448
    v_sin_f32 v149, v163
    ds_read_b64_tr_b16 v[126:127], v4 offset:4496
    v_sin_f32 v161, v165
    ds_read_b64_tr_b16 v[128:129], v4 offset:4320
    v_mul_f32 v141, v141, v166
    ds_read_b64_tr_b16 v[130:131], v4 offset:4384
    v_mul_f32 v148, v148, v162
    s_waitcnt lgkmcnt(8)
    v_mul_f32 v160, v160, v164
    v_mfma_f32_32x32x16_bf16 v[84:99], v[108:111], v[112:115], v[84:99]
    v_mul_f32 v149, v149, v162
    ds_read_b64_tr_b16 v[100:101], v4 offset:7808
    v_mul_f32 v161, v161, v164
    ds_read_b64_tr_b16 v[102:103], v4 offset:7856
    v_cvt_pk_bf16_f32 v60, 1.0, v140
    ds_read_b64_tr_b16 v[104:105], v4 offset:7680
    v_cvt_pk_bf16_f32 v72, 0, v141
    ds_read_b64_tr_b16 v[106:107], v4 offset:7744
    v_mul_f32 v142, v140, v140
    s_waitcnt lgkmcnt(8)
    v_mul_f32 v143, v141, v140
    v_mfma_f32_32x32x16_bf16 v[84:99], v[116:119], v[120:123], v[84:99]
    v_fma_f32 v142, -v141, v141, v142
    ds_read_b64_tr_b16 v[108:109], v4 offset:8288
    v_fmac_f32 v143, v140, v141
    ds_read_b64_tr_b16 v[110:111], v4 offset:8336
    v_mul_f32 v158, v142, v140
    ds_read_b64_tr_b16 v[112:113], v4 offset:8160
    v_mul_f32 v159, v143, v140
    ds_read_b64_tr_b16 v[114:115], v4 offset:8224
    v_fma_f32 v158, -v143, v141, v158
    s_waitcnt lgkmcnt(8)
    v_fmac_f32 v159, v142, v141
    v_mfma_f32_32x32x16_bf16 v[84:99], v[124:127], v[128:131], v[84:99]
    v_cvt_pk_bf16_f32 v61, v142, v158
    ds_read_b64_tr_b16 v[116:117], v4 offset:11648
    v_cvt_pk_bf16_f32 v73, v143, v159
    ds_read_b64_tr_b16 v[118:119], v4 offset:11696
    v_mul_f32 v144, v142, v142
    ds_read_b64_tr_b16 v[120:121], v4 offset:11520
    v_mul_f32 v145, v143, v142
    ds_read_b64_tr_b16 v[122:123], v4 offset:11584
    v_fma_f32 v144, -v143, v143, v144
    s_waitcnt lgkmcnt(8)
    v_fmac_f32 v145, v142, v143
    v_mfma_f32_32x32x16_bf16 v[84:99], v[100:103], v[104:107], v[84:99]
    v_mul_f32 v158, v144, v140
    ds_read_b64_tr_b16 v[124:125], v4 offset:12128
    v_mul_f32 v159, v145, v140
    ds_read_b64_tr_b16 v[126:127], v4 offset:12176
    v_fma_f32 v158, -v145, v141, v158
    ds_read_b64_tr_b16 v[128:129], v4 offset:12000
    v_fmac_f32 v159, v144, v141
    ds_read_b64_tr_b16 v[130:131], v4 offset:12064
    v_cvt_pk_bf16_f32 v62, v144, v158
    s_waitcnt lgkmcnt(8)
    v_cvt_pk_bf16_f32 v74, v145, v159
    v_mfma_f32_32x32x16_bf16 v[84:99], v[108:111], v[112:115], v[84:99]
    v_mul_f32 v146, v144, v142
    s_waitcnt lgkmcnt(4)
    v_mul_f32 v147, v145, v142
    v_mfma_f32_32x32x16_bf16 v[84:99], v[116:119], v[120:123], v[84:99]
    v_fma_f32 v146, -v145, v143, v146
    s_waitcnt lgkmcnt(0)
    v_fmac_f32 v147, v144, v143
    v_mfma_f32_32x32x16_bf16 v[84:99], v[124:127], v[128:131], v[84:99]
    v_mul_f32 v158, v146, v140
    v_mul_f32 v159, v147, v140
    v_fma_f32 v158, -v147, v141, v158
    v_fmac_f32 v159, v146, v141
    v_cvt_pk_bf16_f32 v63, v146, v158
    v_cvt_pk_bf16_f32 v75, v147, v159
    v_pk_mul_f32 v[158:159], v[148:149], v[142:143] op_sel:[0,0] op_sel_hi:[1,0]
    v_pk_fma_f32 v[158:159], v[148:149], v[142:143], v[158:159] op_sel:[1,1,0] op_sel_hi:[0,1,1] neg_lo:[1,0,0]
    v_cvt_pk_bf16_f32 v64, v148, v158
    v_cvt_pk_bf16_f32 v76, v149, v159
    v_pk_mul_f32 v[156:157], v[148:149], v[144:145] op_sel:[0,0] op_sel_hi:[1,0]
    v_pk_fma_f32 v[156:157], v[148:149], v[144:145], v[156:157] op_sel:[1,1,0] op_sel_hi:[0,1,1] neg_lo:[1,0,0]
    v_pk_mul_f32 v[158:159], v[148:149], v[146:147] op_sel:[0,0] op_sel_hi:[1,0]
    v_pk_fma_f32 v[158:159], v[148:149], v[146:147], v[158:159] op_sel:[1,1,0] op_sel_hi:[0,1,1] neg_lo:[1,0,0]
    v_cvt_pk_bf16_f32 v65, v156, v158
    v_cvt_pk_bf16_f32 v77, v157, v159
    v_pk_mul_f32 v[150:151], v[148:149], v[148:149] op_sel:[0,0] op_sel_hi:[1,0]
    v_pk_fma_f32 v[150:151], v[148:149], v[148:149], v[150:151] op_sel:[1,1,0] op_sel_hi:[0,1,1] neg_lo:[1,0,0]
    v_pk_mul_f32 v[158:159], v[150:151], v[144:145] op_sel:[0,0] op_sel_hi:[1,0]
    v_pk_fma_f32 v[158:159], v[150:151], v[144:145], v[158:159] op_sel:[1,1,0] op_sel_hi:[0,1,1] neg_lo:[1,0,0]
    v_cvt_pk_bf16_f32 v66, v150, v158
    v_cvt_pk_bf16_f32 v78, v151, v159
    v_pk_mul_f32 v[152:153], v[150:151], v[148:149] op_sel:[0,0] op_sel_hi:[1,0]
    v_pk_fma_f32 v[152:153], v[150:151], v[148:149], v[152:153] op_sel:[1,1,0] op_sel_hi:[0,1,1] neg_lo:[1,0,0]
    v_pk_mul_f32 v[158:159], v[152:153], v[144:145] op_sel:[0,0] op_sel_hi:[1,0]
    v_pk_fma_f32 v[158:159], v[152:153], v[144:145], v[158:159] op_sel:[1,1,0] op_sel_hi:[0,1,1] neg_lo:[1,0,0]
    v_cvt_pk_bf16_f32 v67, v152, v158
    v_cvt_pk_bf16_f32 v79, v153, v159
    v_pk_mul_f32 v[154:155], v[150:151], v[150:151] op_sel:[0,0] op_sel_hi:[1,0]
    v_pk_fma_f32 v[154:155], v[150:151], v[150:151], v[154:155] op_sel:[1,1,0] op_sel_hi:[0,1,1] neg_lo:[1,0,0]
    v_pk_mul_f32 v[158:159], v[154:155], v[148:149] op_sel:[0,0] op_sel_hi:[1,0]
    v_pk_fma_f32 v[158:159], v[154:155], v[148:149], v[158:159] op_sel:[1,1,0] op_sel_hi:[0,1,1] neg_lo:[1,0,0]
    v_cvt_pk_bf16_f32 v68, v154, v158
    v_cvt_pk_bf16_f32 v80, v155, v159
    v_pk_mul_f32 v[156:157], v[154:155], v[150:151] op_sel:[0,0] op_sel_hi:[1,0]
    v_pk_fma_f32 v[156:157], v[154:155], v[150:151], v[156:157] op_sel:[1,1,0] op_sel_hi:[0,1,1] neg_lo:[1,0,0]
    v_pk_mul_f32 v[158:159], v[154:155], v[152:153] op_sel:[0,0] op_sel_hi:[1,0]
    v_pk_fma_f32 v[158:159], v[154:155], v[152:153], v[158:159] op_sel:[1,1,0] op_sel_hi:[0,1,1] neg_lo:[1,0,0]
    v_cvt_pk_bf16_f32 v69, v156, v158
    v_cvt_pk_bf16_f32 v81, v157, v159
    v_pk_mul_f32 v[156:157], v[154:155], v[154:155] op_sel:[0,0] op_sel_hi:[1,0]
    v_pk_fma_f32 v[156:157], v[154:155], v[154:155], v[156:157] op_sel:[1,1,0] op_sel_hi:[0,1,1] neg_lo:[1,0,0]
    v_cvt_pk_bf16_f32 v70, v156, v156
    v_cvt_pk_bf16_f32 v82, v157, v157
    v_mov_b32 v156, v21
    v_mov_b32 v157, v23
    v_pk_mul_f32 v[158:159], v[156:157], v[160:161] op_sel:[0,0] op_sel_hi:[1,0]
    v_pk_fma_f32 v[158:159], v[156:157], v[160:161], v[158:159] op_sel:[1,1,0] op_sel_hi:[0,1,1] neg_lo:[1,0,0]
    v_cvt_pk_bf16_f32 v28, v156, v158
    v_cvt_pk_bf16_f32 v44, -v157, -v159
    v_pk_mul_f32 v[156:157], v[158:159], v[160:161] op_sel:[0,0] op_sel_hi:[1,0]
    v_pk_fma_f32 v[156:157], v[158:159], v[160:161], v[156:157] op_sel:[1,1,0] op_sel_hi:[0,1,1] neg_lo:[1,0,0]
    ds_write_b128 v3, v[60:63] offset:128
    v_pk_mul_f32 v[158:159], v[156:157], v[160:161] op_sel:[0,0] op_sel_hi:[1,0]
    v_pk_fma_f32 v[158:159], v[156:157], v[160:161], v[158:159] op_sel:[1,1,0] op_sel_hi:[0,1,1] neg_lo:[1,0,0]
    v_cvt_pk_bf16_f32 v29, v156, v158
    v_cvt_pk_bf16_f32 v45, -v157, -v159
    v_pk_mul_f32 v[156:157], v[158:159], v[160:161] op_sel:[0,0] op_sel_hi:[1,0]
    v_pk_fma_f32 v[156:157], v[158:159], v[160:161], v[156:157] op_sel:[1,1,0] op_sel_hi:[0,1,1] neg_lo:[1,0,0]
    ds_write_b128 v3, v[64:67] offset:144
    v_pk_mul_f32 v[158:159], v[156:157], v[160:161] op_sel:[0,0] op_sel_hi:[1,0]
    v_pk_fma_f32 v[158:159], v[156:157], v[160:161], v[158:159] op_sel:[1,1,0] op_sel_hi:[0,1,1] neg_lo:[1,0,0]
    v_cvt_pk_bf16_f32 v30, v156, v158
    v_cvt_pk_bf16_f32 v46, -v157, -v159
    v_pk_mul_f32 v[156:157], v[158:159], v[160:161] op_sel:[0,0] op_sel_hi:[1,0]
    v_pk_fma_f32 v[156:157], v[158:159], v[160:161], v[156:157] op_sel:[1,1,0] op_sel_hi:[0,1,1] neg_lo:[1,0,0]
    ds_write_b128 v3, v[68:71] offset:160
    v_pk_mul_f32 v[158:159], v[156:157], v[160:161] op_sel:[0,0] op_sel_hi:[1,0]
    v_pk_fma_f32 v[158:159], v[156:157], v[160:161], v[158:159] op_sel:[1,1,0] op_sel_hi:[0,1,1] neg_lo:[1,0,0]
    v_cvt_pk_bf16_f32 v31, v156, v158
    v_cvt_pk_bf16_f32 v47, -v157, -v159
    v_pk_mul_f32 v[156:157], v[158:159], v[160:161] op_sel:[0,0] op_sel_hi:[1,0]
    v_pk_fma_f32 v[156:157], v[158:159], v[160:161], v[156:157] op_sel:[1,1,0] op_sel_hi:[0,1,1] neg_lo:[1,0,0]
    ds_write_b128 v3, v[72:75] offset:176
    v_pk_mul_f32 v[158:159], v[156:157], v[160:161] op_sel:[0,0] op_sel_hi:[1,0]
    v_pk_fma_f32 v[158:159], v[156:157], v[160:161], v[158:159] op_sel:[1,1,0] op_sel_hi:[0,1,1] neg_lo:[1,0,0]
    v_cvt_pk_bf16_f32 v32, v156, v158
    v_cvt_pk_bf16_f32 v48, -v157, -v159
    v_pk_mul_f32 v[156:157], v[158:159], v[160:161] op_sel:[0,0] op_sel_hi:[1,0]
    v_pk_fma_f32 v[156:157], v[158:159], v[160:161], v[156:157] op_sel:[1,1,0] op_sel_hi:[0,1,1] neg_lo:[1,0,0]
    ds_write_b128 v3, v[76:79] offset:192
    v_pk_mul_f32 v[158:159], v[156:157], v[160:161] op_sel:[0,0] op_sel_hi:[1,0]
    v_pk_fma_f32 v[158:159], v[156:157], v[160:161], v[158:159] op_sel:[1,1,0] op_sel_hi:[0,1,1] neg_lo:[1,0,0]
    v_cvt_pk_bf16_f32 v33, v156, v158
    v_cvt_pk_bf16_f32 v49, -v157, -v159
    v_pk_mul_f32 v[156:157], v[158:159], v[160:161] op_sel:[0,0] op_sel_hi:[1,0]
    v_pk_fma_f32 v[156:157], v[158:159], v[160:161], v[156:157] op_sel:[1,1,0] op_sel_hi:[0,1,1] neg_lo:[1,0,0]
    ds_write_b128 v3, v[80:83] offset:208
    v_pk_mul_f32 v[158:159], v[156:157], v[160:161] op_sel:[0,0] op_sel_hi:[1,0]
    v_pk_fma_f32 v[158:159], v[156:157], v[160:161], v[158:159] op_sel:[1,1,0] op_sel_hi:[0,1,1] neg_lo:[1,0,0]
    v_cvt_pk_bf16_f32 v34, v156, v158
    v_cvt_pk_bf16_f32 v50, -v157, -v159
    v_pk_mul_f32 v[156:157], v[158:159], v[160:161] op_sel:[0,0] op_sel_hi:[1,0]
    v_pk_fma_f32 v[156:157], v[158:159], v[160:161], v[156:157] op_sel:[1,1,0] op_sel_hi:[0,1,1] neg_lo:[1,0,0]
    ds_write_b128 v3, v[28:31] offset:0
    v_pk_mul_f32 v[158:159], v[156:157], v[160:161] op_sel:[0,0] op_sel_hi:[1,0]
    v_pk_fma_f32 v[158:159], v[156:157], v[160:161], v[158:159] op_sel:[1,1,0] op_sel_hi:[0,1,1] neg_lo:[1,0,0]
    v_cvt_pk_bf16_f32 v35, v156, v158
    v_cvt_pk_bf16_f32 v51, -v157, -v159
    v_pk_mul_f32 v[156:157], v[158:159], v[160:161] op_sel:[0,0] op_sel_hi:[1,0]
    v_pk_fma_f32 v[156:157], v[158:159], v[160:161], v[156:157] op_sel:[1,1,0] op_sel_hi:[0,1,1] neg_lo:[1,0,0]
    ds_write_b128 v3, v[44:47] offset:64
    v_pk_mul_f32 v[158:159], v[156:157], v[160:161] op_sel:[0,0] op_sel_hi:[1,0]
    v_pk_fma_f32 v[158:159], v[156:157], v[160:161], v[158:159] op_sel:[1,1,0] op_sel_hi:[0,1,1] neg_lo:[1,0,0]
    v_cvt_pk_bf16_f32 v36, v156, v158
    v_cvt_pk_bf16_f32 v52, -v157, -v159
    v_pk_mul_f32 v[156:157], v[158:159], v[160:161] op_sel:[0,0] op_sel_hi:[1,0]
    v_pk_fma_f32 v[156:157], v[158:159], v[160:161], v[156:157] op_sel:[1,1,0] op_sel_hi:[0,1,1] neg_lo:[1,0,0]
    ds_write_b128 v3, v[32:35] offset:16
    v_pk_mul_f32 v[158:159], v[156:157], v[160:161] op_sel:[0,0] op_sel_hi:[1,0]
    v_pk_fma_f32 v[158:159], v[156:157], v[160:161], v[158:159] op_sel:[1,1,0] op_sel_hi:[0,1,1] neg_lo:[1,0,0]
    v_cvt_pk_bf16_f32 v37, v156, v158
    v_cvt_pk_bf16_f32 v53, -v157, -v159
    v_pk_mul_f32 v[156:157], v[158:159], v[160:161] op_sel:[0,0] op_sel_hi:[1,0]
    v_pk_fma_f32 v[156:157], v[158:159], v[160:161], v[156:157] op_sel:[1,1,0] op_sel_hi:[0,1,1] neg_lo:[1,0,0]
    ds_write_b128 v3, v[48:51] offset:80
    v_pk_mul_f32 v[158:159], v[156:157], v[160:161] op_sel:[0,0] op_sel_hi:[1,0]
    v_pk_fma_f32 v[158:159], v[156:157], v[160:161], v[158:159] op_sel:[1,1,0] op_sel_hi:[0,1,1] neg_lo:[1,0,0]
    v_cvt_pk_bf16_f32 v38, v156, v158
    v_cvt_pk_bf16_f32 v54, -v157, -v159
    v_pk_mul_f32 v[156:157], v[158:159], v[160:161] op_sel:[0,0] op_sel_hi:[1,0]
    v_pk_fma_f32 v[156:157], v[158:159], v[160:161], v[156:157] op_sel:[1,1,0] op_sel_hi:[0,1,1] neg_lo:[1,0,0]
    v_pk_mul_f32 v[158:159], v[156:157], v[160:161] op_sel:[0,0] op_sel_hi:[1,0]
    v_pk_fma_f32 v[158:159], v[156:157], v[160:161], v[158:159] op_sel:[1,1,0] op_sel_hi:[0,1,1] neg_lo:[1,0,0]
    v_cvt_pk_bf16_f32 v39, v156, v158
    v_cvt_pk_bf16_f32 v55, -v157, -v159
    v_pk_mul_f32 v[156:157], v[158:159], v[160:161] op_sel:[0,0] op_sel_hi:[1,0]
    v_pk_fma_f32 v[156:157], v[158:159], v[160:161], v[156:157] op_sel:[1,1,0] op_sel_hi:[0,1,1] neg_lo:[1,0,0]
    ds_write_b128 v3, v[36:39] offset:32
    v_pk_mul_f32 v[158:159], v[156:157], v[160:161] op_sel:[0,0] op_sel_hi:[1,0]
    v_pk_fma_f32 v[158:159], v[156:157], v[160:161], v[158:159] op_sel:[1,1,0] op_sel_hi:[0,1,1] neg_lo:[1,0,0]
    v_cvt_pk_bf16_f32 v40, v156, v158
    v_cvt_pk_bf16_f32 v56, -v157, -v159
    v_pk_mul_f32 v[156:157], v[158:159], v[160:161] op_sel:[0,0] op_sel_hi:[1,0]
    v_pk_fma_f32 v[156:157], v[158:159], v[160:161], v[156:157] op_sel:[1,1,0] op_sel_hi:[0,1,1] neg_lo:[1,0,0]
    ds_write_b128 v3, v[52:55] offset:96
    v_pk_mul_f32 v[158:159], v[156:157], v[160:161] op_sel:[0,0] op_sel_hi:[1,0]
    v_pk_fma_f32 v[158:159], v[156:157], v[160:161], v[158:159] op_sel:[1,1,0] op_sel_hi:[0,1,1] neg_lo:[1,0,0]
    v_cvt_pk_bf16_f32 v41, v156, v158
    v_cvt_pk_bf16_f32 v57, -v157, -v159
    v_pk_mul_f32 v[156:157], v[158:159], v[160:161] op_sel:[0,0] op_sel_hi:[1,0]
    v_pk_fma_f32 v[156:157], v[158:159], v[160:161], v[156:157] op_sel:[1,1,0] op_sel_hi:[0,1,1] neg_lo:[1,0,0]
    v_pk_mul_f32 v[158:159], v[156:157], v[160:161] op_sel:[0,0] op_sel_hi:[1,0]
    v_pk_fma_f32 v[158:159], v[156:157], v[160:161], v[158:159] op_sel:[1,1,0] op_sel_hi:[0,1,1] neg_lo:[1,0,0]
    v_cvt_pk_bf16_f32 v42, v156, v158
    v_cvt_pk_bf16_f32 v58, -v157, -v159
    v_pk_mul_f32 v[156:157], v[158:159], v[160:161] op_sel:[0,0] op_sel_hi:[1,0]
    v_pk_fma_f32 v[156:157], v[158:159], v[160:161], v[156:157] op_sel:[1,1,0] op_sel_hi:[0,1,1] neg_lo:[1,0,0]
    v_pk_mul_f32 v[158:159], v[156:157], v[160:161] op_sel:[0,0] op_sel_hi:[1,0]
    v_pk_fma_f32 v[158:159], v[156:157], v[160:161], v[158:159] op_sel:[1,1,0] op_sel_hi:[0,1,1] neg_lo:[1,0,0]
    v_cvt_pk_bf16_f32 v43, v156, v158
    v_cvt_pk_bf16_f32 v59, -v157, -v159
    ds_write_b128 v3, v[40:43] offset:48
    ds_write_b128 v3, v[56:59] offset:112
    s_barrier
    s_waitcnt lgkmcnt(3)
    ds_read_b64_tr_b16 v[100:101], v4 offset:128
    ds_read_b64_tr_b16 v[102:103], v4 offset:176
    ds_read_b64_tr_b16 v[104:105], v4 offset:0
    ds_read_b64_tr_b16 v[106:107], v4 offset:64
    ds_read_b64_tr_b16 v[108:109], v4 offset:608
    ds_read_b64_tr_b16 v[110:111], v4 offset:656
    ds_read_b64_tr_b16 v[112:113], v4 offset:480
    ds_read_b64_tr_b16 v[114:115], v4 offset:544
    ds_read_b64_tr_b16 v[116:117], v4 offset:3968
    ds_read_b64_tr_b16 v[118:119], v4 offset:4016
    ds_read_b64_tr_b16 v[120:121], v4 offset:3840
    ds_read_b64_tr_b16 v[122:123], v4 offset:3904
    s_waitcnt lgkmcnt(8)
    v_mfma_f32_32x32x16_bf16 v[84:99], v[100:103], v[104:107], v[84:99]
    ds_read_b64_tr_b16 v[124:125], v4 offset:4448
    ds_read_b64_tr_b16 v[126:127], v4 offset:4496
    ds_read_b64_tr_b16 v[128:129], v4 offset:4320
    ds_read_b64_tr_b16 v[130:131], v4 offset:4384
    s_waitcnt lgkmcnt(8)
    v_mfma_f32_32x32x16_bf16 v[84:99], v[108:111], v[112:115], v[84:99]
    ds_read_b64_tr_b16 v[100:101], v4 offset:7808
    ds_read_b64_tr_b16 v[102:103], v4 offset:7856
    ds_read_b64_tr_b16 v[104:105], v4 offset:7680
    ds_read_b64_tr_b16 v[106:107], v4 offset:7744
    s_waitcnt lgkmcnt(8)
    v_mfma_f32_32x32x16_bf16 v[84:99], v[116:119], v[120:123], v[84:99]
    ds_read_b64_tr_b16 v[108:109], v4 offset:8288
    ds_read_b64_tr_b16 v[110:111], v4 offset:8336
    ds_read_b64_tr_b16 v[112:113], v4 offset:8160
    ds_read_b64_tr_b16 v[114:115], v4 offset:8224
    s_waitcnt lgkmcnt(8)
    v_mfma_f32_32x32x16_bf16 v[84:99], v[124:127], v[128:131], v[84:99]
    ds_read_b64_tr_b16 v[116:117], v4 offset:11648
    ds_read_b64_tr_b16 v[118:119], v4 offset:11696
    ds_read_b64_tr_b16 v[120:121], v4 offset:11520
    ds_read_b64_tr_b16 v[122:123], v4 offset:11584
    s_waitcnt lgkmcnt(8)
    v_mfma_f32_32x32x16_bf16 v[84:99], v[100:103], v[104:107], v[84:99]
    ds_read_b64_tr_b16 v[124:125], v4 offset:12128
    ds_read_b64_tr_b16 v[126:127], v4 offset:12176
    ds_read_b64_tr_b16 v[128:129], v4 offset:12000
    ds_read_b64_tr_b16 v[130:131], v4 offset:12064
    s_waitcnt lgkmcnt(8)
    v_mfma_f32_32x32x16_bf16 v[84:99], v[108:111], v[112:115], v[84:99]
    s_waitcnt lgkmcnt(4)
    v_mfma_f32_32x32x16_bf16 v[84:99], v[116:119], v[120:123], v[84:99]
    s_waitcnt lgkmcnt(0)
    v_mfma_f32_32x32x16_bf16 v[84:99], v[124:127], v[128:131], v[84:99]
    v_lshrrev_b32 v70, 2, v0
    v_mul_u32_u24 v70, 4352, v70
    v_and_b32 v71, 3, v0
    v_lshl_add_u32 v70, v71, 4, v70
    v_mov_b32 v71, 1
    s_barrier
    s_barrier
    s_cmp_lg_u32 s3, 8
    s_cbranch_scc1 L_H0
    v_mov_b32 v26, 0
    buffer_load_dword v27, v26, s[32:35], 0 offen sc1
L_H0:
    s_barrier
    s_cmp_lg_u32 s3, 8
    s_cbranch_scc1 L_H1
    s_waitcnt vmcnt(0)
    v_cmp_ne_u32 vcc, 1, v27
    s_cbranch_vccz L_GOP_S_X
    s_mov_b32 s62, 0
L_GOP_S:
    buffer_load_dword v27, v26, s[32:35], 0 offen sc1
    s_add_u32 s62, s62, 1
    s_waitcnt vmcnt(0)
    v_cmp_ne_u32 vcc, 1, v27
    s_cmp_gt_u32 s62, 20000
    s_cbranch_scc1 L_GOP_S_X
    s_cbranch_vccz L_GOP_S_X
    s_sleep 16
    s_branch L_GOP_S
L_GOP_S_X:
    v_mov_b32 v27, 1
L_H1:
    s_barrier
    s_cmp_lg_u32 s3, 8
    s_cbranch_scc1 L_H2
    v_lshl_add_u32 v26, v0, 7, s101
    s_mov_b64 exec, 0xffff
    buffer_atomic_add v27, v26, s[16:19], 0 offen sc1
    s_mov_b64 exec, -1
L_H2:
    s_and_b32 s89, s91, 60
    s_lshl_b32 s89, s89, 5
    s_add_u32 s88, s101, s89
    v_mov_b32 v26, s88
    s_barrier
    s_barrier
    s_barrier
    s_barrier
    s_mov_b64 exec, 1
    v_mov_b32 v72, 0
    buffer_atomic_add v72, v26, s[16:19], 0 offen sc0 sc1
    s_mov_b64 exec, -1
    s_barrier
    s_mov_b32 s39, 0
    s_waitcnt vmcnt(0)
    v_readfirstlane_b32 s88, v72
    s_cmp_lg_u32 s88, 16
    s_cbranch_scc1 L_H5
    s_add_u32 m0, s38, 512
    s_add_u32 s89, s100, 0
    buffer_load_dwordx4 v70, s[16:19], s89 offen offset:0 sc1 lds
    s_add_u32 s89, s100, 68608
    buffer_load_dwordx4 v70, s[16:19], s89 offen offset:1024 sc1 lds
    s_add_u32 s89, s100, 137216
    buffer_load_dwordx4 v70, s[16:19], s89 offen offset:2048 sc1 lds
    s_add_u32 s89, s100, 205824
    buffer_load_dwordx4 v70, s[16:19], s89 offen offset:3072 sc1 lds
    s_mov_b32 s39, 1
L_H5:
    v_mov_b32 v16, 0
    v_mov_b32 v17, 0
    v_lshl_add_u32 v18, v0, 3, s38
    v_and_b32 v19, 7, v0
    v_lshl_add_u32 v19, v19, 3, s37
    ds_write_b64 v18, v[16:17]
    ds_write_b64 v19, v[16:17]
    s_nop 5
    v_add_f32 v84, v84, v25
    v_cvt_pk_bf16_f32 v48, v84, v85
    v_cvt_pk_bf16_f32 v49, v86, v87
    v_cvt_pk_bf16_f32 v50, v88, v89
    v_cvt_pk_bf16_f32 v51, v90, v91
    v_cvt_pk_bf16_f32 v52, v92, v93
    v_cvt_pk_bf16_f32 v53, v94, v95
    ds_write_b32 v6, v50 offset:14464
    ds_write_b32 v7, v51 offset:14464
    ds_write_b16 v8, v52 offset:15488
    ds_write_b16_d16_hi v8, v52 offset:15552
    ds_write_b16 v8, v53 offset:15616
    ds_write_b16_d16_hi v8, v53 offset:15680
    ds_read2_b32 v[18:19], v9 offset0:128 offset1:129
    ds_read2_b32 v[20:21], v9 offset0:192 offset1:193
    v_add_u32 v9, 1024, v9
    ds_read2_b32 v[22:23], v9 offset0:0 offset1:1
    ds_write_b64 v5, v[48:49] offset:64
    s_waitcnt lgkmcnt(1)
    v_perm_b32 v24, v18, v18, s56
    v_perm_b32 v25, v19, v18, s58
    ds_write_b64 v13, v[24:25] offset:576
    v_perm_b32 v56, v20, v20, s56
    v_mov_b32 v57, v20
    v_perm_b32 v58, v20, v20, s57
    v_perm_b32 v59, v21, v21, s56
    ds_write_b128 v14, v[56:59] offset:1088
    v_perm_b32 v60, v22, v22, s56
    v_mov_b32 v61, v60
    v_mov_b32 v62, v22
    v_perm_b32 v63, v22, v22, s57
    v_mov_b32 v64, v63
    v_mov_b32 v65, v63
    v_perm_b32 v66, v23, v23, s56
    v_mov_b32 v67, v66
    ds_write_b128 v15, v[60:63] offset:2112
    ds_write_b128 v15, v[64:67] offset:2128
    ds_write_b32 v1, v71 offset:36
    s_cmp_lg_u32 s39, 0
    s_cbranch_scc1 L_H7
    s_mov_b64 exec, 1
    s_mov_b32 s62, 0
L_S0P:
    v_mov_b32 v72, 0
    buffer_atomic_add v72, v26, s[16:19], 0 offen sc0 sc1
    s_add_u32 s62, s62, 1
    s_waitcnt vmcnt(0)
    v_cmp_ne_u32 vcc, 16, v72
    s_cmp_gt_u32 s62, 20000
    s_cbranch_scc1 L_S0P_X
    s_cbranch_vccz L_S0P_X
    s_sleep 4
    s_branch L_S0P
L_S0P_X:
    s_mov_b64 exec, -1
    s_add_u32 m0, s38, 512
    s_add_u32 s89, s100, 0
    buffer_load_dwordx4 v70, s[16:19], s89 offen offset:0 sc1 lds
    s_add_u32 s89, s100, 68608
    buffer_load_dwordx4 v70, s[16:19], s89 offen offset:1024 sc1 lds
    s_add_u32 s89, s100, 137216
    buffer_load_dwordx4 v70, s[16:19], s89 offen offset:2048 sc1 lds
    s_add_u32 s89, s100, 205824
    buffer_load_dwordx4 v70, s[16:19], s89 offen offset:3072 sc1 lds
L_H7:
    v_cmp_eq_u32 vcc, 63, v0
    s_waitcnt vmcnt(0) lgkmcnt(0)
    v_mov_b32 v144, 0
    v_mov_b32 v145, 0
    v_mov_b32 v146, 0
    ds_read_b128 v[16:19], v10 offset:1024
    ds_read_b64_tr_b16 v[52:53], v11 offset:8
    ds_read_b64_tr_b16 v[54:55], v11 offset:40
    ds_read_b128 v[20:23], v10 offset:512
    ds_read_b128 v[24:27], v10 offset:896
    ds_read_b64_tr_b16 v[56:57], v11 offset:136
    ds_read_b64_tr_b16 v[58:59], v11 offset:168
    ds_read_b128 v[28:31], v10 offset:384
    ds_read_b128 v[32:35], v10 offset:768
    ds_read_b64_tr_b16 v[60:61], v11 offset:264
    ds_read_b64_tr_b16 v[62:63], v11 offset:296
    ds_read_b128 v[36:39], v10 offset:256
    s_waitcnt lgkmcnt(9)
    v_mfma_f32_32x32x16_bf16 v[92:107], v[16:19], v[52:55], 0
    ds_read_b128 v[40:43], v10 offset:640
    ds_read_b64_tr_b16 v[64:65], v11 offset:392
    ds_read_b64_tr_b16 v[66:67], v11 offset:424
    s_waitcnt lgkmcnt(11)
    v_mfma_f32_32x32x16_bf16 v[76:91], v[20:23], v[52:55], 0
    ds_read_b128 v[44:47], v10 offset:128
    ds_read_b64_tr_b16 v[68:69], v11 offset:520
    ds_read_b64_tr_b16 v[70:71], v11 offset:552
    s_waitcnt lgkmcnt(11)
    v_mfma_f32_32x32x16_bf16 v[92:107], v[24:27], v[56:59], v[92:107]
    ds_read_b64_tr_b16 v[72:73], v11 offset:648
    ds_read_b64_tr_b16 v[74:75], v11 offset:680
    ds_read_b64_tr_b16 v[52:53], v11 offset:776
    ds_read_b64_tr_b16 v[54:55], v11 offset:808
    s_waitcnt lgkmcnt(14)
    v_mfma_f32_32x32x16_bf16 v[76:91], v[28:31], v[56:59], v[76:91]
    s_waitcnt lgkmcnt(13)
    ds_read_b64_tr_b16 v[56:57], v11 offset:904
    ds_read_b64_tr_b16 v[58:59], v11 offset:936
    s_waitcnt lgkmcnt(14)
    ds_read_b128 v[48:51], v10 offset:2048
    s_waitcnt lgkmcnt(14)
    v_mfma_f32_32x32x16_bf16 v[92:107], v[32:35], v[60:63], v[92:107]
    ds_read_b128 v[16:19], v10 offset:1536
    s_waitcnt lgkmcnt(14)
    v_mfma_f32_32x32x16_bf16 v[76:91], v[36:39], v[60:63], v[76:91]
    s_waitcnt lgkmcnt(13)
    ds_read_b64_tr_b16 v[60:61], v11 offset:8
    ds_read_b64_tr_b16 v[62:63], v11 offset:40
    s_waitcnt lgkmcnt(13)
    v_mfma_f32_32x32x16_bf16 v[92:107], v[40:43], v[64:67], v[92:107]
    s_waitcnt lgkmcnt(12)
    v_mfma_f32_32x32x16_bf16 v[76:91], v[44:47], v[64:67], v[76:91]
    ds_read_b64_tr_b16 v[64:65], v11 offset:136
    ds_read_b64_tr_b16 v[66:67], v11 offset:168
    s_waitcnt lgkmcnt(12)
    v_mfma_f32_32x32x16_bf16 v[92:107], v[20:23], v[68:71], v[92:107]
    ds_read_b128 v[20:23], v10 offset:1920
    ds_read_b128 v[24:27], v10 offset:1408
    s_waitcnt lgkmcnt(12)
    v_mfma_f32_32x32x16_bf16 v[92:107], v[28:31], v[72:75], v[92:107]
    ds_read_b128 v[28:31], v10 offset:1792
    ds_read_b64_tr_b16 v[68:69], v11 offset:264
    ds_read_b64_tr_b16 v[70:71], v11 offset:296
    s_waitcnt lgkmcnt(13)
    v_mfma_f32_32x32x16_bf16 v[92:107], v[36:39], v[52:55], v[92:107]
    ds_read_b128 v[32:35], v10 offset:1280
    ds_read_b128 v[36:39], v10 offset:1664
    s_waitcnt lgkmcnt(13)
    v_mfma_f32_32x32x16_bf16 v[92:107], v[44:47], v[56:59], v[92:107]
    ds_read_b64_tr_b16 v[72:73], v11 offset:392
    ds_read_b64_tr_b16 v[74:75], v11 offset:424
    s_waitcnt lgkmcnt(14)
    ds_read_b128 v[40:43], v10 offset:1152
    s_waitcnt lgkmcnt(12)
    v_mfma_f32_32x32x16_bf16 v[124:139], v[48:51], v[60:63], 0
    ds_read_b64_tr_b16 v[52:53], v11 offset:520
    ds_read_b64_tr_b16 v[54:55], v11 offset:552
    ds_read_b128 v[44:47], v10 offset:1024
    v_mfma_f32_32x32x16_bf16 v[108:123], v[16:19], v[60:63], 0
    s_waitcnt lgkmcnt(13)
    ds_read_b64_tr_b16 v[56:57], v11 offset:648
    ds_read_b64_tr_b16 v[58:59], v11 offset:680
    s_waitcnt lgkmcnt(14)
    ds_read_b128 v[48:51], v10 offset:896
    v_mfma_f32_32x32x16_bf16 v[124:139], v[20:23], v[64:67], v[124:139]
    s_waitcnt lgkmcnt(13)
    ds_read_b64_tr_b16 v[60:61], v11 offset:776
    ds_read_b64_tr_b16 v[62:63], v11 offset:808
    v_mfma_f32_32x32x16_bf16 v[108:123], v[24:27], v[64:67], v[108:123]
    s_waitcnt lgkmcnt(13)
    ds_read_b64_tr_b16 v[64:65], v11 offset:904
    ds_read_b64_tr_b16 v[66:67], v11 offset:936
    s_nop 3
    v_mfma_f32_32x32x16_bf16 v[124:139], v[28:31], v[68:71], v[124:139]
    v_cndmask_b32 v140, v79, v144, vcc
    v_cndmask_b32 v141, v83, v79, vcc
    v_cndmask_b32 v142, v87, v83, vcc
    v_cndmask_b32 v143, v91, v87, vcc
    s_waitcnt lgkmcnt(14)
    v_mfma_f32_32x32x16_bf16 v[108:123], v[32:35], v[68:71], v[108:123]
    s_waitcnt lgkmcnt(13)
    ds_read_b64_tr_b16 v[68:69], v11 offset:1032
    ds_read_b64_tr_b16 v[70:71], v11 offset:1064
    v_add_f32_dpp v78, v140, v78 wave_ror:1 row_mask:0xf bank_mask:0xf
    v_add_f32_dpp v82, v141, v82 wave_ror:1 row_mask:0xf bank_mask:0xf
    v_add_f32_dpp v86, v142, v86 wave_ror:1 row_mask:0xf bank_mask:0xf
    v_add_f32_dpp v90, v143, v90 wave_ror:1 row_mask:0xf bank_mask:0xf
    s_waitcnt lgkmcnt(13)
    v_mfma_f32_32x32x16_bf16 v[124:139], v[36:39], v[72:75], v[124:139]
    v_cndmask_b32 v140, v78, v145, vcc
    v_cndmask_b32 v141, v82, v78, vcc
    v_cndmask_b32 v142, v86, v82, vcc
    v_cndmask_b32 v143, v90, v86, vcc
    s_waitcnt lgkmcnt(12)
    v_mfma_f32_32x32x16_bf16 v[108:123], v[40:43], v[72:75], v[108:123]
    ds_read_b64_tr_b16 v[72:73], v11 offset:1160
    ds_read_b64_tr_b16 v[74:75], v11 offset:1192
    v_add_f32_dpp v77, v140, v77 wave_ror:1 row_mask:0xf bank_mask:0xf
    v_add_f32_dpp v81, v141, v81 wave_ror:1 row_mask:0xf bank_mask:0xf
    v_add_f32_dpp v85, v142, v85 wave_ror:1 row_mask:0xf bank_mask:0xf
    v_add_f32_dpp v89, v143, v89 wave_ror:1 row_mask:0xf bank_mask:0xf
    s_waitcnt lgkmcnt(12)
    v_mfma_f32_32x32x16_bf16 v[124:139], v[16:19], v[52:55], v[124:139]
    ds_read_b128 v[16:19], v10 offset:768
    ds_read_b128 v[20:23], v10 offset:640
    v_cndmask_b32 v140, v77, v146, vcc
    v_cndmask_b32 v141, v81, v77, vcc
    v_cndmask_b32 v142, v85, v81, vcc
    v_cndmask_b32 v143, v89, v85, vcc
    s_waitcnt lgkmcnt(13)
    v_mfma_f32_32x32x16_bf16 v[108:123], v[44:47], v[52:55], v[108:123]
    ds_read_b64_tr_b16 v[52:53], v11 offset:1288
    ds_read_b64_tr_b16 v[54:55], v11 offset:1320
    v_add_f32_dpp v76, v140, v76 wave_ror:1 row_mask:0xf bank_mask:0xf
    v_add_f32_dpp v80, v141, v80 wave_ror:1 row_mask:0xf bank_mask:0xf
    v_add_f32_dpp v84, v142, v84 wave_ror:1 row_mask:0xf bank_mask:0xf
    v_add_f32_dpp v88, v143, v88 wave_ror:1 row_mask:0xf bank_mask:0xf
    s_waitcnt lgkmcnt(13)
    v_mfma_f32_32x32x16_bf16 v[124:139], v[24:27], v[56:59], v[124:139]
    ds_read_b128 v[24:27], v10 offset:512
    ds_read_b128 v[28:31], v10 offset:384
    v_cvt_pk_bf16_f32 v148, v76, v80
    v_cvt_pk_bf16_f32 v149, v84, v88
    v_cndmask_b32 v140, v95, v91, vcc
    v_cndmask_b32 v141, v99, v95, vcc
    s_waitcnt lgkmcnt(14)
    v_mfma_f32_32x32x16_bf16 v[108:123], v[48:51], v[56:59], v[108:123]
    s_waitcnt lgkmcnt(13)
    ds_read_b64_tr_b16 v[56:57], v11 offset:1416
    ds_read_b64_tr_b16 v[58:59], v11 offset:1448
    v_cndmask_b32 v142, v103, v99, vcc
    v_cndmask_b32 v143, v107, v103, vcc
    v_add_f32_dpp v94, v140, v94 wave_ror:1 row_mask:0xf bank_mask:0xf
    v_add_f32_dpp v98, v141, v98 wave_ror:1 row_mask:0xf bank_mask:0xf
    s_waitcnt lgkmcnt(14)
    v_mfma_f32_32x32x16_bf16 v[124:139], v[32:35], v[60:63], v[124:139]
    ds_read_b128 v[32:35], v10 offset:256
    s_waitcnt lgkmcnt(14)
    ds_read_b128 v[36:39], v10 offset:128
    v_add_f32_dpp v102, v142, v102 wave_ror:1 row_mask:0xf bank_mask:0xf
    v_add_f32_dpp v106, v143, v106 wave_ror:1 row_mask:0xf bank_mask:0xf
    v_cndmask_b32 v140, v94, v90, vcc
    v_cndmask_b32 v141, v98, v94, vcc
    s_waitcnt lgkmcnt(9)
    v_mfma_f32_32x32x16_bf16 v[108:123], v[16:19], v[60:63], v[108:123]
    ds_read_b64_tr_b16 v[60:61], v11 offset:1544
    ds_read_b64_tr_b16 v[62:63], v11 offset:1576
    v_cndmask_b32 v142, v102, v98, vcc
    v_cndmask_b32 v143, v106, v102, vcc
    v_add_f32_dpp v93, v140, v93 wave_ror:1 row_mask:0xf bank_mask:0xf
    v_add_f32_dpp v97, v141, v97 wave_ror:1 row_mask:0xf bank_mask:0xf
    v_mfma_f32_32x32x16_bf16 v[124:139], v[40:43], v[64:67], v[124:139]
    ds_read_b128 v[40:43], v10 offset:3072
    v_add_f32_dpp v101, v142, v101 wave_ror:1 row_mask:0xf bank_mask:0xf
    v_add_f32_dpp v105, v143, v105 wave_ror:1 row_mask:0xf bank_mask:0xf
    v_cndmask_b32 v140, v93, v89, vcc
    v_cndmask_b32 v141, v97, v93, vcc
    s_waitcnt lgkmcnt(11)
    v_mfma_f32_32x32x16_bf16 v[108:123], v[20:23], v[64:67], v[108:123]
    ds_read_b64_tr_b16 v[64:65], v11 offset:1672
    ds_read_b64_tr_b16 v[66:67], v11 offset:1704
    v_cndmask_b32 v142, v101, v97, vcc
    v_cndmask_b32 v143, v105, v101, vcc
    v_add_f32_dpp v92, v140, v92 wave_ror:1 row_mask:0xf bank_mask:0xf
    v_add_f32_dpp v96, v141, v96 wave_ror:1 row_mask:0xf bank_mask:0xf
    v_mfma_f32_32x32x16_bf16 v[124:139], v[44:47], v[68:71], v[124:139]
    ds_read_b128 v[44:47], v10 offset:2560
    v_add_f32_dpp v100, v142, v100 wave_ror:1 row_mask:0xf bank_mask:0xf
    v_add_f32_dpp v104, v143, v104 wave_ror:1 row_mask:0xf bank_mask:0xf
    v_cvt_pk_bf16_f32 v150, v92, v96
    v_cvt_pk_bf16_f32 v151, v100, v104
    s_waitcnt lgkmcnt(11)
    v_mfma_f32_32x32x16_bf16 v[108:123], v[24:27], v[68:71], v[108:123]
    ds_read_b64_tr_b16 v[68:69], v11 offset:1800
    ds_read_b64_tr_b16 v[70:71], v11 offset:1832
    v_mov_b32 v144, v107
    v_mov_b32 v145, v106
    v_mov_b32 v146, v105
    v_mfma_f32_32x32x16_bf16 v[124:139], v[48:51], v[72:75], v[124:139]
    ds_read_b128 v[48:51], v10 offset:2944
    s_waitcnt lgkmcnt(13)
    v_mfma_f32_32x32x16_bf16 v[108:123], v[28:31], v[72:75], v[108:123]
    ds_read_b64_tr_b16 v[72:73], v11 offset:1928
    ds_read_b64_tr_b16 v[74:75], v11 offset:1960
    v_mfma_f32_32x32x16_bf16 v[124:139], v[16:19], v[52:55], v[124:139]
    s_waitcnt lgkmcnt(14)
    ds_read_b128 v[16:19], v10 offset:2432
    s_waitcnt lgkmcnt(13)
    v_mfma_f32_32x32x16_bf16 v[108:123], v[32:35], v[52:55], v[108:123]
    ds_read_b64_tr_b16 v[52:53], v11 offset:8
    ds_read_b64_tr_b16 v[54:55], v11 offset:40
    v_mfma_f32_32x32x16_bf16 v[124:139], v[20:23], v[56:59], v[124:139]
    s_waitcnt lgkmcnt(14)
    ds_read_b128 v[20:23], v10 offset:2816
    v_mfma_f32_32x32x16_bf16 v[108:123], v[36:39], v[56:59], v[108:123]
    s_waitcnt lgkmcnt(13)
    ds_read_b64_tr_b16 v[56:57], v11 offset:136
    ds_read_b64_tr_b16 v[58:59], v11 offset:168
    v_mfma_f32_32x32x16_bf16 v[124:139], v[24:27], v[60:63], v[124:139]
    s_waitcnt lgkmcnt(13)
    ds_read_b64_tr_b16 v[60:61], v11 offset:264
    ds_read_b64_tr_b16 v[62:63], v11 offset:296
    s_waitcnt lgkmcnt(14)
    ds_read_b128 v[24:27], v10 offset:2304
    v_mfma_f32_32x32x16_bf16 v[124:139], v[28:31], v[64:67], v[124:139]
    s_waitcnt lgkmcnt(14)
    ds_read_b128 v[28:31], v10 offset:2688
    s_waitcnt lgkmcnt(13)
    ds_read_b64_tr_b16 v[64:65], v11 offset:392
    ds_read_b64_tr_b16 v[66:67], v11 offset:424
    v_mfma_f32_32x32x16_bf16 v[124:139], v[32:35], v[68:71], v[124:139]
    s_waitcnt lgkmcnt(14)
    ds_read_b128 v[32:35], v10 offset:2176
    s_waitcnt lgkmcnt(13)
    ds_read_b64_tr_b16 v[68:69], v11 offset:520
    ds_read_b64_tr_b16 v[70:71], v11 offset:552
    v_mfma_f32_32x32x16_bf16 v[124:139], v[36:39], v[72:75], v[124:139]
    s_waitcnt lgkmcnt(14)
    ds_read_b128 v[36:39], v10 offset:2048
    s_waitcnt lgkmcnt(13)
    ds_read_b64_tr_b16 v[72:73], v11 offset:648
    ds_read_b64_tr_b16 v[74:75], v11 offset:680
    v_mfma_f32_32x32x16_bf16 v[92:107], v[40:43], v[52:55], 0
    s_waitcnt lgkmcnt(14)
    ds_read_b128 v[40:43], v10 offset:1920
    v_mfma_f32_32x32x16_bf16 v[76:91], v[44:47], v[52:55], 0
    s_waitcnt lgkmcnt(13)
    ds_read_b64_tr_b16 v[52:53], v11 offset:776
    ds_read_b64_tr_b16 v[54:55], v11 offset:808
    v_mfma_f32_32x32x16_bf16 v[92:107], v[48:51], v[56:59], v[92:107]
    v_mfma_f32_32x32x16_bf16 v[76:91], v[16:19], v[56:59], v[76:91]
    s_waitcnt lgkmcnt(13)
    ds_read_b64_tr_b16 v[56:57], v11 offset:904
    ds_read_b64_tr_b16 v[58:59], v11 offset:936
    s_nop 3
    v_mfma_f32_32x32x16_bf16 v[92:107], v[20:23], v[60:63], v[92:107]
    v_cndmask_b32 v140, v111, v144, vcc
    v_cndmask_b32 v141, v115, v111, vcc
    v_cndmask_b32 v142, v119, v115, vcc
    v_cndmask_b32 v143, v123, v119, vcc
    s_waitcnt lgkmcnt(14)
    v_mfma_f32_32x32x16_bf16 v[76:91], v[24:27], v[60:63], v[76:91]
    s_waitcnt lgkmcnt(13)
    ds_read_b64_tr_b16 v[60:61], v11 offset:1032
    ds_read_b64_tr_b16 v[62:63], v11 offset:1064
    v_add_f32_dpp v110, v140, v110 wave_ror:1 row_mask:0xf bank_mask:0xf
    v_add_f32_dpp v114, v141, v114 wave_ror:1 row_mask:0xf bank_mask:0xf
    v_add_f32_dpp v118, v142, v118 wave_ror:1 row_mask:0xf bank_mask:0xf
    v_add_f32_dpp v122, v143, v122 wave_ror:1 row_mask:0xf bank_mask:0xf
    s_waitcnt lgkmcnt(13)
    v_mfma_f32_32x32x16_bf16 v[92:107], v[28:31], v[64:67], v[92:107]
    v_cndmask_b32 v140, v110, v145, vcc
    v_cndmask_b32 v141, v114, v110, vcc
    v_cndmask_b32 v142, v118, v114, vcc
    v_cndmask_b32 v143, v122, v118, vcc
    s_waitcnt lgkmcnt(12)
    v_mfma_f32_32x32x16_bf16 v[76:91], v[32:35], v[64:67], v[76:91]
    ds_read_b64_tr_b16 v[64:65], v11 offset:1160
    ds_read_b64_tr_b16 v[66:67], v11 offset:1192
    v_add_f32_dpp v109, v140, v109 wave_ror:1 row_mask:0xf bank_mask:0xf
    v_add_f32_dpp v113, v141, v113 wave_ror:1 row_mask:0xf bank_mask:0xf
    v_add_f32_dpp v117, v142, v117 wave_ror:1 row_mask:0xf bank_mask:0xf
    v_add_f32_dpp v121, v143, v121 wave_ror:1 row_mask:0xf bank_mask:0xf
    s_waitcnt lgkmcnt(12)
    v_mfma_f32_32x32x16_bf16 v[92:107], v[44:47], v[68:71], v[92:107]
    ds_read_b128 v[44:47], v10 offset:1792
    ds_read_b128 v[48:51], v10 offset:1664
    v_cndmask_b32 v140, v109, v146, vcc
    v_cndmask_b32 v141, v113, v109, vcc
    v_cndmask_b32 v142, v117, v113, vcc
    v_cndmask_b32 v143, v121, v117, vcc
    s_waitcnt lgkmcnt(13)
    v_mfma_f32_32x32x16_bf16 v[76:91], v[36:39], v[68:71], v[76:91]
    ds_read_b64_tr_b16 v[68:69], v11 offset:1288
    ds_read_b64_tr_b16 v[70:71], v11 offset:1320
    v_add_f32_dpp v108, v140, v108 wave_ror:1 row_mask:0xf bank_mask:0xf
    v_add_f32_dpp v112, v141, v112 wave_ror:1 row_mask:0xf bank_mask:0xf
    v_add_f32_dpp v116, v142, v116 wave_ror:1 row_mask:0xf bank_mask:0xf
    v_add_f32_dpp v120, v143, v120 wave_ror:1 row_mask:0xf bank_mask:0xf
    s_waitcnt lgkmcnt(13)
    v_mfma_f32_32x32x16_bf16 v[92:107], v[16:19], v[72:75], v[92:107]
    ds_read_b128 v[16:19], v10 offset:1536
    ds_read_b128 v[20:23], v10 offset:1408
    v_cvt_pk_bf16_f32 v152, v108, v112
    v_cvt_pk_bf16_f32 v153, v116, v120
    v_cndmask_b32 v140, v127, v123, vcc
    v_cndmask_b32 v141, v131, v127, vcc
    s_waitcnt lgkmcnt(14)
    v_mfma_f32_32x32x16_bf16 v[76:91], v[40:43], v[72:75], v[76:91]
    s_waitcnt lgkmcnt(13)
    ds_read_b64_tr_b16 v[72:73], v11 offset:1416
    ds_read_b64_tr_b16 v[74:75], v11 offset:1448
    v_cndmask_b32 v142, v135, v131, vcc
    v_cndmask_b32 v143, v139, v135, vcc
    v_add_f32_dpp v126, v140, v126 wave_ror:1 row_mask:0xf bank_mask:0xf
    v_add_f32_dpp v130, v141, v130 wave_ror:1 row_mask:0xf bank_mask:0xf
    s_waitcnt lgkmcnt(14)
    v_mfma_f32_32x32x16_bf16 v[92:107], v[24:27], v[52:55], v[92:107]
    ds_read_b128 v[24:27], v10 offset:1280
    s_waitcnt lgkmcnt(14)
    ds_read_b128 v[28:31], v10 offset:1152
    v_add_f32_dpp v134, v142, v134 wave_ror:1 row_mask:0xf bank_mask:0xf
    v_add_f32_dpp v138, v143, v138 wave_ror:1 row_mask:0xf bank_mask:0xf
    v_cndmask_b32 v140, v126, v122, vcc
    v_cndmask_b32 v141, v130, v126, vcc
    s_waitcnt lgkmcnt(9)
    v_mfma_f32_32x32x16_bf16 v[76:91], v[44:47], v[52:55], v[76:91]
    ds_read_b64_tr_b16 v[52:53], v11 offset:1544
    ds_read_b64_tr_b16 v[54:55], v11 offset:1576
    v_cndmask_b32 v142, v134, v130, vcc
    v_cndmask_b32 v143, v138, v134, vcc
    v_add_f32_dpp v125, v140, v125 wave_ror:1 row_mask:0xf bank_mask:0xf
    v_add_f32_dpp v129, v141, v129 wave_ror:1 row_mask:0xf bank_mask:0xf
    v_mfma_f32_32x32x16_bf16 v[92:107], v[32:35], v[56:59], v[92:107]
    ds_read_b128 v[32:35], v10 offset:1024
    v_add_f32_dpp v133, v142, v133 wave_ror:1 row_mask:0xf bank_mask:0xf
    v_add_f32_dpp v137, v143, v137 wave_ror:1 row_mask:0xf bank_mask:0xf
    v_cndmask_b32 v140, v125, v121, vcc
    v_cndmask_b32 v141, v129, v125, vcc
    s_waitcnt lgkmcnt(11)
    v_mfma_f32_32x32x16_bf16 v[76:91], v[48:51], v[56:59], v[76:91]
    ds_read_b64_tr_b16 v[56:57], v11 offset:1672
    ds_read_b64_tr_b16 v[58:59], v11 offset:1704
    v_cndmask_b32 v142, v133, v129, vcc
    v_cndmask_b32 v143, v137, v133, vcc
    v_add_f32_dpp v124, v140, v124 wave_ror:1 row_mask:0xf bank_mask:0xf
    v_add_f32_dpp v128, v141, v128 wave_ror:1 row_mask:0xf bank_mask:0xf
    v_mfma_f32_32x32x16_bf16 v[92:107], v[36:39], v[60:63], v[92:107]
    ds_read_b128 v[36:39], v10 offset:896
    v_add_f32_dpp v132, v142, v132 wave_ror:1 row_mask:0xf bank_mask:0xf
    v_add_f32_dpp v136, v143, v136 wave_ror:1 row_mask:0xf bank_mask:0xf
    v_cvt_pk_bf16_f32 v154, v124, v128
    v_cvt_pk_bf16_f32 v155, v132, v136
    s_waitcnt lgkmcnt(11)
    v_mfma_f32_32x32x16_bf16 v[76:91], v[16:19], v[60:63], v[76:91]
    ds_read_b64_tr_b16 v[60:61], v11 offset:1800
    ds_read_b64_tr_b16 v[62:63], v11 offset:1832
    v_mov_b32 v144, v139
    v_mov_b32 v145, v138
    v_mov_b32 v146, v137
    v_mfma_f32_32x32x16_bf16 v[92:107], v[40:43], v[64:67], v[92:107]
    ds_read_b128 v[40:43], v10 offset:768
    s_waitcnt lgkmcnt(13)
    v_mfma_f32_32x32x16_bf16 v[76:91], v[20:23], v[64:67], v[76:91]
    ds_read_b64_tr_b16 v[64:65], v11 offset:1928
    ds_read_b64_tr_b16 v[66:67], v11 offset:1960
    v_mfma_f32_32x32x16_bf16 v[92:107], v[44:47], v[68:71], v[92:107]
    s_waitcnt lgkmcnt(14)
    ds_read_b128 v[44:47], v10 offset:640
    s_waitcnt lgkmcnt(13)
    v_mfma_f32_32x32x16_bf16 v[76:91], v[24:27], v[68:71], v[76:91]
    ds_read_b64_tr_b16 v[68:69], v11 offset:2056
    ds_read_b64_tr_b16 v[70:71], v11 offset:2088
    v_mfma_f32_32x32x16_bf16 v[92:107], v[48:51], v[72:75], v[92:107]
    s_waitcnt lgkmcnt(14)
    ds_read_b128 v[48:51], v10 offset:512
    v_mfma_f32_32x32x16_bf16 v[76:91], v[28:31], v[72:75], v[76:91]
    s_waitcnt lgkmcnt(13)
    ds_read_b64_tr_b16 v[72:73], v11 offset:2184
    ds_read_b64_tr_b16 v[74:75], v11 offset:2216
    v_mfma_f32_32x32x16_bf16 v[92:107], v[16:19], v[52:55], v[92:107]
    s_waitcnt lgkmcnt(14)
    ds_read_b128 v[16:19], v10 offset:384
    v_mfma_f32_32x32x16_bf16 v[76:91], v[32:35], v[52:55], v[76:91]
    s_waitcnt lgkmcnt(13)
    ds_read_b64_tr_b16 v[52:53], v11 offset:2312
    ds_read_b64_tr_b16 v[54:55], v11 offset:2344
    v_mfma_f32_32x32x16_bf16 v[92:107], v[20:23], v[56:59], v[92:107]
    s_waitcnt lgkmcnt(14)
    ds_read_b128 v[20:23], v10 offset:256
    v_mfma_f32_32x32x16_bf16 v[76:91], v[36:39], v[56:59], v[76:91]
    s_waitcnt lgkmcnt(13)
    ds_read_b64_tr_b16 v[56:57], v11 offset:2440
    ds_read_b64_tr_b16 v[58:59], v11 offset:2472
    v_mfma_f32_32x32x16_bf16 v[92:107], v[24:27], v[60:63], v[92:107]
    s_waitcnt lgkmcnt(14)
    ds_read_b128 v[24:27], v10 offset:128
    v_mfma_f32_32x32x16_bf16 v[76:91], v[40:43], v[60:63], v[76:91]
    s_waitcnt lgkmcnt(13)
    ds_read_b64_tr_b16 v[60:61], v11 offset:2568
    ds_read_b64_tr_b16 v[62:63], v11 offset:2600
    v_mfma_f32_32x32x16_bf16 v[92:107], v[28:31], v[64:67], v[92:107]
    s_waitcnt lgkmcnt(14)
    ds_read_b128 v[28:31], v10 offset:4096
    v_mfma_f32_32x32x16_bf16 v[76:91], v[44:47], v[64:67], v[76:91]
    s_waitcnt lgkmcnt(13)
    ds_read_b64_tr_b16 v[64:65], v11 offset:2696
    ds_read_b64_tr_b16 v[66:67], v11 offset:2728
    v_mfma_f32_32x32x16_bf16 v[92:107], v[32:35], v[68:71], v[92:107]
    s_waitcnt lgkmcnt(14)
    ds_read_b128 v[32:35], v10 offset:3584
    v_mfma_f32_32x32x16_bf16 v[76:91], v[48:51], v[68:71], v[76:91]
    s_waitcnt lgkmcnt(13)
    ds_read_b64_tr_b16 v[68:69], v11 offset:2824
    ds_read_b64_tr_b16 v[70:71], v11 offset:2856
    v_mfma_f32_32x32x16_bf16 v[92:107], v[36:39], v[72:75], v[92:107]
    s_waitcnt lgkmcnt(14)
    ds_read_b128 v[36:39], v10 offset:3968
    v_mfma_f32_32x32x16_bf16 v[76:91], v[16:19], v[72:75], v[76:91]
    s_waitcnt lgkmcnt(13)
    ds_read_b64_tr_b16 v[72:73], v11 offset:2952
    ds_read_b64_tr_b16 v[74:75], v11 offset:2984
    v_mfma_f32_32x32x16_bf16 v[92:107], v[40:43], v[52:55], v[92:107]
    s_waitcnt lgkmcnt(14)
    ds_read_b128 v[40:43], v10 offset:3456
    v_mfma_f32_32x32x16_bf16 v[76:91], v[20:23], v[52:55], v[76:91]
    s_waitcnt lgkmcnt(13)
    ds_read_b64_tr_b16 v[52:53], v11 offset:8
    ds_read_b64_tr_b16 v[54:55], v11 offset:40
    v_mfma_f32_32x32x16_bf16 v[92:107], v[44:47], v[56:59], v[92:107]
    s_waitcnt lgkmcnt(14)
    ds_read_b128 v[44:47], v10 offset:3840
    v_mfma_f32_32x32x16_bf16 v[76:91], v[24:27], v[56:59], v[76:91]
    s_waitcnt lgkmcnt(13)
    ds_read_b64_tr_b16 v[56:57], v11 offset:136
    ds_read_b64_tr_b16 v[58:59], v11 offset:168
    v_mfma_f32_32x32x16_bf16 v[92:107], v[48:51], v[60:63], v[92:107]
    s_waitcnt lgkmcnt(13)
    ds_read_b64_tr_b16 v[60:61], v11 offset:264
    ds_read_b64_tr_b16 v[62:63], v11 offset:296
    s_waitcnt lgkmcnt(14)
    ds_read_b128 v[48:51], v10 offset:3328
    v_mfma_f32_32x32x16_bf16 v[92:107], v[16:19], v[64:67], v[92:107]
    s_waitcnt lgkmcnt(14)
    ds_read_b128 v[16:19], v10 offset:3712
    s_waitcnt lgkmcnt(13)
    ds_read_b64_tr_b16 v[64:65], v11 offset:392
    ds_read_b64_tr_b16 v[66:67], v11 offset:424
    v_mfma_f32_32x32x16_bf16 v[92:107], v[20:23], v[68:71], v[92:107]
    s_waitcnt lgkmcnt(14)
    ds_read_b128 v[20:23], v10 offset:3200
    s_waitcnt lgkmcnt(13)
    ds_read_b64_tr_b16 v[68:69], v11 offset:520
    ds_read_b64_tr_b16 v[70:71], v11 offset:552
    v_mfma_f32_32x32x16_bf16 v[92:107], v[24:27], v[72:75], v[92:107]
    s_waitcnt lgkmcnt(14)
    ds_read_b128 v[24:27], v10 offset:3072
    s_waitcnt lgkmcnt(13)
    ds_read_b64_tr_b16 v[72:73], v11 offset:648
    ds_read_b64_tr_b16 v[74:75], v11 offset:680
    v_mfma_f32_32x32x16_bf16 v[124:139], v[28:31], v[52:55], 0
    s_waitcnt lgkmcnt(14)
    ds_read_b128 v[28:31], v10 offset:2944
    v_mfma_f32_32x32x16_bf16 v[108:123], v[32:35], v[52:55], 0
    s_waitcnt lgkmcnt(13)
    ds_read_b64_tr_b16 v[52:53], v11 offset:776
    ds_read_b64_tr_b16 v[54:55], v11 offset:808
    v_mfma_f32_32x32x16_bf16 v[124:139], v[36:39], v[56:59], v[124:139]
    v_mfma_f32_32x32x16_bf16 v[108:123], v[40:43], v[56:59], v[108:123]
    s_waitcnt lgkmcnt(13)
    ds_read_b64_tr_b16 v[56:57], v11 offset:904
    ds_read_b64_tr_b16 v[58:59], v11 offset:936
    s_nop 3
    v_mfma_f32_32x32x16_bf16 v[124:139], v[44:47], v[60:63], v[124:139]
    v_cndmask_b32 v140, v79, v144, vcc
    v_cndmask_b32 v141, v83, v79, vcc
    v_cndmask_b32 v142, v87, v83, vcc
    v_cndmask_b32 v143, v91, v87, vcc
    s_waitcnt lgkmcnt(14)
    v_mfma_f32_32x32x16_bf16 v[108:123], v[48:51], v[60:63], v[108:123]
    s_waitcnt lgkmcnt(13)
    ds_read_b64_tr_b16 v[60:61], v11 offset:1032
    ds_read_b64_tr_b16 v[62:63], v11 offset:1064
    v_add_f32_dpp v78, v140, v78 wave_ror:1 row_mask:0xf bank_mask:0xf
    v_add_f32_dpp v82, v141, v82 wave_ror:1 row_mask:0xf bank_mask:0xf
    v_add_f32_dpp v86, v142, v86 wave_ror:1 row_mask:0xf bank_mask:0xf
    v_add_f32_dpp v90, v143, v90 wave_ror:1 row_mask:0xf bank_mask:0xf
    s_waitcnt lgkmcnt(13)
    v_mfma_f32_32x32x16_bf16 v[124:139], v[16:19], v[64:67], v[124:139]
    v_cndmask_b32 v140, v78, v145, vcc
    v_cndmask_b32 v141, v82, v78, vcc
    v_cndmask_b32 v142, v86, v82, vcc
    v_cndmask_b32 v143, v90, v86, vcc
    s_waitcnt lgkmcnt(12)
    v_mfma_f32_32x32x16_bf16 v[108:123], v[20:23], v[64:67], v[108:123]
    ds_read_b64_tr_b16 v[64:65], v11 offset:1160
    ds_read_b64_tr_b16 v[66:67], v11 offset:1192
    v_add_f32_dpp v77, v140, v77 wave_ror:1 row_mask:0xf bank_mask:0xf
    v_add_f32_dpp v81, v141, v81 wave_ror:1 row_mask:0xf bank_mask:0xf
    v_add_f32_dpp v85, v142, v85 wave_ror:1 row_mask:0xf bank_mask:0xf
    v_add_f32_dpp v89, v143, v89 wave_ror:1 row_mask:0xf bank_mask:0xf
    s_waitcnt lgkmcnt(12)
    v_mfma_f32_32x32x16_bf16 v[124:139], v[32:35], v[68:71], v[124:139]
    ds_read_b128 v[32:35], v10 offset:2816
    ds_read_b128 v[36:39], v10 offset:2688
    v_cndmask_b32 v140, v77, v146, vcc
    v_cndmask_b32 v141, v81, v77, vcc
    v_cndmask_b32 v142, v85, v81, vcc
    v_cndmask_b32 v143, v89, v85, vcc
    s_waitcnt lgkmcnt(13)
    v_mfma_f32_32x32x16_bf16 v[108:123], v[24:27], v[68:71], v[108:123]
    ds_read_b64_tr_b16 v[68:69], v11 offset:1288
    ds_read_b64_tr_b16 v[70:71], v11 offset:1320
    v_add_f32_dpp v76, v140, v76 wave_ror:1 row_mask:0xf bank_mask:0xf
    v_add_f32_dpp v80, v141, v80 wave_ror:1 row_mask:0xf bank_mask:0xf
    v_add_f32_dpp v84, v142, v84 wave_ror:1 row_mask:0xf bank_mask:0xf
    v_add_f32_dpp v88, v143, v88 wave_ror:1 row_mask:0xf bank_mask:0xf
    s_waitcnt lgkmcnt(13)
    v_mfma_f32_32x32x16_bf16 v[124:139], v[40:43], v[72:75], v[124:139]
    ds_read_b128 v[40:43], v10 offset:2560
    ds_read_b128 v[44:47], v10 offset:2432
    v_cvt_pk_bf16_f32 v156, v76, v80
    v_cvt_pk_bf16_f32 v157, v84, v88
    v_cndmask_b32 v140, v95, v91, vcc
    v_cndmask_b32 v141, v99, v95, vcc
    s_waitcnt lgkmcnt(14)
    v_mfma_f32_32x32x16_bf16 v[108:123], v[28:31], v[72:75], v[108:123]
    s_waitcnt lgkmcnt(13)
    ds_read_b64_tr_b16 v[72:73], v11 offset:1416
    ds_read_b64_tr_b16 v[74:75], v11 offset:1448
    v_cndmask_b32 v142, v103, v99, vcc
    v_cndmask_b32 v143, v107, v103, vcc
    v_add_f32_dpp v94, v140, v94 wave_ror:1 row_mask:0xf bank_mask:0xf
    v_add_f32_dpp v98, v141, v98 wave_ror:1 row_mask:0xf bank_mask:0xf
    s_waitcnt lgkmcnt(14)
    v_mfma_f32_32x32x16_bf16 v[124:139], v[48:51], v[52:55], v[124:139]
    ds_read_b128 v[48:51], v10 offset:2304
    s_waitcnt lgkmcnt(14)
    ds_read_b128 v[16:19], v10 offset:2176
    v_add_f32_dpp v102, v142, v102 wave_ror:1 row_mask:0xf bank_mask:0xf
    v_add_f32_dpp v106, v143, v106 wave_ror:1 row_mask:0xf bank_mask:0xf
    v_cndmask_b32 v140, v94, v90, vcc
    v_cndmask_b32 v141, v98, v94, vcc
    s_waitcnt lgkmcnt(9)
    v_mfma_f32_32x32x16_bf16 v[108:123], v[32:35], v[52:55], v[108:123]
    ds_read_b64_tr_b16 v[52:53], v11 offset:1544
    ds_read_b64_tr_b16 v[54:55], v11 offset:1576
    v_cndmask_b32 v142, v102, v98, vcc
    v_cndmask_b32 v143, v106, v102, vcc
    v_add_f32_dpp v93, v140, v93 wave_ror:1 row_mask:0xf bank_mask:0xf
    v_add_f32_dpp v97, v141, v97 wave_ror:1 row_mask:0xf bank_mask:0xf
    v_mfma_f32_32x32x16_bf16 v[124:139], v[20:23], v[56:59], v[124:139]
    ds_read_b128 v[20:23], v10 offset:2048
    v_add_f32_dpp v101, v142, v101 wave_ror:1 row_mask:0xf bank_mask:0xf
    v_add_f32_dpp v105, v143, v105 wave_ror:1 row_mask:0xf bank_mask:0xf
    v_cndmask_b32 v140, v93, v89, vcc
    v_cndmask_b32 v141, v97, v93, vcc
    s_waitcnt lgkmcnt(11)
    v_mfma_f32_32x32x16_bf16 v[108:123], v[36:39], v[56:59], v[108:123]
    ds_read_b64_tr_b16 v[56:57], v11 offset:1672
    ds_read_b64_tr_b16 v[58:59], v11 offset:1704
    v_cndmask_b32 v142, v101, v97, vcc
    v_cndmask_b32 v143, v105, v101, vcc
    v_add_f32_dpp v92, v140, v92 wave_ror:1 row_mask:0xf bank_mask:0xf
    v_add_f32_dpp v96, v141, v96 wave_ror:1 row_mask:0xf bank_mask:0xf
    v_mfma_f32_32x32x16_bf16 v[124:139], v[24:27], v[60:63], v[124:139]
    ds_read_b128 v[24:27], v10 offset:1920
    v_add_f32_dpp v100, v142, v100 wave_ror:1 row_mask:0xf bank_mask:0xf
    v_add_f32_dpp v104, v143, v104 wave_ror:1 row_mask:0xf bank_mask:0xf
    v_cvt_pk_bf16_f32 v158, v92, v96
    v_cvt_pk_bf16_f32 v159, v100, v104
    s_waitcnt lgkmcnt(11)
    v_mfma_f32_32x32x16_bf16 v[108:123], v[40:43], v[60:63], v[108:123]
    ds_read_b64_tr_b16 v[60:61], v11 offset:1800
    ds_read_b64_tr_b16 v[62:63], v11 offset:1832
    v_mov_b32 v144, v107
    v_mov_b32 v145, v106
    v_mov_b32 v146, v105
    v_mfma_f32_32x32x16_bf16 v[124:139], v[28:31], v[64:67], v[124:139]
    ds_read_b128 v[28:31], v10 offset:1792
    s_waitcnt lgkmcnt(13)
    v_mfma_f32_32x32x16_bf16 v[108:123], v[44:47], v[64:67], v[108:123]
    ds_read_b64_tr_b16 v[64:65], v11 offset:1928
    ds_read_b64_tr_b16 v[66:67], v11 offset:1960
    v_mfma_f32_32x32x16_bf16 v[124:139], v[32:35], v[68:71], v[124:139]
    s_waitcnt lgkmcnt(14)
    ds_read_b128 v[32:35], v10 offset:1664
    s_waitcnt lgkmcnt(13)
    v_mfma_f32_32x32x16_bf16 v[108:123], v[48:51], v[68:71], v[108:123]
    ds_read_b64_tr_b16 v[68:69], v11 offset:2056
    ds_read_b64_tr_b16 v[70:71], v11 offset:2088
    v_mfma_f32_32x32x16_bf16 v[124:139], v[36:39], v[72:75], v[124:139]
    s_waitcnt lgkmcnt(14)
    ds_read_b128 v[36:39], v10 offset:1536
    v_mfma_f32_32x32x16_bf16 v[108:123], v[16:19], v[72:75], v[108:123]
    s_waitcnt lgkmcnt(13)
    ds_read_b64_tr_b16 v[72:73], v11 offset:2184
    ds_read_b64_tr_b16 v[74:75], v11 offset:2216
    v_mfma_f32_32x32x16_bf16 v[124:139], v[40:43], v[52:55], v[124:139]
    s_waitcnt lgkmcnt(14)
    ds_read_b128 v[40:43], v10 offset:1408
    v_mfma_f32_32x32x16_bf16 v[108:123], v[20:23], v[52:55], v[108:123]
    s_waitcnt lgkmcnt(13)
    ds_read_b64_tr_b16 v[52:53], v11 offset:2312
    ds_read_b64_tr_b16 v[54:55], v11 offset:2344
    v_mfma_f32_32x32x16_bf16 v[124:139], v[44:47], v[56:59], v[124:139]
    s_waitcnt lgkmcnt(14)
    ds_read_b128 v[44:47], v10 offset:1280
    v_mfma_f32_32x32x16_bf16 v[108:123], v[24:27], v[56:59], v[108:123]
    s_waitcnt lgkmcnt(13)
    ds_read_b64_tr_b16 v[56:57], v11 offset:2440
    ds_read_b64_tr_b16 v[58:59], v11 offset:2472
    v_mfma_f32_32x32x16_bf16 v[124:139], v[48:51], v[60:63], v[124:139]
    s_waitcnt lgkmcnt(14)
    ds_read_b128 v[48:51], v10 offset:1152
    v_mfma_f32_32x32x16_bf16 v[108:123], v[28:31], v[60:63], v[108:123]
    s_waitcnt lgkmcnt(13)
    ds_read_b64_tr_b16 v[60:61], v11 offset:2568
    ds_read_b64_tr_b16 v[62:63], v11 offset:2600
    v_mfma_f32_32x32x16_bf16 v[124:139], v[16:19], v[64:67], v[124:139]
    s_waitcnt lgkmcnt(14)
    ds_read_b128 v[16:19], v10 offset:1024
    v_mfma_f32_32x32x16_bf16 v[108:123], v[32:35], v[64:67], v[108:123]
    s_waitcnt lgkmcnt(13)
    ds_read_b64_tr_b16 v[64:65], v11 offset:2696
    ds_read_b64_tr_b16 v[66:67], v11 offset:2728
    v_mfma_f32_32x32x16_bf16 v[124:139], v[20:23], v[68:71], v[124:139]
    s_waitcnt lgkmcnt(14)
    ds_read_b128 v[20:23], v10 offset:896
    v_mfma_f32_32x32x16_bf16 v[108:123], v[36:39], v[68:71], v[108:123]
    s_waitcnt lgkmcnt(13)
    ds_read_b64_tr_b16 v[68:69], v11 offset:2824
    ds_read_b64_tr_b16 v[70:71], v11 offset:2856
    v_mfma_f32_32x32x16_bf16 v[124:139], v[24:27], v[72:75], v[124:139]
    s_waitcnt lgkmcnt(14)
    ds_read_b128 v[24:27], v10 offset:768
    v_mfma_f32_32x32x16_bf16 v[108:123], v[40:43], v[72:75], v[108:123]
    s_waitcnt lgkmcnt(13)
    ds_read_b64_tr_b16 v[72:73], v11 offset:2952
    ds_read_b64_tr_b16 v[74:75], v11 offset:2984
    v_mfma_f32_32x32x16_bf16 v[124:139], v[28:31], v[52:55], v[124:139]
    s_waitcnt lgkmcnt(14)
    ds_read_b128 v[28:31], v10 offset:640
    v_mfma_f32_32x32x16_bf16 v[108:123], v[44:47], v[52:55], v[108:123]
    s_waitcnt lgkmcnt(13)
    ds_read_b64_tr_b16 v[52:53], v11 offset:3080
    ds_read_b64_tr_b16 v[54:55], v11 offset:3112
    v_mfma_f32_32x32x16_bf16 v[124:139], v[32:35], v[56:59], v[124:139]
    s_waitcnt lgkmcnt(14)
    ds_read_b128 v[32:35], v10 offset:512
    v_mfma_f32_32x32x16_bf16 v[108:123], v[48:51], v[56:59], v[108:123]
    s_waitcnt lgkmcnt(13)
    ds_read_b64_tr_b16 v[56:57], v11 offset:3208
    ds_read_b64_tr_b16 v[58:59], v11 offset:3240
    v_mfma_f32_32x32x16_bf16 v[124:139], v[36:39], v[60:63], v[124:139]
    s_waitcnt lgkmcnt(14)
    ds_read_b128 v[36:39], v10 offset:384
    v_mfma_f32_32x32x16_bf16 v[108:123], v[16:19], v[60:63], v[108:123]
    s_waitcnt lgkmcnt(13)
    ds_read_b64_tr_b16 v[60:61], v11 offset:3336
    ds_read_b64_tr_b16 v[62:63], v11 offset:3368
    v_mfma_f32_32x32x16_bf16 v[124:139], v[40:43], v[64:67], v[124:139]
    s_waitcnt lgkmcnt(14)
    ds_read_b128 v[40:43], v10 offset:256
    v_mfma_f32_32x32x16_bf16 v[108:123], v[20:23], v[64:67], v[108:123]
    s_waitcnt lgkmcnt(13)
    ds_read_b64_tr_b16 v[64:65], v11 offset:3464
    ds_read_b64_tr_b16 v[66:67], v11 offset:3496
    v_mfma_f32_32x32x16_bf16 v[124:139], v[44:47], v[68:71], v[124:139]
    s_waitcnt lgkmcnt(14)
    ds_read_b128 v[44:47], v10 offset:128
    v_mfma_f32_32x32x16_bf16 v[108:123], v[24:27], v[68:71], v[108:123]
    s_waitcnt lgkmcnt(13)
    ds_read_b64_tr_b16 v[68:69], v11 offset:3592
    ds_read_b64_tr_b16 v[70:71], v11 offset:3624
    v_mfma_f32_32x32x16_bf16 v[124:139], v[48:51], v[72:75], v[124:139]
    s_waitcnt lgkmcnt(14)
    v_mfma_f32_32x32x16_bf16 v[108:123], v[28:31], v[72:75], v[108:123]
    s_waitcnt lgkmcnt(13)
    ds_read_b64_tr_b16 v[72:73], v11 offset:3720
    ds_read_b64_tr_b16 v[74:75], v11 offset:3752
    s_waitcnt lgkmcnt(14)
    v_mfma_f32_32x32x16_bf16 v[124:139], v[16:19], v[52:55], v[124:139]
    s_waitcnt lgkmcnt(13)
    v_mfma_f32_32x32x16_bf16 v[108:123], v[32:35], v[52:55], v[108:123]
    ds_read_b64_tr_b16 v[52:53], v11 offset:3848
    ds_read_b64_tr_b16 v[54:55], v11 offset:3880
    s_waitcnt lgkmcnt(13)
    v_mfma_f32_32x32x16_bf16 v[124:139], v[20:23], v[56:59], v[124:139]
    s_waitcnt lgkmcnt(12)
    v_mfma_f32_32x32x16_bf16 v[108:123], v[36:39], v[56:59], v[108:123]
    ds_read_b64_tr_b16 v[56:57], v11 offset:3976
    ds_read_b64_tr_b16 v[58:59], v11 offset:4008
    s_waitcnt lgkmcnt(12)
    v_mfma_f32_32x32x16_bf16 v[124:139], v[24:27], v[60:63], v[124:139]
    s_waitcnt lgkmcnt(11)
    v_mfma_f32_32x32x16_bf16 v[108:123], v[40:43], v[60:63], v[108:123]
    s_waitcnt lgkmcnt(9)
    v_mfma_f32_32x32x16_bf16 v[124:139], v[28:31], v[64:67], v[124:139]
    s_waitcnt lgkmcnt(8)
    v_mfma_f32_32x32x16_bf16 v[108:123], v[44:47], v[64:67], v[108:123]
    s_waitcnt lgkmcnt(6)
    v_mfma_f32_32x32x16_bf16 v[124:139], v[32:35], v[68:71], v[124:139]
    s_waitcnt lgkmcnt(4)
    v_mfma_f32_32x32x16_bf16 v[124:139], v[36:39], v[72:75], v[124:139]
    s_waitcnt lgkmcnt(2)
    v_mfma_f32_32x32x16_bf16 v[124:139], v[40:43], v[52:55], v[124:139]
    s_waitcnt lgkmcnt(0)
    v_mfma_f32_32x32x16_bf16 v[124:139], v[44:47], v[56:59], v[124:139]
    s_nop 11
    v_cndmask_b32 v140, v111, v144, vcc
    v_cndmask_b32 v141, v115, v111, vcc
    v_cndmask_b32 v142, v119, v115, vcc
    v_cndmask_b32 v143, v123, v119, vcc
    v_add_f32_dpp v110, v140, v110 wave_ror:1 row_mask:0xf bank_mask:0xf
    v_add_f32_dpp v114, v141, v114 wave_ror:1 row_mask:0xf bank_mask:0xf
    v_add_f32_dpp v118, v142, v118 wave_ror:1 row_mask:0xf bank_mask:0xf
    v_add_f32_dpp v122, v143, v122 wave_ror:1 row_mask:0xf bank_mask:0xf
    v_cndmask_b32 v140, v110, v145, vcc
    v_cndmask_b32 v141, v114, v110, vcc
    v_cndmask_b32 v142, v118, v114, vcc
    v_cndmask_b32 v143, v122, v118, vcc
    v_add_f32_dpp v109, v140, v109 wave_ror:1 row_mask:0xf bank_mask:0xf
    v_add_f32_dpp v113, v141, v113 wave_ror:1 row_mask:0xf bank_mask:0xf
    v_add_f32_dpp v117, v142, v117 wave_ror:1 row_mask:0xf bank_mask:0xf
    v_add_f32_dpp v121, v143, v121 wave_ror:1 row_mask:0xf bank_mask:0xf
    v_cndmask_b32 v140, v109, v146, vcc
    v_cndmask_b32 v141, v113, v109, vcc
    v_cndmask_b32 v142, v117, v113, vcc
    v_cndmask_b32 v143, v121, v117, vcc
    v_add_f32_dpp v108, v140, v108 wave_ror:1 row_mask:0xf bank_mask:0xf
    v_add_f32_dpp v112, v141, v112 wave_ror:1 row_mask:0xf bank_mask:0xf
    v_add_f32_dpp v116, v142, v116 wave_ror:1 row_mask:0xf bank_mask:0xf
    v_add_f32_dpp v120, v143, v120 wave_ror:1 row_mask:0xf bank_mask:0xf
    v_cvt_pk_bf16_f32 v160, v108, v112
    v_cvt_pk_bf16_f32 v161, v116, v120
    v_cndmask_b32 v140, v127, v123, vcc
    v_cndmask_b32 v141, v131, v127, vcc
    v_cndmask_b32 v142, v135, v131, vcc
    v_cndmask_b32 v143, v139, v135, vcc
    v_add_f32_dpp v126, v140, v126 wave_ror:1 row_mask:0xf bank_mask:0xf
    v_add_f32_dpp v130, v141, v130 wave_ror:1 row_mask:0xf bank_mask:0xf
    v_add_f32_dpp v134, v142, v134 wave_ror:1 row_mask:0xf bank_mask:0xf
    v_add_f32_dpp v138, v143, v138 wave_ror:1 row_mask:0xf bank_mask:0xf
    v_cndmask_b32 v140, v126, v122, vcc
    v_cndmask_b32 v141, v130, v126, vcc
    v_cndmask_b32 v142, v134, v130, vcc
    v_cndmask_b32 v143, v138, v134, vcc
    v_add_f32_dpp v125, v140, v125 wave_ror:1 row_mask:0xf bank_mask:0xf
    v_add_f32_dpp v129, v141, v129 wave_ror:1 row_mask:0xf bank_mask:0xf
    v_add_f32_dpp v133, v142, v133 wave_ror:1 row_mask:0xf bank_mask:0xf
    v_add_f32_dpp v137, v143, v137 wave_ror:1 row_mask:0xf bank_mask:0xf
    v_cndmask_b32 v140, v125, v121, vcc
    v_cndmask_b32 v141, v129, v125, vcc
    v_cndmask_b32 v142, v133, v129, vcc
    v_cndmask_b32 v143, v137, v133, vcc
    v_add_f32_dpp v124, v140, v124 wave_ror:1 row_mask:0xf bank_mask:0xf
    v_add_f32_dpp v128, v141, v128 wave_ror:1 row_mask:0xf bank_mask:0xf
    v_add_f32_dpp v132, v142, v132 wave_ror:1 row_mask:0xf bank_mask:0xf
    v_add_f32_dpp v136, v143, v136 wave_ror:1 row_mask:0xf bank_mask:0xf
    v_cvt_pk_bf16_f32 v162, v124, v128
    v_cvt_pk_bf16_f32 v163, v132, v136
    s_mov_b32 s63, 0
    s_branch L_YH_R
L_YH:
    v_readfirstlane_b32 s88, v16
    s_cmp_ge_u32 s88, 8
    s_cbranch_scc1 L_YH_X
    s_add_u32 s63, s63, 1
    s_cmp_gt_u32 s63, 200000
    s_cbranch_scc1 L_YH_X
    s_sleep 4
L_YH_R:
    ds_read_b32 v16, v1 offset:28
    s_waitcnt lgkmcnt(0)
    s_branch L_YH
L_YH_X:
    s_setprio 3
    ds_write_b16 v12, v148 offset:10240
    ds_write_b16_d16_hi v12, v148 offset:10368
    ds_write_b16 v12, v149 offset:10496
    ds_write_b16_d16_hi v12, v149 offset:10624
    ds_write_b16 v12, v150 offset:10752
    ds_write_b16_d16_hi v12, v150 offset:10880
    ds_write_b16 v12, v151 offset:11008
    ds_write_b16_d16_hi v12, v151 offset:11136
    ds_write_b16 v12, v152 offset:11264
    ds_write_b16_d16_hi v12, v152 offset:11392
    ds_write_b16 v12, v153 offset:11520
    ds_write_b16_d16_hi v12, v153 offset:11648
    ds_write_b16 v12, v154 offset:11776
    ds_write_b16_d16_hi v12, v154 offset:11904
    ds_write_b16 v12, v155 offset:12032
    s_waitcnt lgkmcnt(14)
    ds_write_b16_d16_hi v12, v155 offset:12160
    s_waitcnt lgkmcnt(14)
    ds_write_b16 v12, v156 offset:12288
    s_waitcnt lgkmcnt(14)
    ds_write_b16_d16_hi v12, v156 offset:12416
    s_waitcnt lgkmcnt(14)
    ds_write_b16 v12, v157 offset:12544
    s_waitcnt lgkmcnt(14)
    ds_write_b16_d16_hi v12, v157 offset:12672
    s_waitcnt lgkmcnt(14)
    ds_write_b16 v12, v158 offset:12800
    s_waitcnt lgkmcnt(14)
    ds_write_b16_d16_hi v12, v158 offset:12928
    s_waitcnt lgkmcnt(14)
    ds_write_b16 v12, v159 offset:13056
    s_waitcnt lgkmcnt(14)
    ds_write_b16_d16_hi v12, v159 offset:13184
    s_waitcnt lgkmcnt(14)
    ds_write_b16 v12, v160 offset:13312
    s_waitcnt lgkmcnt(14)
    ds_write_b16_d16_hi v12, v160 offset:13440
    s_waitcnt lgkmcnt(14)
    ds_write_b16 v12, v161 offset:13568
    s_waitcnt lgkmcnt(14)
    ds_write_b16_d16_hi v12, v161 offset:13696
    s_waitcnt lgkmcnt(14)
    ds_write_b16 v12, v162 offset:13824
    s_waitcnt lgkmcnt(14)
    ds_write_b16_d16_hi v12, v162 offset:13952
    s_waitcnt lgkmcnt(14)
    ds_write_b16 v12, v163 offset:14080
    s_waitcnt lgkmcnt(14)
    ds_write_b16_d16_hi v12, v163 offset:14208
    s_waitcnt lgkmcnt(0)
    v_mov_b32 v3, 1
    s_mov_b64 exec, 1
    ds_add_u32 v1, v3 offset:4
    s_mov_b64 exec, -1
    s_lshl_b32 s89, s90, 10
    s_add_u32 s89, s89, 108544
    v_lshl_add_u32 v4, v0, 3, s89
    s_mov_b32 s63, 0
L_Y0:
    ds_read_b32 v5, v1 offset:4
    s_add_u32 s63, s63, 1
    s_waitcnt lgkmcnt(0)
    v_readfirstlane_b32 s88, v5
    s_cmp_gt_u32 s63, 200000
    s_cselect_b32 s88, 4, s88
    s_cmp_ge_u32 s88, 4
    s_cbranch_scc0 L_Y0
    ds_read_b64 v[16:17], v4 offset:0
    ds_read_b64 v[18:19], v4 offset:16384
    ds_read_b64 v[20:21], v4 offset:32768
    ds_read_b64 v[22:23], v4 offset:49152
    ds_read_b64 v[24:25], v4 offset:512
    ds_read_b64 v[26:27], v4 offset:16896
    ds_read_b64 v[28:29], v4 offset:33280
    ds_read_b64 v[30:31], v4 offset:49664
    s_mov_b32 s56, 0x05040100
    s_mov_b32 s57, 0x07060302
    s_waitcnt lgkmcnt(0)
    s_mov_b64 exec, 1
    ds_add_u32 v1, v3 offset:8
    s_mov_b64 exec, -1
    v_perm_b32 v150, v18, v16, s56
    v_perm_b32 v151, v22, v20, s56
    v_perm_b32 v152, v18, v16, s57
    v_perm_b32 v153, v22, v20, s57
    v_perm_b32 v154, v19, v17, s56
    v_perm_b32 v155, v23, v21, s56
    v_perm_b32 v156, v19, v17, s57
    v_perm_b32 v157, v23, v21, s57
    v_perm_b32 v158, v26, v24, s56
    v_perm_b32 v159, v30, v28, s56
    v_perm_b32 v160, v26, v24, s57
    v_perm_b32 v161, v30, v28, s57
    v_perm_b32 v162, v27, v25, s56
    v_perm_b32 v163, v31, v29, s56
    v_perm_b32 v164, v27, v25, s57
    v_perm_b32 v165, v31, v29, s57
    s_mov_b32 s63, 0
L_Y1:
    ds_read_b32 v5, v1 offset:8
    s_add_u32 s63, s63, 1
    s_waitcnt lgkmcnt(0)
    v_readfirstlane_b32 s88, v5
    s_cmp_gt_u32 s63, 200000
    s_cselect_b32 s88, 4, s88
    s_cmp_ge_u32 s88, 4
    s_cbranch_scc0 L_Y1
L_SVC2:
    s_setprio 3
    s_sub_u32 s36, s3, 8
    s_lshl_b32 s37, s4, 2
    s_and_b32 s38, s5, 3
    s_add_u32 s37, s37, s38
    v_lshlrev_b32 v2, 4, v0
    v_mov_b32 v1, 114432
    s_mul_i32 s39, s37, 163840
    s_add_u32 s39, s39, 2621440
    s_and_b32 s40, s5, 7
    s_lshr_b32 s41, s5, 3
    s_lshl_b32 s88, s4, 2
    s_add_u32 s41, s41, s88
    s_mul_i32 s58, s4, 20
    s_add_u32 s58, s58, s5
    s_lshl_b32 s58, s58, 3
    s_mul_i32 s88, s36, 1310720
    s_add_u32 s58, s58, s88
    s_add_u32 s58, s58, 1280
    s_cmp_lt_u32 s5, 20
    s_cselect_b32 s58, s58, 0x7ff00000
    v_mul_u32_u24 v145, 10240, v0
    v_add_u32 v146, 5120, v145
    v_and_b32 v3, 15, v0
    v_lshrrev_b32 v4, 4, v0
    v_lshrrev_b32 v5, 1, v4
    v_and_b32 v6, 1, v4
    v_mul_u32_u24 v7, 1280, v5
    v_lshl_add_u32 v7, v6, 9, v7
    v_lshl_add_u32 v7, v3, 4, v7
    v_mul_u32_u24 v8, 2560, v4
    v_lshl_add_u32 v8, v3, 3, v8
    s_lshl_b32 s88, s41, 1
    s_lshr_b32 s89, s36, 1
    s_add_u32 s88, s88, s89
    s_mul_i32 s59, s88, 40960
    s_add_u32 s59, s59, 7864320
    s_lshl_b32 s88, s41, 3
    s_add_u32 s88, s88, s40
    s_lshl_b32 s88, s88, 7
    s_lshl_b32 s89, s89, 4
    s_add_u32 s88, s88, s89
    s_add_u32 s88, s88, 10489888
    v_lshl_add_u32 v15, v0, 2, s88
    s_and_b32 s89, s36, 1
    s_lshl_b32 s88, s89, 8
    v_add_u32 v7, s88, v7
    s_lshl_b32 s88, s89, 7
    v_add_u32 v8, s88, v8
    s_lshl_b32 s88, s41, 6
    s_lshl_b32 s89, s36, 4
    s_add_u32 s88, s88, s89
    s_mul_i32 s56, s88, 2560
    s_mul_i32 s88, s40, 160
    s_add_u32 s56, s56, s88
    v_mul_u32_u24 v9, 2560, v3
    v_lshl_add_u32 v10, v4, 3, v9
    v_lshl_add_u32 v9, v6, 5, v9
    v_lshl_add_u32 v9, v5, 4, v9
    s_mul_i32 s93, s36, 25600
    s_add_u32 s93, s93, 1024
    s_lshl_b32 s88, s41, 3
    s_add_u32 s88, s88, s40
    s_lshl_b32 s88, s88, 7
    s_add_u32 s88, s88, 10489868
    v_mov_b32 v13, s88
    v_add_u32 v14, 51200, v2
    s_lshl_b32 s88, s5, 2
    s_add_u32 s88, s88, s36
    s_mul_i32 s88, s88, 512
    v_min_u32 v147, 3, v0
    v_lshl_add_u32 v147, v147, 7, s88
    v_min_u32 v147, L_CODE_END-concat_heads__mha_block__ssm_conv_s4d__prompt_kernel-4, v147
    s_getpc_b64 s[94:95]
L_PC2:
    s_sub_u32 s94, s94, L_PC2-concat_heads__mha_block__ssm_conv_s4d__prompt_kernel
    s_subb_u32 s95, s95, 0
    v_mov_b32 v148, 0
    v_mov_b32 v149, 1
    v_mov_b32 v48, 0
    v_mov_b32 v49, 0
    v_mov_b32 v50, 0
    v_mov_b32 v51, 0
    v_mov_b32 v52, 0
    v_mov_b32 v53, 0
    v_mov_b32 v54, 0
    v_mov_b32 v55, 0
    v_mov_b32 v56, 0
    v_mov_b32 v57, 0
    v_mov_b32 v58, 0
    v_mov_b32 v59, 0
    v_mov_b32 v60, 0
    v_mov_b32 v61, 0
    v_mov_b32 v62, 0
    v_mov_b32 v63, 0
    v_mov_b32 v64, 0
    v_mov_b32 v65, 0
    v_mov_b32 v66, 0
    v_mov_b32 v67, 0
    s_and_b32 s98, s40, 3
    v_lshlrev_b32 v6, 2, v0
    s_mov_b32 s63, 0
    s_branch L_V_S1_R
L_V_S1:
    v_readfirstlane_b32 s88, v3
    s_cmp_ge_u32 s88, 8
    s_cbranch_scc1 L_V_S1_X
    s_add_u32 s63, s63, 1
    s_cmp_gt_u32 s63, 200000
    s_cbranch_scc1 L_V_S1_X
    s_sleep 4
L_V_S1_R:
    ds_read_b32 v3, v1 offset:28
    s_waitcnt lgkmcnt(0)
    s_branch L_V_S1
L_V_S1_X:
    s_add_u32 s42, s36, 88
    s_lshl_b32 s42, s42, 10
    s_mov_b32 m0, s42
    s_add_u32 s43, s39, s42
    buffer_load_dwordx4 v2, s[16:19], s43 offen sc1 lds
    s_add_u32 s42, s42, 4096
    s_waitcnt vmcnt(3)
    s_mov_b32 m0, s42
    s_add_u32 s43, s39, s42
    buffer_load_dwordx4 v2, s[16:19], s43 offen sc1 lds
    s_add_u32 s42, s42, 4096
    s_waitcnt vmcnt(3)
    s_mov_b32 m0, s42
    s_add_u32 s43, s39, s42
    buffer_load_dwordx4 v2, s[16:19], s43 offen sc1 lds
    s_add_u32 s42, s42, 4096
    s_waitcnt vmcnt(3)
    s_mov_b32 m0, s42
    s_add_u32 s43, s39, s42
    buffer_load_dwordx4 v2, s[16:19], s43 offen sc1 lds
    s_add_u32 s42, s42, 4096
    s_waitcnt vmcnt(3)
    s_mov_b32 m0, s42
    s_add_u32 s43, s39, s42
    buffer_load_dwordx4 v2, s[16:19], s43 offen sc1 lds
    s_add_u32 s42, s42, 4096
    s_waitcnt vmcnt(3)
    s_cmp_eq_u32 s42, 113664
    s_cselect_b32 s88, 4096, 0
    s_sub_u32 s88, s42, s88
    s_mov_b32 m0, s88
    s_add_u32 s43, s39, s88
    buffer_load_dwordx4 v2, s[16:19], s43 offen sc1 lds
    s_add_u32 s42, s42, 4096
    s_waitcnt vmcnt(3)
    s_mov_b32 m0, s42
    s_add_u32 s43, s39, s42
    buffer_load_dwordx4 v2, s[16:19], s43 offen sc1 lds
    s_add_u32 s42, s42, 4096
    s_waitcnt vmcnt(3)
    s_mov_b32 m0, s42
    s_add_u32 s43, s39, s42
    buffer_load_dwordx4 v2, s[16:19], s43 offen sc1 lds
    s_add_u32 s42, s42, 4096
    s_waitcnt vmcnt(3)
    s_mov_b32 m0, s42
    s_add_u32 s43, s39, s42
    buffer_load_dwordx4 v2, s[16:19], s43 offen sc1 lds
    s_add_u32 s42, s42, 4096
    s_waitcnt vmcnt(3)
    s_mov_b32 m0, s42
    s_add_u32 s43, s39, s42
    buffer_load_dwordx4 v2, s[16:19], s43 offen sc1 lds
    s_add_u32 s42, s42, 4096
    s_waitcnt vmcnt(3)
    s_mov_b32 m0, s42
    s_add_u32 s43, s39, s42
    buffer_load_dwordx4 v2, s[16:19], s43 offen sc1 lds
    s_add_u32 s42, s42, 4096
    s_waitcnt vmcnt(3)
    s_mov_b32 m0, s42
    s_add_u32 s43, s39, s42
    buffer_load_dwordx4 v2, s[16:19], s43 offen sc1 lds
    s_add_u32 s42, s42, 4096
    s_waitcnt vmcnt(3)
    s_mov_b32 m0, s42
    s_add_u32 s43, s39, s42
    buffer_load_dwordx4 v2, s[16:19], s43 offen sc1 lds
    s_add_u32 s42, s42, 4096
    s_waitcnt vmcnt(3)
    s_mov_b32 m0, s42
    s_add_u32 s43, s39, s42
    buffer_load_dwordx4 v2, s[16:19], s43 offen sc1 lds
    s_add_u32 s42, s42, 4096
    s_waitcnt vmcnt(3)
    s_mov_b32 m0, s42
    s_add_u32 s43, s39, s42
    buffer_load_dwordx4 v2, s[16:19], s43 offen sc1 lds
    s_add_u32 s42, s42, 4096
    s_waitcnt vmcnt(3)
    s_mov_b32 m0, s42
    s_add_u32 s43, s39, s42
    buffer_load_dwordx4 v2, s[16:19], s43 offen sc1 lds
    s_add_u32 s42, s42, 4096
    s_waitcnt vmcnt(3)
    s_mov_b32 m0, s42
    s_add_u32 s43, s39, s42
    buffer_load_dwordx4 v2, s[16:19], s43 offen sc1 lds
    s_add_u32 s42, s42, 4096
    s_waitcnt vmcnt(3)
    s_mov_b32 m0, s42
    s_add_u32 s43, s39, s42
    buffer_load_dwordx4 v2, s[16:19], s43 offen sc1 lds
    s_add_u32 s42, s42, 4096
    s_waitcnt vmcnt(3)
    s_waitcnt vmcnt(0)
    s_mov_b64 exec, 1
    ds_add_u32 v148, v149 offset:136
    s_mov_b64 exec, -1
    s_cmp_lg_u32 s36, 0
    s_cbranch_scc1 L_LWD
    s_mov_b32 s63, 0
    s_branch L_P1_R
L_P1:
    v_readfirstlane_b32 s88, v3
    s_cmp_ge_u32 s88, 8
    s_cbranch_scc1 L_P1_X
    s_add_u32 s63, s63, 1
    s_cmp_gt_u32 s63, 200000
    s_cbranch_scc1 L_P1_X
    s_sleep 2
L_P1_R:
    ds_read_b32 v3, v148 offset:4
    s_waitcnt lgkmcnt(0)
    s_branch L_P1
L_P1_X:
    s_mov_b32 s63, 0
    s_branch L_P1b_R
L_P1b:
    v_readfirstlane_b32 s88, v3
    s_cmp_ge_u32 s88, 4
    s_cbranch_scc1 L_P1b_X
    s_add_u32 s63, s63, 1
    s_cmp_gt_u32 s63, 200000
    s_cbranch_scc1 L_P1b_X
    s_sleep 2
L_P1b_R:
    ds_read_b32 v3, v148 offset:136
    s_waitcnt lgkmcnt(0)
    s_branch L_P1b
L_P1b_X:
    s_mov_b32 m0, 113664
    s_add_u32 s43, s39, 113664
    buffer_load_dwordx4 v2, s[16:19], s43 offen sc1 lds
    s_waitcnt vmcnt(0)
    s_mov_b64 exec, 1
    ds_add_u32 v148, v149 offset:136
    s_mov_b64 exec, -1
L_LWD:
    s_mov_b64 exec, 1
    s_mov_b32 s62, 0
L_WIP:
    v_mov_b32 v3, 0
    buffer_atomic_add v3, v13, s[16:19], 0 offen sc0 sc1
    s_add_u32 s62, s62, 1
    s_waitcnt vmcnt(0)
    v_cmp_ne_u32 vcc, 2, v3
    s_cmp_gt_u32 s62, 20000
    s_cbranch_scc1 L_WIP_X
    s_cbranch_vccz L_WIP_X
    s_sleep 8
    s_branch L_WIP
L_WIP_X:
    s_mov_b64 exec, -1
    buffer_store_dwordx2 v[150:151], v145, s[24:27], s58 offen offset:0
    buffer_store_dwordx2 v[152:153], v145, s[24:27], s58 offen offset:2560
    buffer_store_dwordx2 v[154:155], v146, s[24:27], s58 offen offset:0
    buffer_store_dwordx2 v[156:157], v146, s[24:27], s58 offen offset:2560
    s_add_u32 s58, s58, 655360
    buffer_store_dwordx2 v[158:159], v145, s[24:27], s58 offen offset:0
    buffer_store_dwordx2 v[160:161], v145, s[24:27], s58 offen offset:2560
    buffer_store_dwordx2 v[162:163], v146, s[24:27], s58 offen offset:0
    buffer_store_dwordx2 v[164:165], v146, s[24:27], s58 offen offset:2560
    s_add_u32 s58, s58, 655360
    s_waitcnt vmcnt(0)
    global_load_dword v167, v147, s[94:95]
    s_setprio 0
    s_mul_i32 s42, s40, 102400
    s_add_u32 s42, s42, s93
    s_add_u32 s42, s42, 10615808
    s_mov_b32 s63, 0
    s_branch L_PW_R
L_PW:
    v_readfirstlane_b32 s88, v3
    s_cmp_ge_u32 s88, 8
    s_cbranch_scc1 L_PW_X
    s_add_u32 s63, s63, 1
    s_cmp_gt_u32 s63, 200000
    s_cbranch_scc1 L_PW_X
    s_sleep 12
L_PW_R:
    ds_read_b32 v3, v148 offset:16
    s_waitcnt lgkmcnt(0)
    s_branch L_PW
L_PW_X:
    s_cmp_lg_u32 s36, 3
    s_cbranch_scc1 L_NOWB
    s_cmp_lt_u32 s5, 31
    s_cbranch_scc1 L_NOWB
    buffer_wbl2 sc1
L_NOWB:
    s_mov_b32 s63, 0
    s_branch L_P4_R
L_P4:
    v_readfirstlane_b32 s88, v3
    s_cmp_ge_u32 s88, 8
    s_cbranch_scc1 L_P4_X
    s_add_u32 s63, s63, 1
    s_cmp_gt_u32 s63, 200000
    s_cbranch_scc1 L_P4_X
    s_sleep 12
L_P4_R:
    ds_read_b32 v3, v148 offset:16
    s_waitcnt lgkmcnt(0)
    s_branch L_P4
L_P4_X:
    s_cmp_lg_u32 s36, 3
    s_cbranch_scc1 L_P6_X
    s_mov_b32 s63, 0
    s_branch L_P6_R
L_P6:
    v_readfirstlane_b32 s88, v3
    s_cmp_ge_u32 s88, 8
    s_cbranch_scc1 L_P6_X
    s_add_u32 s63, s63, 1
    s_cmp_gt_u32 s63, 200000
    s_cbranch_scc1 L_P6_X
    s_sleep 12
L_P6_R:
    ds_read_b32 v3, v148 offset:20
    s_waitcnt lgkmcnt(0)
    s_branch L_P6
L_P6_X:
    s_mov_b32 m0, s93
    s_nop 0
    buffer_load_dwordx4 v2, s[16:19], s42 offen sc1 lds
    s_add_u32 m0, m0, 1024
    s_add_u32 s42, s42, 1024
    s_waitcnt vmcnt(4)
    s_nop 0
    buffer_load_dwordx4 v2, s[16:19], s42 offen sc1 lds
    s_add_u32 m0, m0, 1024
    s_add_u32 s42, s42, 1024
    s_waitcnt vmcnt(4)
    s_nop 0
    buffer_load_dwordx4 v2, s[16:19], s42 offen sc1 lds
    s_add_u32 m0, m0, 1024
    s_add_u32 s42, s42, 1024
    s_waitcnt vmcnt(4)
    s_nop 0
    buffer_load_dwordx4 v2, s[16:19], s42 offen sc1 lds
    s_add_u32 m0, m0, 1024
    s_add_u32 s42, s42, 1024
    s_waitcnt vmcnt(4)
    s_nop 0
    buffer_load_dwordx4 v2, s[16:19], s42 offen sc1 lds
    s_add_u32 m0, m0, 1024
    s_add_u32 s42, s42, 1024
    s_waitcnt vmcnt(4)
    s_nop 0
    buffer_load_dwordx4 v2, s[16:19], s42 offen sc1 lds
    s_add_u32 m0, m0, 1024
    s_add_u32 s42, s42, 1024
    s_waitcnt vmcnt(4)
    s_nop 0
    buffer_load_dwordx4 v2, s[16:19], s42 offen sc1 lds
    s_add_u32 m0, m0, 1024
    s_add_u32 s42, s42, 1024
    s_waitcnt vmcnt(4)
    s_nop 0
    buffer_load_dwordx4 v2, s[16:19], s42 offen sc1 lds
    s_add_u32 m0, m0, 1024
    s_add_u32 s42, s42, 1024
    s_waitcnt vmcnt(4)
    s_nop 0
    buffer_load_dwordx4 v2, s[16:19], s42 offen sc1 lds
    s_add_u32 m0, m0, 1024
    s_add_u32 s42, s42, 1024
    s_waitcnt vmcnt(4)
    s_nop 0
    buffer_load_dwordx4 v2, s[16:19], s42 offen sc1 lds
    s_add_u32 m0, m0, 1024
    s_add_u32 s42, s42, 1024
    s_waitcnt vmcnt(4)
    s_nop 0
    buffer_load_dwordx4 v2, s[16:19], s42 offen sc1 lds
    s_add_u32 m0, m0, 1024
    s_add_u32 s42, s42, 1024
    s_waitcnt vmcnt(4)
    s_nop 0
    buffer_load_dwordx4 v2, s[16:19], s42 offen sc1 lds
    s_add_u32 m0, m0, 1024
    s_add_u32 s42, s42, 1024
    s_waitcnt vmcnt(4)
    s_nop 0
    buffer_load_dwordx4 v2, s[16:19], s42 offen sc1 lds
    s_add_u32 m0, m0, 1024
    s_add_u32 s42, s42, 1024
    s_waitcnt vmcnt(4)
    s_nop 0
    buffer_load_dwordx4 v2, s[16:19], s42 offen sc1 lds
    s_add_u32 m0, m0, 1024
    s_add_u32 s42, s42, 1024
    s_waitcnt vmcnt(4)
    s_nop 0
    buffer_load_dwordx4 v2, s[16:19], s42 offen sc1 lds
    s_add_u32 m0, m0, 1024
    s_add_u32 s42, s42, 1024
    s_waitcnt vmcnt(4)
    s_nop 0
    buffer_load_dwordx4 v2, s[16:19], s42 offen sc1 lds
    s_add_u32 m0, m0, 1024
    s_add_u32 s42, s42, 1024
    s_waitcnt vmcnt(4)
    s_nop 0
    buffer_load_dwordx4 v2, s[16:19], s42 offen sc1 lds
    s_add_u32 m0, m0, 1024
    s_add_u32 s42, s42, 1024
    s_waitcnt vmcnt(4)
    s_nop 0
    buffer_load_dwordx4 v2, s[16:19], s42 offen sc1 lds
    s_add_u32 m0, m0, 1024
    s_add_u32 s42, s42, 1024
    s_waitcnt vmcnt(4)
    s_nop 0
    buffer_load_dwordx4 v2, s[16:19], s42 offen sc1 lds
    s_add_u32 m0, m0, 1024
    s_add_u32 s42, s42, 1024
    s_waitcnt vmcnt(4)
    s_nop 0
    buffer_load_dwordx4 v2, s[16:19], s42 offen sc1 lds
    s_add_u32 m0, m0, 1024
    s_add_u32 s42, s42, 1024
    s_waitcnt vmcnt(4)
    s_nop 0
    buffer_load_dwordx4 v2, s[16:19], s42 offen sc1 lds
    s_add_u32 m0, m0, 1024
    s_add_u32 s42, s42, 1024
    s_waitcnt vmcnt(4)
    s_nop 0
    buffer_load_dwordx4 v2, s[16:19], s42 offen sc1 lds
    s_add_u32 m0, m0, 1024
    s_add_u32 s42, s42, 1024
    s_waitcnt vmcnt(4)
    s_nop 0
    buffer_load_dwordx4 v2, s[16:19], s42 offen sc1 lds
    s_add_u32 m0, m0, 1024
    s_add_u32 s42, s42, 1024
    s_waitcnt vmcnt(4)
    s_nop 0
    buffer_load_dwordx4 v2, s[16:19], s42 offen sc1 lds
    s_add_u32 m0, m0, 1024
    s_add_u32 s42, s42, 1024
    s_waitcnt vmcnt(4)
    s_nop 0
    buffer_load_dwordx4 v2, s[16:19], s42 offen sc1 lds
    s_add_u32 m0, m0, 1024
    s_add_u32 s42, s42, 1024
    s_waitcnt vmcnt(4)
    global_load_dword v167, v147, s[94:95]
    s_waitcnt vmcnt(0)
    s_mov_b64 exec, 1
    ds_add_u32 v148, v149 offset:128
    s_mov_b64 exec, -1
    s_mov_b32 s63, 0
    s_branch L_WT_R
L_WT:
    v_readfirstlane_b32 s88, v3
    s_cmp_ge_u32 s88, 4
    s_cbranch_scc1 L_WT_X
    s_add_u32 s63, s63, 1
    s_cmp_gt_u32 s63, 200000
    s_cbranch_scc1 L_WT_X
    s_sleep 12
L_WT_R:
    ds_read_b32 v3, v148 offset:128
    s_waitcnt lgkmcnt(0)
    s_branch L_WT
L_WT_X:
    s_mov_b32 s63, 0
    s_branch L_P7_R
L_P7:
    v_readfirstlane_b32 s88, v3
    s_cmp_ge_u32 s88, 8
    s_cbranch_scc1 L_P7_X
    s_add_u32 s63, s63, 1
    s_cmp_gt_u32 s63, 200000
    s_cbranch_scc1 L_P7_X
    s_sleep 12
L_P7_R:
    ds_read_b32 v3, v148 offset:28
    s_waitcnt lgkmcnt(0)
    s_branch L_P7
L_P7_X:
    s_waitcnt vmcnt(0)
    v_mov_b32 v4, v7
    v_mov_b32 v5, v8
    v_mov_b32 v6, v15
    v_mov_b32 v7, v9
    v_mov_b32 v3, 0
    s_mov_b32 s42, 15
    s_mov_b32 s62, 0
    s_mov_b32 s60, s98
    s_mul_i32 s88, s60, 25600
    v_add_u32 v1, s88, v2
    ds_read_b128 v[68:71], v1 offset:1024
    ds_read_b128 v[72:75], v1 offset:2048
    ds_read_b128 v[76:79], v1 offset:3072
    ds_read_b128 v[80:83], v1 offset:4096
    ds_read_b128 v[84:87], v1 offset:5120
    ds_read_b128 v[88:91], v1 offset:6144
    ds_read_b128 v[92:95], v1 offset:7168
    ds_read_b128 v[96:99], v1 offset:8192
    ds_read_b128 v[100:103], v1 offset:9216
    ds_read_b128 v[104:107], v1 offset:10240
    ds_read_b128 v[108:111], v1 offset:11264
    ds_read_b128 v[112:115], v1 offset:12288
    ds_read_b128 v[116:119], v1 offset:13312
    s_waitcnt lgkmcnt(11)
    ds_read_b128 v[120:123], v1 offset:14336
    ds_read_b128 v[124:127], v1 offset:15360
    ds_read_b128 v[128:131], v1 offset:16384
    s_waitcnt lgkmcnt(11)
    ds_read_b128 v[132:135], v1 offset:17408
    ds_read_b128 v[136:139], v1 offset:18432
    ds_read_b128 v[140:143], v1 offset:19456
    s_waitcnt lgkmcnt(11)
    ds_read_b128 v[144:147], v1 offset:20480
    ds_read_b128 v[148:151], v1 offset:21504
    ds_read_b128 v[152:155], v1 offset:22528
    s_waitcnt lgkmcnt(11)
    ds_read_b128 v[156:159], v1 offset:23552
    ds_read_b128 v[160:163], v1 offset:24576
    ds_read_b128 v[164:167], v1 offset:25600
    s_waitcnt lgkmcnt(11)
    v_mov_b32 v6, 132
    s_lshr_b32 s99, s36, 1
    s_lshl_b32 s99, s99, 2
L_O_ACQ0:
    ds_read_b32 v3, v6
    s_add_u32 s62, s62, 1
    s_waitcnt lgkmcnt(0)
    v_readfirstlane_b32 s43, v3
    s_lshr_b32 s43, s43, s99
    s_cmp_gt_u32 s62, 800000
    s_cselect_b32 s43, 15, s43
    s_and_b32 s43, s43, s42
    s_cbranch_scc1 L_O_GOT0
    s_sleep 1
    s_branch L_O_ACQ0
L_O_GOT0:
    s_ff1_i32_b32 s61, s43
    s_bitcmp1_b32 s43, s60
    s_cselect_b32 s61, s60, s61
    s_mul_i32 s88, s61, 10240
    s_add_u32 s88, s88, s59
    s_cmp_gt_u32 s61, 3
    s_cselect_b32 s88, 0x7ff00000, s88
    s_add_u32 s89, s88, 5120
    buffer_load_dwordx4 v[8:11], v4, s[16:19], s88 offen offset:0 sc1
    buffer_load_dwordx4 v[12:15], v4, s[16:19], s88 offen offset:2560 sc1
    buffer_load_dwordx4 v[16:19], v4, s[16:19], s89 offen offset:0 sc1
    buffer_load_dwordx4 v[20:23], v4, s[16:19], s89 offen offset:2560 sc1
    buffer_load_dwordx2 v[24:25], v5, s[16:19], s88 offen offset:1024 sc1
    buffer_load_dwordx2 v[26:27], v5, s[16:19], s88 offen offset:2304 sc1
    s_bitset0_b32 s42, s61
    s_bitset0_b32 s43, s61
    s_cmp_eq_u32 s61, s60
    s_cbranch_scc1 L_O_RUN0
    s_mul_i32 s88, s61, 25600
    v_add_u32 v1, s88, v2
    ds_read_b128 v[68:71], v1 offset:1024
    ds_read_b128 v[72:75], v1 offset:2048
    ds_read_b128 v[76:79], v1 offset:3072
    ds_read_b128 v[80:83], v1 offset:4096
    ds_read_b128 v[84:87], v1 offset:5120
    ds_read_b128 v[88:91], v1 offset:6144
    ds_read_b128 v[92:95], v1 offset:7168
    ds_read_b128 v[96:99], v1 offset:8192
    ds_read_b128 v[100:103], v1 offset:9216
    ds_read_b128 v[104:107], v1 offset:10240
    ds_read_b128 v[108:111], v1 offset:11264
    ds_read_b128 v[112:115], v1 offset:12288
    ds_read_b128 v[116:119], v1 offset:13312
    s_waitcnt lgkmcnt(11)
    ds_read_b128 v[120:123], v1 offset:14336
    ds_read_b128 v[124:127], v1 offset:15360
    ds_read_b128 v[128:131], v1 offset:16384
    s_waitcnt lgkmcnt(11)
    ds_read_b128 v[132:135], v1 offset:17408
    ds_read_b128 v[136:139], v1 offset:18432
    ds_read_b128 v[140:143], v1 offset:19456
    s_waitcnt lgkmcnt(11)
    ds_read_b128 v[144:147], v1 offset:20480
    ds_read_b128 v[148:151], v1 offset:21504
    ds_read_b128 v[152:155], v1 offset:22528
    s_waitcnt lgkmcnt(11)
    ds_read_b128 v[156:159], v1 offset:23552
    ds_read_b128 v[160:163], v1 offset:24576
    ds_read_b128 v[164:167], v1 offset:25600
    s_waitcnt lgkmcnt(11)
L_O_RUN0:
    s_cmp_eq_u32 s42, 0
    s_cbranch_scc1 L_O_LAST0
    ds_read_b32 v3, v6
    s_waitcnt lgkmcnt(0)
    v_readfirstlane_b32 s43, v3
    s_lshr_b32 s43, s43, s99
    s_and_b32 s43, s43, s42
    s_ff1_i32_b32 s61, s43
    s_ff1_i32_b32 s60, s42
    s_cmp_lt_i32 s61, 0
    s_cselect_b32 s60, s60, s61
    s_max_i32 s60, s60, 0
    s_mul_i32 s88, s61, 10240
    s_add_u32 s88, s88, s59
    s_cmp_gt_u32 s61, 3
    s_cselect_b32 s88, 0x7ff00000, s88
    s_add_u32 s89, s88, 5120
    buffer_load_dwordx4 v[28:31], v4, s[16:19], s88 offen offset:0 sc1
    buffer_load_dwordx4 v[32:35], v4, s[16:19], s88 offen offset:2560 sc1
    buffer_load_dwordx4 v[36:39], v4, s[16:19], s89 offen offset:0 sc1
    buffer_load_dwordx4 v[40:43], v4, s[16:19], s89 offen offset:2560 sc1
    buffer_load_dwordx2 v[44:45], v5, s[16:19], s88 offen offset:1024 sc1
    buffer_load_dwordx2 v[46:47], v5, s[16:19], s88 offen offset:2304 sc1
    s_mul_i32 s88, s60, 25600
    v_add_u32 v1, s88, v2
    s_waitcnt vmcnt(11)
    v_mfma_f32_16x16x32_bf16 v[48:51], v[68:71], v[8:11], v[48:51]
    ds_read_b128 v[68:71], v1 offset:1024
    v_mfma_f32_16x16x32_bf16 v[52:55], v[72:75], v[8:11], v[52:55]
    ds_read_b128 v[72:75], v1 offset:2048
    v_mfma_f32_16x16x32_bf16 v[56:59], v[76:79], v[8:11], v[56:59]
    ds_read_b128 v[76:79], v1 offset:3072
    v_mfma_f32_16x16x32_bf16 v[60:63], v[80:83], v[8:11], v[60:63]
    ds_read_b128 v[80:83], v1 offset:4096
    v_mfma_f32_16x16x32_bf16 v[64:67], v[84:87], v[8:11], v[64:67]
    ds_read_b128 v[84:87], v1 offset:5120
    s_waitcnt vmcnt(10)
    v_mfma_f32_16x16x32_bf16 v[48:51], v[88:91], v[12:15], v[48:51]
    ds_read_b128 v[88:91], v1 offset:6144
    v_mfma_f32_16x16x32_bf16 v[52:55], v[92:95], v[12:15], v[52:55]
    ds_read_b128 v[92:95], v1 offset:7168
    v_mfma_f32_16x16x32_bf16 v[56:59], v[96:99], v[12:15], v[56:59]
    ds_read_b128 v[96:99], v1 offset:8192
    v_mfma_f32_16x16x32_bf16 v[60:63], v[100:103], v[12:15], v[60:63]
    ds_read_b128 v[100:103], v1 offset:9216
    v_mfma_f32_16x16x32_bf16 v[64:67], v[104:107], v[12:15], v[64:67]
    ds_read_b128 v[104:107], v1 offset:10240
    s_waitcnt vmcnt(9)
    v_mfma_f32_16x16x32_bf16 v[48:51], v[108:111], v[16:19], v[48:51]
    ds_read_b128 v[108:111], v1 offset:11264
    v_mfma_f32_16x16x32_bf16 v[52:55], v[112:115], v[16:19], v[52:55]
    ds_read_b128 v[112:115], v1 offset:12288
    v_mfma_f32_16x16x32_bf16 v[56:59], v[116:119], v[16:19], v[56:59]
    ds_read_b128 v[116:119], v1 offset:13312
    v_mfma_f32_16x16x32_bf16 v[60:63], v[120:123], v[16:19], v[60:63]
    ds_read_b128 v[120:123], v1 offset:14336
    v_mfma_f32_16x16x32_bf16 v[64:67], v[124:127], v[16:19], v[64:67]
    s_waitcnt lgkmcnt(13)
    ds_read_b128 v[124:127], v1 offset:15360
    s_waitcnt vmcnt(8)
    v_mfma_f32_16x16x32_bf16 v[48:51], v[128:131], v[20:23], v[48:51]
    s_waitcnt lgkmcnt(13)
    ds_read_b128 v[128:131], v1 offset:16384
    v_mfma_f32_16x16x32_bf16 v[52:55], v[132:135], v[20:23], v[52:55]
    s_waitcnt lgkmcnt(13)
    ds_read_b128 v[132:135], v1 offset:17408
    v_mfma_f32_16x16x32_bf16 v[56:59], v[136:139], v[20:23], v[56:59]
    s_waitcnt lgkmcnt(13)
    ds_read_b128 v[136:139], v1 offset:18432
    v_mfma_f32_16x16x32_bf16 v[60:63], v[140:143], v[20:23], v[60:63]
    s_waitcnt lgkmcnt(13)
    ds_read_b128 v[140:143], v1 offset:19456
    v_mfma_f32_16x16x32_bf16 v[64:67], v[144:147], v[20:23], v[64:67]
    s_waitcnt lgkmcnt(13)
    ds_read_b128 v[144:147], v1 offset:20480
    s_waitcnt vmcnt(6)
    v_mfma_f32_16x16x32_bf16 v[48:51], v[148:151], v[24:27], v[48:51]
    s_waitcnt lgkmcnt(13)
    ds_read_b128 v[148:151], v1 offset:21504
    v_mfma_f32_16x16x32_bf16 v[52:55], v[152:155], v[24:27], v[52:55]
    s_waitcnt lgkmcnt(13)
    ds_read_b128 v[152:155], v1 offset:22528
    v_mfma_f32_16x16x32_bf16 v[56:59], v[156:159], v[24:27], v[56:59]
    s_waitcnt lgkmcnt(13)
    ds_read_b128 v[156:159], v1 offset:23552
    v_mfma_f32_16x16x32_bf16 v[60:63], v[160:163], v[24:27], v[60:63]
    s_waitcnt lgkmcnt(13)
    ds_read_b128 v[160:163], v1 offset:24576
    v_mfma_f32_16x16x32_bf16 v[64:67], v[164:167], v[24:27], v[64:67]
    s_waitcnt lgkmcnt(13)
    ds_read_b128 v[164:167], v1 offset:25600
    s_cmp_eq_u32 s42, 0
    s_cbranch_scc1 L_O_DONE
    s_cmp_lt_i32 s61, 0
    s_cbranch_scc1 L_O_ACQ1
    s_bitset0_b32 s42, s61
    s_branch L_O_RUN1
L_O_ACQ1:
    ds_read_b32 v3, v6
    s_add_u32 s62, s62, 1
    s_waitcnt lgkmcnt(0)
    v_readfirstlane_b32 s43, v3
    s_lshr_b32 s43, s43, s99
    s_cmp_gt_u32 s62, 800000
    s_cselect_b32 s43, 15, s43
    s_and_b32 s43, s43, s42
    s_cbranch_scc1 L_O_GOT1
    s_sleep 1
    s_branch L_O_ACQ1
L_O_GOT1:
    s_ff1_i32_b32 s61, s43
    s_bitcmp1_b32 s43, s60
    s_cselect_b32 s61, s60, s61
    s_mul_i32 s88, s61, 10240
    s_add_u32 s88, s88, s59
    s_cmp_gt_u32 s61, 3
    s_cselect_b32 s88, 0x7ff00000, s88
    s_add_u32 s89, s88, 5120
    buffer_load_dwordx4 v[28:31], v4, s[16:19], s88 offen offset:0 sc1
    buffer_load_dwordx4 v[32:35], v4, s[16:19], s88 offen offset:2560 sc1
    buffer_load_dwordx4 v[36:39], v4, s[16:19], s89 offen offset:0 sc1
    buffer_load_dwordx4 v[40:43], v4, s[16:19], s89 offen offset:2560 sc1
    buffer_load_dwordx2 v[44:45], v5, s[16:19], s88 offen offset:1024 sc1
    buffer_load_dwordx2 v[46:47], v5, s[16:19], s88 offen offset:2304 sc1
    s_bitset0_b32 s42, s61
    s_bitset0_b32 s43, s61
    s_cmp_eq_u32 s61, s60
    s_cbranch_scc1 L_O_RUN1
    s_mul_i32 s88, s61, 25600
    v_add_u32 v1, s88, v2
    ds_read_b128 v[68:71], v1 offset:1024
    ds_read_b128 v[72:75], v1 offset:2048
    ds_read_b128 v[76:79], v1 offset:3072
    ds_read_b128 v[80:83], v1 offset:4096
    ds_read_b128 v[84:87], v1 offset:5120
    ds_read_b128 v[88:91], v1 offset:6144
    ds_read_b128 v[92:95], v1 offset:7168
    ds_read_b128 v[96:99], v1 offset:8192
    ds_read_b128 v[100:103], v1 offset:9216
    ds_read_b128 v[104:107], v1 offset:10240
    ds_read_b128 v[108:111], v1 offset:11264
    ds_read_b128 v[112:115], v1 offset:12288
    ds_read_b128 v[116:119], v1 offset:13312
    s_waitcnt lgkmcnt(11)
    ds_read_b128 v[120:123], v1 offset:14336
    ds_read_b128 v[124:127], v1 offset:15360
    ds_read_b128 v[128:131], v1 offset:16384
    s_waitcnt lgkmcnt(11)
    ds_read_b128 v[132:135], v1 offset:17408
    ds_read_b128 v[136:139], v1 offset:18432
    ds_read_b128 v[140:143], v1 offset:19456
    s_waitcnt lgkmcnt(11)
    ds_read_b128 v[144:147], v1 offset:20480
    ds_read_b128 v[148:151], v1 offset:21504
    ds_read_b128 v[152:155], v1 offset:22528
    s_waitcnt lgkmcnt(11)
    ds_read_b128 v[156:159], v1 offset:23552
    ds_read_b128 v[160:163], v1 offset:24576
    ds_read_b128 v[164:167], v1 offset:25600
    s_waitcnt lgkmcnt(11)
L_O_RUN1:
    s_cmp_eq_u32 s42, 0
    s_cbranch_scc1 L_O_LAST1
    ds_read_b32 v3, v6
    s_waitcnt lgkmcnt(0)
    v_readfirstlane_b32 s43, v3
    s_lshr_b32 s43, s43, s99
    s_and_b32 s43, s43, s42
    s_ff1_i32_b32 s61, s43
    s_ff1_i32_b32 s60, s42
    s_cmp_lt_i32 s61, 0
    s_cselect_b32 s60, s60, s61
    s_max_i32 s60, s60, 0
    s_mul_i32 s88, s61, 10240
    s_add_u32 s88, s88, s59
    s_cmp_gt_u32 s61, 3
    s_cselect_b32 s88, 0x7ff00000, s88
    s_add_u32 s89, s88, 5120
    buffer_load_dwordx4 v[8:11], v4, s[16:19], s88 offen offset:0 sc1
    buffer_load_dwordx4 v[12:15], v4, s[16:19], s88 offen offset:2560 sc1
    buffer_load_dwordx4 v[16:19], v4, s[16:19], s89 offen offset:0 sc1
    buffer_load_dwordx4 v[20:23], v4, s[16:19], s89 offen offset:2560 sc1
    buffer_load_dwordx2 v[24:25], v5, s[16:19], s88 offen offset:1024 sc1
    buffer_load_dwordx2 v[26:27], v5, s[16:19], s88 offen offset:2304 sc1
    s_mul_i32 s88, s60, 25600
    v_add_u32 v1, s88, v2
    s_waitcnt vmcnt(11)
    v_mfma_f32_16x16x32_bf16 v[48:51], v[68:71], v[28:31], v[48:51]
    ds_read_b128 v[68:71], v1 offset:1024
    v_mfma_f32_16x16x32_bf16 v[52:55], v[72:75], v[28:31], v[52:55]
    ds_read_b128 v[72:75], v1 offset:2048
    v_mfma_f32_16x16x32_bf16 v[56:59], v[76:79], v[28:31], v[56:59]
    ds_read_b128 v[76:79], v1 offset:3072
    v_mfma_f32_16x16x32_bf16 v[60:63], v[80:83], v[28:31], v[60:63]
    ds_read_b128 v[80:83], v1 offset:4096
    v_mfma_f32_16x16x32_bf16 v[64:67], v[84:87], v[28:31], v[64:67]
    ds_read_b128 v[84:87], v1 offset:5120
    s_waitcnt vmcnt(10)
    v_mfma_f32_16x16x32_bf16 v[48:51], v[88:91], v[32:35], v[48:51]
    ds_read_b128 v[88:91], v1 offset:6144
    v_mfma_f32_16x16x32_bf16 v[52:55], v[92:95], v[32:35], v[52:55]
    ds_read_b128 v[92:95], v1 offset:7168
    v_mfma_f32_16x16x32_bf16 v[56:59], v[96:99], v[32:35], v[56:59]
    ds_read_b128 v[96:99], v1 offset:8192
    v_mfma_f32_16x16x32_bf16 v[60:63], v[100:103], v[32:35], v[60:63]
    ds_read_b128 v[100:103], v1 offset:9216
    v_mfma_f32_16x16x32_bf16 v[64:67], v[104:107], v[32:35], v[64:67]
    ds_read_b128 v[104:107], v1 offset:10240
    s_waitcnt vmcnt(9)
    v_mfma_f32_16x16x32_bf16 v[48:51], v[108:111], v[36:39], v[48:51]
    ds_read_b128 v[108:111], v1 offset:11264
    v_mfma_f32_16x16x32_bf16 v[52:55], v[112:115], v[36:39], v[52:55]
    ds_read_b128 v[112:115], v1 offset:12288
    v_mfma_f32_16x16x32_bf16 v[56:59], v[116:119], v[36:39], v[56:59]
    ds_read_b128 v[116:119], v1 offset:13312
    v_mfma_f32_16x16x32_bf16 v[60:63], v[120:123], v[36:39], v[60:63]
    ds_read_b128 v[120:123], v1 offset:14336
    v_mfma_f32_16x16x32_bf16 v[64:67], v[124:127], v[36:39], v[64:67]
    s_waitcnt lgkmcnt(13)
    ds_read_b128 v[124:127], v1 offset:15360
    s_waitcnt vmcnt(8)
    v_mfma_f32_16x16x32_bf16 v[48:51], v[128:131], v[40:43], v[48:51]
    s_waitcnt lgkmcnt(13)
    ds_read_b128 v[128:131], v1 offset:16384
    v_mfma_f32_16x16x32_bf16 v[52:55], v[132:135], v[40:43], v[52:55]
    s_waitcnt lgkmcnt(13)
    ds_read_b128 v[132:135], v1 offset:17408
    v_mfma_f32_16x16x32_bf16 v[56:59], v[136:139], v[40:43], v[56:59]
    s_waitcnt lgkmcnt(13)
    ds_read_b128 v[136:139], v1 offset:18432
    v_mfma_f32_16x16x32_bf16 v[60:63], v[140:143], v[40:43], v[60:63]
    s_waitcnt lgkmcnt(13)
    ds_read_b128 v[140:143], v1 offset:19456
    v_mfma_f32_16x16x32_bf16 v[64:67], v[144:147], v[40:43], v[64:67]
    s_waitcnt lgkmcnt(13)
    ds_read_b128 v[144:147], v1 offset:20480
    s_waitcnt vmcnt(6)
    v_mfma_f32_16x16x32_bf16 v[48:51], v[148:151], v[44:47], v[48:51]
    s_waitcnt lgkmcnt(13)
    ds_read_b128 v[148:151], v1 offset:21504
    v_mfma_f32_16x16x32_bf16 v[52:55], v[152:155], v[44:47], v[52:55]
    s_waitcnt lgkmcnt(13)
    ds_read_b128 v[152:155], v1 offset:22528
    v_mfma_f32_16x16x32_bf16 v[56:59], v[156:159], v[44:47], v[56:59]
    s_waitcnt lgkmcnt(13)
    ds_read_b128 v[156:159], v1 offset:23552
    v_mfma_f32_16x16x32_bf16 v[60:63], v[160:163], v[44:47], v[60:63]
    s_waitcnt lgkmcnt(13)
    ds_read_b128 v[160:163], v1 offset:24576
    v_mfma_f32_16x16x32_bf16 v[64:67], v[164:167], v[44:47], v[64:67]
    s_waitcnt lgkmcnt(13)
    ds_read_b128 v[164:167], v1 offset:25600
    s_cmp_eq_u32 s42, 0
    s_cbranch_scc1 L_O_DONE
    s_cmp_lt_i32 s61, 0
    s_cbranch_scc1 L_O_ACQ0
    s_bitset0_b32 s42, s61
    s_branch L_O_RUN0
L_O_LAST0:
    s_waitcnt lgkmcnt(0)
    s_waitcnt vmcnt(5)
    v_mfma_f32_16x16x32_bf16 v[48:51], v[68:71], v[8:11], v[48:51]
    v_mfma_f32_16x16x32_bf16 v[52:55], v[72:75], v[8:11], v[52:55]
    v_mfma_f32_16x16x32_bf16 v[56:59], v[76:79], v[8:11], v[56:59]
    v_mfma_f32_16x16x32_bf16 v[60:63], v[80:83], v[8:11], v[60:63]
    v_mfma_f32_16x16x32_bf16 v[64:67], v[84:87], v[8:11], v[64:67]
    s_waitcnt vmcnt(4)
    v_mfma_f32_16x16x32_bf16 v[48:51], v[88:91], v[12:15], v[48:51]
    v_mfma_f32_16x16x32_bf16 v[52:55], v[92:95], v[12:15], v[52:55]
    v_mfma_f32_16x16x32_bf16 v[56:59], v[96:99], v[12:15], v[56:59]
    v_mfma_f32_16x16x32_bf16 v[60:63], v[100:103], v[12:15], v[60:63]
    v_mfma_f32_16x16x32_bf16 v[64:67], v[104:107], v[12:15], v[64:67]
    s_waitcnt vmcnt(3)
    v_mfma_f32_16x16x32_bf16 v[48:51], v[108:111], v[16:19], v[48:51]
    v_mfma_f32_16x16x32_bf16 v[52:55], v[112:115], v[16:19], v[52:55]
    v_mfma_f32_16x16x32_bf16 v[56:59], v[116:119], v[16:19], v[56:59]
    v_mfma_f32_16x16x32_bf16 v[60:63], v[120:123], v[16:19], v[60:63]
    v_mfma_f32_16x16x32_bf16 v[64:67], v[124:127], v[16:19], v[64:67]
    s_waitcnt vmcnt(2)
    v_mfma_f32_16x16x32_bf16 v[48:51], v[128:131], v[20:23], v[48:51]
    v_mfma_f32_16x16x32_bf16 v[52:55], v[132:135], v[20:23], v[52:55]
    v_mfma_f32_16x16x32_bf16 v[56:59], v[136:139], v[20:23], v[56:59]
    v_mfma_f32_16x16x32_bf16 v[60:63], v[140:143], v[20:23], v[60:63]
    v_mfma_f32_16x16x32_bf16 v[64:67], v[144:147], v[20:23], v[64:67]
    s_waitcnt vmcnt(0)
    v_mfma_f32_16x16x32_bf16 v[48:51], v[148:151], v[24:27], v[48:51]
    v_mfma_f32_16x16x32_bf16 v[52:55], v[152:155], v[24:27], v[52:55]
    v_mfma_f32_16x16x32_bf16 v[56:59], v[156:159], v[24:27], v[56:59]
    v_mfma_f32_16x16x32_bf16 v[60:63], v[160:163], v[24:27], v[60:63]
    v_mfma_f32_16x16x32_bf16 v[64:67], v[164:167], v[24:27], v[64:67]
    s_branch L_O_DONE
L_O_LAST1:
    s_waitcnt lgkmcnt(0)
    s_waitcnt vmcnt(5)
    v_mfma_f32_16x16x32_bf16 v[48:51], v[68:71], v[28:31], v[48:51]
    v_mfma_f32_16x16x32_bf16 v[52:55], v[72:75], v[28:31], v[52:55]
    v_mfma_f32_16x16x32_bf16 v[56:59], v[76:79], v[28:31], v[56:59]
    v_mfma_f32_16x16x32_bf16 v[60:63], v[80:83], v[28:31], v[60:63]
    v_mfma_f32_16x16x32_bf16 v[64:67], v[84:87], v[28:31], v[64:67]
    s_waitcnt vmcnt(4)
    v_mfma_f32_16x16x32_bf16 v[48:51], v[88:91], v[32:35], v[48:51]
    v_mfma_f32_16x16x32_bf16 v[52:55], v[92:95], v[32:35], v[52:55]
    v_mfma_f32_16x16x32_bf16 v[56:59], v[96:99], v[32:35], v[56:59]
    v_mfma_f32_16x16x32_bf16 v[60:63], v[100:103], v[32:35], v[60:63]
    v_mfma_f32_16x16x32_bf16 v[64:67], v[104:107], v[32:35], v[64:67]
    s_waitcnt vmcnt(3)
    v_mfma_f32_16x16x32_bf16 v[48:51], v[108:111], v[36:39], v[48:51]
    v_mfma_f32_16x16x32_bf16 v[52:55], v[112:115], v[36:39], v[52:55]
    v_mfma_f32_16x16x32_bf16 v[56:59], v[116:119], v[36:39], v[56:59]
    v_mfma_f32_16x16x32_bf16 v[60:63], v[120:123], v[36:39], v[60:63]
    v_mfma_f32_16x16x32_bf16 v[64:67], v[124:127], v[36:39], v[64:67]
    s_waitcnt vmcnt(2)
    v_mfma_f32_16x16x32_bf16 v[48:51], v[128:131], v[40:43], v[48:51]
    v_mfma_f32_16x16x32_bf16 v[52:55], v[132:135], v[40:43], v[52:55]
    v_mfma_f32_16x16x32_bf16 v[56:59], v[136:139], v[40:43], v[56:59]
    v_mfma_f32_16x16x32_bf16 v[60:63], v[140:143], v[40:43], v[60:63]
    v_mfma_f32_16x16x32_bf16 v[64:67], v[144:147], v[40:43], v[64:67]
    s_waitcnt vmcnt(0)
    v_mfma_f32_16x16x32_bf16 v[48:51], v[148:151], v[44:47], v[48:51]
    v_mfma_f32_16x16x32_bf16 v[52:55], v[152:155], v[44:47], v[52:55]
    v_mfma_f32_16x16x32_bf16 v[56:59], v[156:159], v[44:47], v[56:59]
    v_mfma_f32_16x16x32_bf16 v[60:63], v[160:163], v[44:47], v[60:63]
    v_mfma_f32_16x16x32_bf16 v[64:67], v[164:167], v[44:47], v[64:67]
L_O_DONE:
    s_waitcnt vmcnt(0)
    v_lshrrev_b32 v4, 4, v0
    v_and_b32 v5, 15, v0
    v_mul_u32_u24 v5, 2560, v5
    v_lshl_add_u32 v5, v4, 3, v5
    s_nop 2
    v_cvt_pk_bf16_f32 v16, v48, v49
    v_cvt_pk_bf16_f32 v17, v50, v51
    v_cvt_pk_bf16_f32 v18, v52, v53
    v_cvt_pk_bf16_f32 v19, v54, v55
    v_cvt_pk_bf16_f32 v20, v56, v57
    v_cvt_pk_bf16_f32 v21, v58, v59
    v_cvt_pk_bf16_f32 v22, v60, v61
    v_cvt_pk_bf16_f32 v23, v62, v63
    v_cvt_pk_bf16_f32 v24, v64, v65
    v_cvt_pk_bf16_f32 v25, v66, v67
    v_permlane16_swap_b32 v16, v18
    v_permlane16_swap_b32 v17, v19
    v_permlane16_swap_b32 v20, v22
    v_permlane16_swap_b32 v21, v23
    buffer_store_dwordx2 v[24:25], v5, s[24:27], s56 offen offset:128
    buffer_store_dwordx4 v[16:19], v7, s[24:27], s56 offen
    buffer_store_dwordx4 v[20:23], v7, s[24:27], s56 offen offset:64
L_END:
    s_endpgm
L_FREE:
    v_lshlrev_b32 v2, 2, v0
    v_add_u32 v2, 114432, v2
    v_cmp_eq_u32 vcc, 0, v0
    v_mov_b32 v8, 0
    v_mov_b32 v9, 0
    v_mov_b32 v10, 0
    v_mov_b32 v11, 0
    v_cndmask_b32 v3, 0, 4, vcc
    ds_write_b32 v2, v3
    v_lshlrev_b32 v4, 4, v0
    s_mul_i32 s88, s3, 3072
    s_add_u32 s88, s88, 10485760
    s_cmp_eq_u32 s2, 240
    s_cselect_b32 s88, s88, 0x7ff00000
    s_waitcnt lgkmcnt(0)
    s_mov_b32 s16, s60
    s_and_b32 s17, s61, 0xffff
    s_mov_b32 s18, 0x1000000
    s_mov_b32 s19, 0x00020000
    s_mov_b32 s12, s38
    s_and_b32 s13, s39, 0xffff
    s_mov_b32 s14, 0x258000
    s_mov_b32 s15, 0x00020000
    v_lshrrev_b32 v5, 1, v0
    v_mul_u32_u24 v5, 3840, v5
    v_and_b32 v6, 1, v0
    v_lshl_add_u32 v5, v6, 7, v5
    s_add_u32 s89, s3, 0
    s_cmp_ge_u32 s89, 10
    s_cselect_b32 s92, 10, 0
    s_sub_u32 s89, s89, s92
    s_lshl_b32 s89, s89, 1
    s_add_u32 s89, s89, s5
    s_sub_u32 s89, s89, 30
    s_mul_i32 s89, s89, 122880
    s_add_u32 s89, s89, 512
    buffer_load_dword v166, v5, s[12:15], s89 offen
    buffer_store_dwordx4 v[8:11], v4, s[16:19], s88 offen offset:0 sc1
    buffer_store_dwordx4 v[8:11], v4, s[16:19], s88 offen offset:1024 sc1
    buffer_store_dwordx4 v[8:11], v4, s[16:19], s88 offen offset:2048 sc1
    s_mov_b32 s24, s56
    s_and_b32 s25, s57, 0xffff
    s_mov_b32 s26, 0x500000
    s_mov_b32 s27, 0x00020000
    s_mov_b32 s28, s40
    s_and_b32 s29, s41, 0xffff
    s_mov_b32 s30, 0xc8000
    s_mov_b32 s31, 0x00020000
    s_mov_b32 s32, s58
    s_and_b32 s33, s59, 0xffff
    s_mov_b32 s34, 0x100
    s_mov_b32 s35, 0x00020000
    s_waitcnt vmcnt(0)
    s_barrier
    v_mov_b32 v1, 114432
    v_mov_b32 v26, 0
    v_mov_b32 v27, 1
    s_sub_u32 s6, s5, 30
    v_mov_b32 v13, 0
    s_cmp_lt_u32 s3, 10
    s_cbranch_scc1 L_F_W
    s_cmp_lg_u32 s3, 10
    s_cbranch_scc1 L_F_B1
    s_cmp_lg_u32 s2, 240
    s_cbranch_scc1 L_F_K
    s_mov_b64 exec, 1
    buffer_store_dword v27, v26, s[32:35], 0 offen sc1
    s_mov_b64 exec, -1
L_F_K:
    s_mov_b32 s62, 0
L_GOP_F:
    buffer_load_dword v27, v26, s[32:35], 0 offen sc1
    s_add_u32 s62, s62, 1
    s_waitcnt vmcnt(0)
    v_cmp_ne_u32 vcc, 1, v27
    s_cmp_gt_u32 s62, 20000
    s_cbranch_scc1 L_GOP_F_X
    s_cbranch_vccz L_GOP_F_X
    s_sleep 16
    s_branch L_GOP_F
L_GOP_F_X:
    v_mov_b32 v27, 1
    ds_write_b32 v1, v27 offset:36
    s_branch L_F_B1
L_F_W:
    s_mul_i32 s92, s6, 10
    s_add_u32 s92, s92, s3
    s_mul_i32 s92, s92, 40960
    s_mul_i32 s88, s4, 160
    s_add_u32 s92, s92, s88
    s_mul_i32 s93, s3, 5120
    v_add_u32 v10, 0, v0
    v_mul_u32_u24 v11, 6554, v10
    v_lshrrev_b32 v11, 16, v11
    v_mul_u32_u24 v12, 10, v11
    v_sub_u32 v12, v10, v12
    v_mul_u32_u24 v11, 1280, v11
    v_lshl_add_u32 v13, v12, 4, v11
    s_add_u32 m0, s93, 0
    s_nop 0
    buffer_load_dwordx4 v13, s[28:31], s92 offen lds
    v_add_u32 v10, 64, v0
    v_mul_u32_u24 v11, 6554, v10
    v_lshrrev_b32 v11, 16, v11
    v_mul_u32_u24 v12, 10, v11
    v_sub_u32 v12, v10, v12
    v_mul_u32_u24 v11, 1280, v11
    v_lshl_add_u32 v13, v12, 4, v11
    s_add_u32 m0, s93, 1024
    s_nop 0
    buffer_load_dwordx4 v13, s[28:31], s92 offen lds
    v_add_u32 v10, 128, v0
    v_mul_u32_u24 v11, 6554, v10
    v_lshrrev_b32 v11, 16, v11
    v_mul_u32_u24 v12, 10, v11
    v_sub_u32 v12, v10, v12
    v_mul_u32_u24 v11, 1280, v11
    v_lshl_add_u32 v13, v12, 4, v11
    s_add_u32 m0, s93, 2048
    s_nop 0
    buffer_load_dwordx4 v13, s[28:31], s92 offen lds
    v_add_u32 v10, 192, v0
    v_mul_u32_u24 v11, 6554, v10
    v_lshrrev_b32 v11, 16, v11
    v_mul_u32_u24 v12, 10, v11
    v_sub_u32 v12, v10, v12
    v_mul_u32_u24 v11, 1280, v11
    v_lshl_add_u32 v13, v12, 4, v11
    s_add_u32 m0, s93, 3072
    s_nop 0
    buffer_load_dwordx4 v13, s[28:31], s92 offen lds
    v_add_u32 v10, 256, v0
    v_mul_u32_u24 v11, 6554, v10
    v_lshrrev_b32 v11, 16, v11
    v_mul_u32_u24 v12, 10, v11
    v_sub_u32 v12, v10, v12
    v_mul_u32_u24 v11, 1280, v11
    v_lshl_add_u32 v13, v12, 4, v11
    s_add_u32 m0, s93, 4096
    s_nop 0
    buffer_load_dwordx4 v13, s[28:31], s92 offen lds
    s_cmp_ge_u32 s3, 5
    s_cselect_b32 s94, 1, 0
    s_mul_i32 s88, s94, 5
    s_sub_u32 s95, s3, s88
    v_lshrrev_b32 v4, 4, v0
    v_lshrrev_b32 v5, 1, v4
    v_and_b32 v6, 1, v4
    v_bfe_u32 v9, v0, 2, 2
    v_and_b32 v10, 3, v0
    v_mul_u32_u24 v11, 20, v5
    v_lshl_add_u32 v11, v6, 2, v11
    v_mul_u32_u24 v12, 40, v4
    v_add_u32 v12, 16, v12
    s_cmp_eq_u32 s95, 4
    s_cselect_b64 vcc, -1, 0
    s_cselect_b32 s96, 20, 8
    s_cselect_b32 s88, 0, s95
    s_mul_i32 s88, s88, 40
    s_mul_i32 s89, s94, 160
    s_add_u32 s88, s88, s89
    v_cndmask_b32 v11, v11, v12, vcc
    v_add3_u32 v11, v11, v9, s88
    v_mul_u32_u24 v11, 160, v11
    v_lshl_add_u32 v11, v10, 3, v11
    s_mul_i32 s96, s96, 160
    v_add_u32 v12, s96, v11
    s_mul_i32 s92, s4, 102400
    s_mul_i32 s88, s6, 51200
    s_add_u32 s92, s92, s88
    s_add_u32 s92, s92, s93
    s_add_u32 s92, s92, 10616832
    s_add_u32 s93, s92, 4096
    v_lshlrev_b32 v13, 4, v0
    s_waitcnt vmcnt(0)
L_F_B1:
    s_barrier
    s_cmp_ge_u32 s3, 10
    s_cbranch_scc1 L_F_B2
    ds_read_b64_tr_b16 v[32:33], v11 offset:0
    ds_read_b64_tr_b16 v[34:35], v12 offset:0
    ds_read_b64_tr_b16 v[36:37], v11 offset:32
    ds_read_b64_tr_b16 v[38:39], v12 offset:32
    ds_read_b64_tr_b16 v[40:41], v11 offset:64
    ds_read_b64_tr_b16 v[42:43], v12 offset:64
    ds_read_b64_tr_b16 v[44:45], v11 offset:96
    ds_read_b64_tr_b16 v[46:47], v12 offset:96
    ds_read_b64_tr_b16 v[48:49], v11 offset:128
    ds_read_b64_tr_b16 v[50:51], v12 offset:128
    s_waitcnt lgkmcnt(8)
    buffer_store_dwordx4 v[32:35], v13, s[16:19], s92 offen offset:0 sc1
    s_waitcnt lgkmcnt(6)
    buffer_store_dwordx4 v[36:39], v13, s[16:19], s92 offen offset:1024 sc1
    s_waitcnt lgkmcnt(4)
    buffer_store_dwordx4 v[40:43], v13, s[16:19], s92 offen offset:2048 sc1
    s_waitcnt lgkmcnt(2)
    buffer_store_dwordx4 v[44:47], v13, s[16:19], s92 offen offset:3072 sc1
    s_waitcnt lgkmcnt(0)
    buffer_store_dwordx4 v[48:51], v13, s[16:19], s93 offen offset:0 sc1
    s_waitcnt vmcnt(0)
L_F_B2:
    s_waitcnt lgkmcnt(0)
    s_barrier
    s_cmp_lt_u32 s3, 8
    s_cbranch_scc1 L_ATT
    s_cmp_lg_u32 s3, 10
    s_cbranch_scc1 L_SVC2
    s_lshl_b32 s88, s4, 7
    s_add_u32 s88, s88, 10489868
    v_lshl_add_u32 v26, v0, 10, s88
    s_mov_b32 exec_hi, 0
    buffer_atomic_add v27, v26, s[16:19], 0 offen sc1
    s_mov_b64 exec, -1
    s_branch L_SVC2
L_UTR:
    v_mov_b32 v1, 114432
    v_mov_b32 v26, 0
    s_waitcnt lgkmcnt(0)
    s_mov_b32 s16, s60
    s_and_b32 s17, s61, 0xffff
    s_mov_b32 s18, 0x1000000
    s_mov_b32 s19, 0x00020000
    s_mov_b32 s24, s56
    s_and_b32 s25, s57, 0xffff
    s_mov_b32 s26, 0x500000
    s_mov_b32 s27, 0x00020000
    s_mov_b32 s28, s40
    s_and_b32 s29, s41, 0xffff
    s_mov_b32 s30, 0xc8000
    s_mov_b32 s31, 0x00020000
    s_mov_b32 s32, s58
    s_and_b32 s33, s59, 0xffff
    s_mov_b32 s34, 0x100
    s_mov_b32 s35, 0x00020000
    s_barrier
    s_barrier
    s_barrier
    s_barrier
    s_barrier
    s_barrier
    s_barrier
    s_barrier
    s_barrier
    s_barrier
    s_cmp_lg_u32 s3, 8
    s_cbranch_scc1 L_SVC2
    s_mov_b32 s62, 0
L_GOP_U:
    buffer_load_dword v27, v26, s[32:35], 0 offen sc1
    s_add_u32 s62, s62, 1
    s_waitcnt vmcnt(0)
    v_cmp_ne_u32 vcc, 1, v27
    s_cmp_gt_u32 s62, 20000
    s_cbranch_scc1 L_GOP_U_X
    s_cbranch_vccz L_GOP_U_X
    s_sleep 16
    s_branch L_GOP_U
L_GOP_U_X:
    v_mov_b32 v27, 1
    ds_write_b32 v1, v27 offset:36
    s_branch L_SVC2
L_CODE_END:
.section .rodata,"a"
.p2align 6
.amdhsa_kernel concat_heads__mha_block__ssm_conv_s4d__prompt_kernel
  .amdhsa_next_free_vgpr 168
  .amdhsa_next_free_sgpr 102
  .amdhsa_accum_offset 168
  .amdhsa_group_segment_fixed_size 0
  .amdhsa_kernarg_size 104
  .amdhsa_user_sgpr_count 2
  .amdhsa_user_sgpr_kernarg_segment_ptr 1
  .amdhsa_system_sgpr_workgroup_id_x 1
.end_amdhsa_kernel
```
